```python
import torch

def _softmax(x, axis=-1):
    return torch.softmax(x, dim=axis)
def _gelu(x):
    return torch.nn.functional.gelu(x, approximate="tanh")
def _silu(x):
    return torch.nn.functional.silu(x)
def _sigmoid(x):
    return torch.sigmoid(x)
def _layernorm(x, axis=-1, eps=1e-5):
    m = x.mean(dim=axis, keepdim=True)
    v = x.var(dim=axis, keepdim=True, unbiased=False)
    return (x - m) / torch.sqrt(v + eps)
def _scatter_add(tgt, idx, src, axis=0):
    return tgt.clone().index_add_(axis, idx, src)
def _segment_sum(src, seg, n):
    out = torch.zeros((n,) + src.shape[1:], dtype=src.dtype)
    return out.index_add_(0, seg, src)
def _pad(x, pw):
    flat = tuple(v for pair in reversed(pw) for v in pair)
    return torch.nn.functional.pad(x, flat)

kernel_name = 'interleave_layers__linear_kernel_hedgehog__glu_gated_geglu__prompt'

def setup_inputs():

    _w = (lambda a: (lambda t: t.to(torch.bfloat16) if t.is_floating_point() else t)(torch.as_tensor(a)))
    def _A_setup():
        B, S, D, H = 1, 2048, 448, 16
        Dh = D // H
        return {
            "x": _w((lambda *s: torch.randn(*s, dtype=torch.bfloat16) * 0.05)(B, S, D)),
            "wqkv": _w((lambda *s: torch.randn(*s, dtype=torch.bfloat16) * 0.4)(D, 3 * D)),
            "w_phi": _w((lambda *s: torch.randn(*s, dtype=torch.bfloat16) * 0.4)(H, Dh, Dh) * (Dh ** -0.5)),
            "wo": _w((lambda *s: torch.randn(*s, dtype=torch.bfloat16) * 0.05)(D, D)),
        }
    _A_in = _A_setup()

    def _B_setup():
        B, S, Dm, Df = 1, 2048, 448, 1792
        return {
            "x": _w((lambda *s: torch.randn(*s, dtype=torch.bfloat16) * 0.05)(B, S, Dm)),
            "w_gate": _w((lambda *s: torch.randn(*s, dtype=torch.bfloat16) * 0.8)(Dm, Df) * (Dm ** -0.5)),
            "w_up": _w((lambda *s: torch.randn(*s, dtype=torch.bfloat16) * 0.8)(Dm, Df) * (Dm ** -0.5)),
            "w_down": _w((lambda *s: torch.randn(*s, dtype=torch.bfloat16) * 0.8)(Df, Dm) * (Df ** -0.5)),
        }
    _B_in = _B_setup()

    return {
        "A_x": _A_in["x"],
        "A_wqkv": _A_in["wqkv"],
        "A_w_phi": _A_in["w_phi"],
        "A_wo": _A_in["wo"],
        "B_x": _B_in["x"],
        "B_w_gate": _B_in["w_gate"],
        "B_w_up": _B_in["w_up"],
        "B_w_down": _B_in["w_down"],
    }

def reference(A_x, A_wqkv, A_w_phi, A_wo, B_x, B_w_gate, B_w_up, B_w_down):
    def _A_ref(x, wqkv, w_phi, wo):
        B, S, D = x.shape
        H = 16; Dh = D // H
        qkv = (lambda x, *d: x.permute(*d))((x @ wqkv).reshape(B, S, 3, H, Dh), 2, 0, 3, 1, 4)
        q, k, v = qkv[0], qkv[1], qkv[2]
        pq = torch.einsum("bhsd,hdf->bhsf", q, w_phi)
        pk = torch.einsum("bhsd,hdf->bhsf", k, w_phi)
        phi_q = torch.concatenate([_softmax(pq, axis=-1), _softmax(-pq, axis=-1)], axis=-1)
        phi_k = torch.concatenate([_softmax(pk, axis=-1), _softmax(-pk, axis=-1)], axis=-1)
        kv = torch.einsum("bhsf,bhsd->bhfd", phi_k, v)
        z  = torch.einsum("bhsf->bhf", phi_k)
        num = torch.einsum("bhqf,bhfd->bhqd", phi_q, kv)
        den = torch.einsum("bhqf,bhf->bhq", phi_q, z)[..., None] + 1e-6
        o = num / den
        return (lambda x, *d: x.permute(*d))(o, 0, 2, 1, 3).reshape(B, S, D) @ wo

    def _B_ref(x, w_gate, w_up, w_down):
        g = torch.einsum("bsd,df->bsf", x, w_gate)
        u = torch.einsum("bsd,df->bsf", x, w_up)
        h = _gelu(g) * u
        return torch.einsum("bsf,fd->bsd", h, w_down)

    x = A_x
    x = x + _A_ref(_layernorm(x, axis=-1), A_wqkv, A_w_phi, A_wo)
    x = x + _B_ref(_layernorm(x, axis=-1), B_w_gate, B_w_up, B_w_down)
    x = x + _A_ref(_layernorm(x, axis=-1), A_wqkv, A_w_phi, A_wo)
    x = x + _B_ref(_layernorm(x, axis=-1), B_w_gate, B_w_up, B_w_down)
    return x
```

```asm
; @launch grid=(256,1,1) block=(256,1,1) lds=163840
.amdgcn_target "amdgcn-amd-amdhsa--gfx950"
.text
.globl interleave_layers__linear_kernel_hedgehog__glu_gated_geglu__prompt_kernel
.p2align 8
.type interleave_layers__linear_kernel_hedgehog__glu_gated_geglu__prompt_kernel,@function
interleave_layers__linear_kernel_hedgehog__glu_gated_geglu__prompt_kernel:
  s_cmp_ge_u32 s2, 256
  s_cbranch_scc1 L_end
  s_getpc_b64 s[96:97]
L_pc:
  s_lshr_b32 s48, s2, 3
  s_and_b32 s48, s48, 3
  s_lshl_b32 s48, s48, 14
  v_lshl_add_u32 v12, v0, 6, s48
  v_min_u32 v12, L_code_end-L_pc-4, v12
  global_load_dword a136, v12, s[96:97]
  s_load_dwordx2 s[16:17], s[0:1], 16
  s_load_dwordx2 s[12:13], s[0:1], 8
  s_load_dwordx2 s[8:9], s[0:1], 0
  s_load_dwordx2 s[20:21], s[0:1], 80
  s_load_dwordx2 s[24:25], s[0:1], 64
  s_load_dwordx2 s[32:33], s[0:1], 24
  s_load_dwordx2 s[34:35], s[0:1], 40
  s_load_dwordx2 s[36:37], s[0:1], 48
  s_load_dwordx2 s[38:39], s[0:1], 56
  v_lshrrev_b32 v8, 6, v0
  v_and_b32 v0, 63, v0
  v_readfirstlane_b32 s42, v8
  s_getreg_b32 s45, hwreg(HW_REG_XCC_ID, 0, 4)
  s_and_b32 s40, s2, 7
  s_lshl_b32 s40, s40, 1
  s_lshr_b32 s48, s2, 7
  s_add_u32 s40, s40, s48
  s_lshr_b32 s41, s2, 3
  s_and_b32 s41, s41, 15
  v_lshlrev_b32 v1, 4, v0
  v_and_b32 v9, 31, v0
  v_lshrrev_b32 v10, 5, v0
  v_and_b32 v11, 19, v9
  v_and_b32 v12, 4, v9
  v_lshl_or_b32 v11, v12, 1, v11
  v_and_b32 v12, 8, v9
  v_lshrrev_b32 v12, 1, v12
  v_or_b32 v11, v11, v12
  v_lshlrev_b32 v42, 4, v10
  v_mul_u32_u24 v40, 2688, v11
  v_add_u32 v40, v40, v42
  v_mul_u32_u24 v41, 56, v11
  v_add_u32 v41, v41, v42
  v_cmp_gt_u32 vcc, 28, v11
  v_mov_b32 v12, 0x7f000000
  s_nop 0
  v_cndmask_b32 v41, v12, v41, vcc
  v_lshrrev_b32 v12, 3, v0
  v_lshrrev_b32 v13, 4, v0
  v_xor_b32 v13, v13, v0
  v_and_b32 v13, 7, v13
  v_lshlrev_b32 v13, 4, v13
  v_mul_u32_u24 v244, 896, v12
  v_add_u32 v244, v244, v13
  v_xor_b32 v245, 64, v244
  s_and_b32 s56, s2, 7
  s_mul_i32 s56, s56, 28
  s_lshr_b32 s57, s2, 3
  s_add_u32 s56, s56, s57
  s_cmp_ge_u32 s2, 224
  s_cselect_b32 s56, s2, s56
  s_lshr_b32 s57, s56, 4
  s_and_b32 s56, s56, 15
  s_mul_i32 s48, s56, 1568
  s_mul_i32 s49, s56, 56
  s_mul_i32 s50, s57, 86016
  s_add_u32 s49, s49, s50
  s_mul_i32 s74, s40, 114688
  s_mul_i32 s76, s42, 8
  s_mul_i32 s75, s42, 1
  s_mul_i32 s77, s42, 28672
  s_add_u32 s74, s74, s77
  s_lshl_b32 s77, s75, 7
  s_add_u32 s74, s74, s77
  s_lshl_b32 s76, s76, 12
  s_add_u32 s76, s76, 0xc000
  s_mul_i32 s93, s42, 28672
  s_add_u32 s93, s93, 0xc000
  s_lshl_b32 s50, s40, 4
  s_add_u32 s50, s50, s41
  s_lshl_b32 s50, s50, 2
  s_add_u32 s50, s50, s42
  s_mul_i32 s50, s50, 1792
  v_min_u32 v12, 13, v0
  v_lshlrev_b32 v12, 7, v12
  s_waitcnt lgkmcnt(0)
  s_mov_b32 s18, 0x6200
  s_mov_b32 s19, 0x00020000
  s_mov_b32 s14, 0x126000
  s_mov_b32 s15, 0x00020000
  s_mov_b32 s10, 0x1c0000
  s_mov_b32 s11, 0x00020000
  s_mov_b32 s22, 0x12e0000
  s_mov_b32 s23, 0x00020000
  s_mov_b32 s26, 0x1c0000
  s_mov_b32 s27, 0x00020000
  buffer_load_dword a139, v12, s[8:11], s50 offen nt
  s_lshl_b32 s50, s2, 2
  s_add_u32 s50, s50, s42
  s_lshl_b32 s50, s50, 8
  s_add_u32 s50, s50, 0x1000
  s_min_u32 s50, s50, 0x1af00
  v_and_b32 v12, 128, v12
  buffer_load_dword a140, v12, s[20:23], s50 offen
  buffer_load_dword a137, off, s[20:23], 0 offset:0 sc1
  s_cmp_lg_u32 s42, 3
  s_cbranch_scc1 L_now_1
  buffer_load_dwordx4 a[128:131], v41, s[16:19], s48 offen offset:0
  buffer_load_dwordx4 a[132:135], v41, s[16:19], s48 offen offset:32
  buffer_load_dwordx4 a[0:3], v40, s[12:15], s49 offen offset:896
  buffer_load_dwordx4 a[4:7], v40, s[12:15], s49 offen offset:928
  buffer_load_dwordx4 a[8:11], v40, s[12:15], s49 offen offset:1792
  buffer_load_dwordx4 a[12:15], v40, s[12:15], s49 offen offset:1824
  buffer_load_dwordx4 a[16:19], v40, s[12:15], s49 offen offset:0
  buffer_load_dwordx4 a[20:23], v40, s[12:15], s49 offen offset:32
L_now_1:
  s_cmp_ge_u32 s41, 7
  s_cselect_b32 s46, 1, 0
  s_mul_i32 s48, s46, 7
  s_sub_u32 s47, s41, s48
  s_mov_b32 s60, 0x3f80
  s_mov_b32 s61, 0x3f800000
  s_mov_b32 s62, 0x3f803f80
  s_mov_b32 s64, -1
  s_mov_b32 s65, 0
  s_mov_b32 s44, 0
  v_add_u32 v2, 65536, v1
  v_add_u32 v3, 131072, v1
  v_lshlrev_b32 v7, 2, v0
  v_lshlrev_b32 v4, 4, v9
  v_lshl_add_u32 v5, v10, 9, v4
  v_lshl_add_u32 v4, v10, 2, v4
  v_mul_u32_u24 v6, 896, v9
  v_lshl_add_u32 v6, v10, 4, v6
  v_add_u32 v43, -2, v9
  v_cmp_gt_u32 vcc, 26, v9
  s_nop 1
  v_cndmask_b32 v43, v43, v9, vcc
  v_and_b32 v13, 26, v9
  v_cmp_eq_u32 vcc, 26, v13
  s_nop 1
  v_cndmask_b32 v43, v43, 64, vcc
  v_mov_b32 v62, 0x3f80
  v_lshlrev_b32 v12, 3, v10
  v_sub_u32 v13, v43, v12
  v_and_b32 v60, 1, v13
  v_lshlrev_b32 v60, 4, v60
  v_lshlrev_b32 v60, v60, v62
  v_lshrrev_b32 v61, 1, v13
  v_cmp_eq_u32 s[48:49], 0, v61
  v_cmp_eq_u32 s[50:51], 1, v61
  v_cmp_eq_u32 s[52:53], 2, v61
  v_cmp_eq_u32 s[54:55], 3, v61
  v_cndmask_b32 v44, 0, v60, s[48:49]
  v_cndmask_b32 v45, 0, v60, s[50:51]
  v_cndmask_b32 v46, 0, v60, s[52:53]
  v_cndmask_b32 v47, 0, v60, s[54:55]
  v_cmp_eq_u32 s[48:49], 8, v61
  v_cmp_eq_u32 s[50:51], 9, v61
  v_cmp_eq_u32 s[52:53], 10, v61
  v_cmp_eq_u32 s[54:55], 11, v61
  v_cndmask_b32 v48, 0, v60, s[48:49]
  v_cndmask_b32 v49, 0, v60, s[50:51]
  v_cndmask_b32 v50, 0, v60, s[52:53]
  v_cndmask_b32 v51, 0, v60, s[54:55]
  s_nop 2
  s_cmp_eq_u32 s42, 3
  s_cbranch_scc1 L_setup_2
  s_add_u32 s54, s76, 16384
L_xl_3:
  s_mov_b32 m0, s76
  s_add_u32 s76, s76, 4096
  buffer_load_dwordx4 v244, s[8:11], s74 offen offset:0 lds
  s_add_u32 s77, s74, 6144
  buffer_load_dwordx4 v245, s[8:11], s77 offen offset:1024 lds
  s_add_u32 s77, s74, 12288
  buffer_load_dwordx4 v244, s[8:11], s77 offen offset:2048 lds
  s_add_u32 s77, s74, 18432
  buffer_load_dwordx4 v245, s[8:11], s77 offen offset:3072 lds
  s_add_u32 s75, s75, 1
  s_cmp_eq_u32 s75, 7
  s_cselect_b32 s77, 27776, 0
  s_cselect_b32 s75, 0, s75
  s_add_u32 s74, s74, 128
  s_add_u32 s74, s74, s77
  s_cmp_lt_u32 s76, s54
  s_cbranch_scc1 L_xl_3
L_setup_2:
  s_mul_i32 s78, s56, 89088
  s_lshl_b32 s48, s57, 11
  s_add_u32 s78, s78, s48
  s_add_u32 s78, s78, 0x40000
  s_mul_i32 s79, s56, 42
  s_add_u32 s79, s79, s57
  s_lshl_b32 s79, s79, 7
  s_add_u32 s79, s79, 0x27000
  s_cmp_ge_u32 s2, 224
  s_cselect_b32 s78, 0x7f000000, s78
  s_cselect_b32 s79, 0x7f000000, s79
  s_lshl_b32 s80, s57, 6
  s_lshl_b32 s81, s56, 10
  s_add_u32 s80, s80, s81
  s_add_u32 s80, s80, 0x17000
  s_lshl_b32 s81, s40, 10
  s_lshl_b32 s48, s41, 6
  s_add_u32 s81, s81, s48
  s_add_u32 s81, s81, 0xf000
  v_lshlrev_b32 v249, 2, v9
  s_nop 2
  s_mov_b64 s[16:17], s[38:39]
  s_mov_b32 s18, 0x188000
  s_cmp_lt_u32 s2, 224
  s_cbranch_scc1 L_shgu_4
  s_and_b32 s48, s2, 1
  s_mul_i32 s48, s48, 7
  s_lshl_b32 s49, s42, 1
  s_add_u32 s48, s48, s49
  s_mov_b32 s86, 0x7f000000
  s_mov_b32 s90, 0x7f000000
  s_mov_b32 s92, 0x7f000000
  s_mov_b32 s53, 108
  s_mov_b64 s[28:29], s[32:33]
  s_mov_b32 s30, 0x62000
  s_sub_u32 s49, s2, 224
  s_lshr_b32 s49, s49, 1
  s_mul_i32 s84, s49, 25088
  s_lshl_b32 s50, s48, 6
  s_add_u32 s84, s84, s50
  s_mul_i32 s88, s48, 32768
  s_lshl_b32 s49, s49, 11
  s_add_u32 s88, s88, s49
  s_add_u32 s88, s88, 0x19c000
  s_add_u32 s89, s88, 32768
  v_mul_u32_u24 v14, 896, v43
  v_add_u32 v14, v14, v42
  v_cmp_gt_u32 vcc, 64, v43
  v_mov_b32 v12, 0x7f000000
  s_nop 0
  v_cndmask_b32 v14, v12, v14, vcc
  s_add_u32 s85, s84, 64
  s_cmp_eq_u32 s42, 3
  s_cselect_b32 s85, 0x7f000000, s85
  s_cselect_b32 s89, 0x7f000000, s89
  s_branch L_shdone_6
L_shgu_4:
  s_bitcmp1_b32 s2, 2
  s_cselect_b64 s[28:29], s[36:37], s[34:35]
  s_cselect_b32 s51, 29696, 0
  s_mov_b32 s30, 0x188000
  s_mov_b32 s53, 0
  s_lshr_b32 s48, s2, 3
  s_and_b32 s49, s2, 3
  s_mul_i32 s50, s49, 7
  s_add_u32 s50, s50, 1
  s_lshr_b32 s50, s50, 1
  s_add_u32 s50, s50, s42
  s_mul_i32 s84, s50, 114688
  s_lshl_b32 s52, s48, 7
  s_add_u32 s84, s84, s52
  s_mul_i32 s92, s48, 118784
  s_add_u32 s92, s92, s51
  s_add_u32 s92, s92, 0x20c000
  s_lshl_b32 s50, s50, 11
  s_add_u32 s88, s92, s50
  s_add_u32 s85, s84, 64
  s_add_u32 s89, s88, 59392
  s_and_b32 s50, s2, 1
  s_add_u32 s50, s50, s42
  s_cmp_ge_u32 s50, 4
  s_cselect_b32 s84, 0x7f000000, s84
  s_cselect_b32 s88, 0x7f000000, s88
  s_cselect_b32 s85, 0x7f000000, s85
  s_cselect_b32 s89, 0x7f000000, s89
  s_mul_i32 s50, s42, 59392
  s_add_u32 s92, s92, s50
  s_lshl_b32 s50, s49, 7
  s_add_u32 s92, s92, s50
  s_add_u32 s92, s92, 28672
  s_cmp_ge_u32 s42, 2
  s_cselect_b32 s92, 0x7f000000, s92
  s_lshl_b32 s49, s49, 2
  s_add_u32 s49, s49, s42
  s_lshr_b32 s48, s2, 2
  s_mul_i32 s86, s48, 28672
  s_lshl_b32 s50, s49, 6
  s_add_u32 s86, s86, s50
  s_mul_i32 s90, s49, 114688
  s_lshl_b32 s48, s48, 11
  s_add_u32 s90, s90, s48
  s_add_u32 s90, s90, 0x538000
  s_cmp_ge_u32 s49, 14
  s_cselect_b32 s86, 0x7f000000, s86
  s_cselect_b32 s90, 0x7f000000, s90
  v_mul_u32_u24 v14, 3584, v11
  v_add_u32 v14, v14, v42
L_shdone_6:
  s_mov_b32 s31, 0x00020000
  v_mad_u32_u24 v247, v10, s53, v14
  s_lshl_b32 s48, s41, 2
  s_add_u32 s48, s48, s42
  s_mul_i32 s67, s48, 59392
  s_add_u32 s67, s67, 0x20c000
  s_lshr_b32 s49, s42, 1
  s_lshl_b32 s48, s47, 1
  s_add_u32 s48, s48, s49
  s_xor_b32 s49, s48, 1
  s_lshl_b32 s50, s42, 13
  s_add_u32 s50, s50, 0x19c000
  s_mul_i32 s51, s42, 28672
  s_add_u32 s51, s51, 0x538000
  s_lshl_b32 s66, s48, 15
  s_add_u32 s66, s66, s50
  s_mul_i32 s68, s48, 114688
  s_add_u32 s68, s68, s51
  s_lshl_b32 s82, s49, 15
  s_add_u32 s82, s82, s50
  s_mul_i32 s83, s49, 114688
  s_add_u32 s83, s83, s51
  s_cmp_ge_u32 s41, 14
  s_cselect_b32 s67, 0x7f000000, s67
  s_cselect_b32 s66, 0x7f000000, s66
  s_cselect_b32 s82, 0x7f000000, s82
  s_cselect_b32 s68, 0x7f000000, s68
  s_cselect_b32 s83, 0x7f000000, s83
  v_lshlrev_b32 v12, 3, v10
  v_sub_u32 v13, v9, v12
  v_and_b32 v60, 1, v13
  v_lshlrev_b32 v60, 4, v60
  v_lshlrev_b32 v60, v60, v62
  v_lshrrev_b32 v61, 1, v13
  v_cmp_eq_u32 s[48:49], 0, v61
  v_cmp_eq_u32 s[50:51], 1, v61
  v_cmp_eq_u32 s[52:53], 2, v61
  v_cmp_eq_u32 s[54:55], 3, v61
  v_cndmask_b32 v24, 0, v60, s[48:49]
  v_cndmask_b32 v25, 0, v60, s[50:51]
  v_cndmask_b32 v26, 0, v60, s[52:53]
  v_cndmask_b32 v27, 0, v60, s[54:55]
  v_cmp_eq_u32 s[48:49], 8, v61
  v_cmp_eq_u32 s[50:51], 9, v61
  v_cmp_eq_u32 s[52:53], 10, v61
  v_cmp_eq_u32 s[54:55], 11, v61
  v_cndmask_b32 v28, 0, v60, s[48:49]
  v_cndmask_b32 v29, 0, v60, s[50:51]
  v_cndmask_b32 v30, 0, v60, s[52:53]
  v_cndmask_b32 v31, 0, v60, s[54:55]
  v_lshlrev_b32 v12, 2, v10
  v_sub_u32 v13, v9, v12
  v_and_b32 v60, 1, v13
  v_lshlrev_b32 v60, 4, v60
  v_lshlrev_b32 v60, v60, v62
  v_lshrrev_b32 v61, 1, v13
  v_cmp_eq_u32 s[48:49], 0, v61
  v_cmp_eq_u32 s[50:51], 1, v61
  v_cmp_eq_u32 s[52:53], 4, v61
  v_cmp_eq_u32 s[54:55], 5, v61
  v_cndmask_b32 v32, 0, v60, s[48:49]
  v_cndmask_b32 v33, 0, v60, s[50:51]
  v_cndmask_b32 v34, 0, v60, s[52:53]
  v_cndmask_b32 v35, 0, v60, s[54:55]
  v_cmp_eq_u32 s[48:49], 8, v61
  v_cmp_eq_u32 s[50:51], 9, v61
  v_cmp_eq_u32 s[52:53], 12, v61
  v_cmp_eq_u32 s[54:55], 13, v61
  v_cndmask_b32 v36, 0, v60, s[48:49]
  v_cndmask_b32 v37, 0, v60, s[50:51]
  v_cndmask_b32 v38, 0, v60, s[52:53]
  v_cndmask_b32 v39, 0, v60, s[54:55]
  v_and_b32 v12, 59, v0
  v_cmp_eq_u32 vcc, 26, v12
  s_nop 1
  v_cndmask_b32 v63, 0, v62, vcc
  s_cmp_eq_u32 s42, 1
  s_cselect_b32 s48, -1, 0
  v_and_b32 v63, s48, v63
  v_lshrrev_b32 v12, 1, v9
  v_and_b32 v12, 7, v12
  v_xor_b32 v12, v12, v10
  v_lshlrev_b32 v12, 4, v12
  v_lshl_add_u32 v12, v9, 7, v12
  v_add_u32 v252, s93, v12
  v_xor_b32 v253, 32, v252
  v_xor_b32 v254, 64, v252
  v_xor_b32 v255, 96, v252
  v_lshlrev_b32 v13, 2, v9
  v_lshl_add_u32 v13, v10, 7, v13
  s_nop 2
  s_cmp_eq_u32 s42, 3
  s_cbranch_scc1 L_w3_8
  s_add_u32 s54, s76, 16384
L_xl_10:
  s_mov_b32 m0, s76
  s_add_u32 s76, s76, 4096
  buffer_load_dwordx4 v244, s[8:11], s74 offen offset:0 lds
  s_add_u32 s77, s74, 6144
  buffer_load_dwordx4 v245, s[8:11], s77 offen offset:1024 lds
  s_add_u32 s77, s74, 12288
  buffer_load_dwordx4 v244, s[8:11], s77 offen offset:2048 lds
  s_add_u32 s77, s74, 18432
  buffer_load_dwordx4 v245, s[8:11], s77 offen offset:3072 lds
  s_add_u32 s75, s75, 1
  s_cmp_eq_u32 s75, 7
  s_cselect_b32 s77, 27776, 0
  s_cselect_b32 s75, 0, s75
  s_add_u32 s74, s74, 128
  s_add_u32 s74, s74, s77
  s_cmp_lt_u32 s76, s54
  s_cbranch_scc1 L_xl_10
  s_waitcnt vmcnt(0)
  v_accvgpr_read_b32 v8, a137
  s_nop 0
  v_readfirstlane_b32 s43, v8
  s_nop 1
  s_add_u32 s43, s43, 16
  s_nop 1
  s_branch L_w3join_9
L_w3_8:
  s_waitcnt vmcnt(6)
  v_mfma_f32_32x32x16_bf16 v[64:79], a[128:131], v[44:47], 0
  v_mfma_f32_32x32x16_bf16 v[64:79], a[132:135], v[48:51], v[64:79]
  v_accvgpr_read_b32 v8, a137
  s_nop 0
  v_readfirstlane_b32 s43, v8
  s_waitcnt vmcnt(2)
  v_mfma_f32_32x32x16_bf16 v[96:111], a[8:11], v[44:47], 0
  v_mfma_f32_32x32x16_bf16 v[96:111], a[12:15], v[48:51], v[96:111]
  s_nop 6
  v_cvt_pk_bf16_f32 v52, v64, v65
  v_cvt_pk_bf16_f32 v53, v66, v67
  v_cvt_pk_bf16_f32 v54, v68, v69
  v_cvt_pk_bf16_f32 v55, v70, v71
  v_cvt_pk_bf16_f32 v56, v72, v73
  v_cvt_pk_bf16_f32 v57, v74, v75
  v_cvt_pk_bf16_f32 v58, v76, v77
  v_cvt_pk_bf16_f32 v59, v78, v79
  s_add_u32 s43, s43, 16
  v_mfma_f32_32x32x16_bf16 v[80:95], a[0:3], v[52:55], 0
  v_mfma_f32_32x32x16_bf16 v[80:95], a[4:7], v[56:59], v[80:95]
  s_waitcnt vmcnt(0)
  v_mfma_f32_32x32x16_bf16 v[112:127], a[16:19], v[52:55], 0
  v_mfma_f32_32x32x16_bf16 v[112:127], a[20:23], v[56:59], v[112:127]
  v_cvt_pk_bf16_f32 v136, v96, v97
  v_cvt_pk_bf16_f32 v137, v98, v99
  v_cvt_pk_bf16_f32 v138, v100, v101
  v_cvt_pk_bf16_f32 v139, v102, v103
  v_cvt_pk_bf16_f32 v140, v104, v105
  v_cvt_pk_bf16_f32 v141, v106, v107
  v_cvt_pk_bf16_f32 v142, v108, v109
  v_cvt_pk_bf16_f32 v143, v110, v111
  s_add_u32 s48, s78, 29696
  buffer_store_dwordx4 v[136:139], v1, s[20:23], s48 offen offset:0 sc1
  buffer_store_dwordx4 v[140:143], v1, s[20:23], s48 offen offset:1024 sc1
  v_cvt_pk_bf16_f32 v128, v80, v81
  v_cvt_pk_bf16_f32 v129, v82, v83
  v_cvt_pk_bf16_f32 v130, v84, v85
  v_cvt_pk_bf16_f32 v131, v86, v87
  v_cvt_pk_bf16_f32 v132, v88, v89
  v_cvt_pk_bf16_f32 v133, v90, v91
  v_cvt_pk_bf16_f32 v134, v92, v93
  v_cvt_pk_bf16_f32 v135, v94, v95
  s_add_u32 s48, s78, 0
  buffer_store_dwordx4 v[128:131], v1, s[20:23], s48 offen offset:0 sc1
  buffer_store_dwordx4 v[132:135], v1, s[20:23], s48 offen offset:1024 sc1
  v_cvt_pk_bf16_f32 v144, v112, v113
  v_cvt_pk_bf16_f32 v145, v114, v115
  v_cvt_pk_bf16_f32 v146, v116, v117
  v_cvt_pk_bf16_f32 v147, v118, v119
  v_cvt_pk_bf16_f32 v148, v120, v121
  v_cvt_pk_bf16_f32 v149, v122, v123
  v_cvt_pk_bf16_f32 v150, v124, v125
  v_cvt_pk_bf16_f32 v151, v126, v127
  s_add_u32 s48, s78, 59392
  buffer_store_dwordx4 v[144:147], v1, s[20:23], s48 offen offset:0 sc1
  buffer_store_dwordx4 v[148:151], v1, s[20:23], s48 offen offset:1024 sc1
  v_dot2_f32_bf16 v52, v128, s62, 0
  v_dot2_f32_bf16 v53, v136, s62, 0
  v_dot2_f32_bf16 v54, v144, s62, 0
  v_dot2_f32_bf16 v52, v129, s62, v52
  v_dot2_f32_bf16 v53, v137, s62, v53
  v_dot2_f32_bf16 v54, v145, s62, v54
  v_dot2_f32_bf16 v52, v130, s62, v52
  v_dot2_f32_bf16 v53, v138, s62, v53
  v_dot2_f32_bf16 v54, v146, s62, v54
  v_dot2_f32_bf16 v52, v131, s62, v52
  v_dot2_f32_bf16 v53, v139, s62, v53
  v_dot2_f32_bf16 v54, v147, s62, v54
  v_dot2_f32_bf16 v52, v132, s62, v52
  v_dot2_f32_bf16 v53, v140, s62, v53
  v_dot2_f32_bf16 v54, v148, s62, v54
  v_dot2_f32_bf16 v52, v133, s62, v52
  v_dot2_f32_bf16 v53, v141, s62, v53
  v_dot2_f32_bf16 v54, v149, s62, v54
  v_dot2_f32_bf16 v52, v134, s62, v52
  v_dot2_f32_bf16 v53, v142, s62, v53
  v_dot2_f32_bf16 v54, v150, s62, v54
  v_dot2_f32_bf16 v52, v135, s62, v52
  v_dot2_f32_bf16 v53, v143, s62, v53
  v_dot2_f32_bf16 v54, v151, s62, v54
  s_nop 0
  v_mov_b32 v56, v52
  v_mov_b32 v57, v53
  v_mov_b32 v58, v54
  v_permlane32_swap_b32 v52, v56
  v_permlane32_swap_b32 v53, v57
  v_permlane32_swap_b32 v54, v58
  v_add_f32 v52, v52, v56
  buffer_store_dword v52, v249, s[20:23], s79 offen offset:0 sc1
  v_add_f32 v53, v53, v57
  buffer_store_dword v53, v249, s[20:23], s79 offen offset:1792 sc1
  v_add_f32 v54, v54, v58
  buffer_store_dword v54, v249, s[20:23], s79 offen offset:3584 sc1
  v_mov_b32 v8, s43
  v_add_u32 v9, s45, v8
  s_waitcnt vmcnt(0)
  s_mov_b64 exec, 1
  buffer_store_dword v8, v7, s[20:23], s80 offen sc1
  buffer_store_dword v9, v7, s[20:23], s81 offen sc1
  s_mov_b64 exec, -1
  s_add_u32 s54, s76, 16384
L_xl_11:
  s_mov_b32 m0, s76
  s_add_u32 s76, s76, 4096
  buffer_load_dwordx4 v244, s[8:11], s74 offen offset:0 lds
  s_add_u32 s77, s74, 6144
  buffer_load_dwordx4 v245, s[8:11], s77 offen offset:1024 lds
  s_add_u32 s77, s74, 12288
  buffer_load_dwordx4 v244, s[8:11], s77 offen offset:2048 lds
  s_add_u32 s77, s74, 18432
  buffer_load_dwordx4 v245, s[8:11], s77 offen offset:3072 lds
  s_add_u32 s75, s75, 1
  s_cmp_eq_u32 s75, 7
  s_cselect_b32 s77, 27776, 0
  s_cselect_b32 s75, 0, s75
  s_add_u32 s74, s74, 128
  s_add_u32 s74, s74, s77
  s_cmp_lt_u32 s76, s54
  s_cbranch_scc1 L_xl_11
  s_waitcnt vmcnt(0)
L_w3join_9:
  v_min_u32 v11, 13, v0
  v_lshlrev_b32 v11, 6, v11
  s_lshl_b32 s48, s41, 10
  s_add_u32 s48, s48, 0x17000
  v_add_u32 v11, s48, v11
  s_lshr_b32 s48, s42, 1
  s_mul_i32 s48, s48, 29696
  s_and_b32 s49, s42, 1
  s_lshl_b32 s50, s49, 12
  s_add_u32 s93, s48, s50
  s_lshl_b32 s50, s49, 11
  s_add_u32 s78, s48, s50
  s_mul_i32 s69, s41, 89088
  s_add_u32 s69, s69, 0x40000
  s_mul_i32 s79, s42, 7168
  s_add_u32 s79, s79, 59392
  s_min_u32 s48, s42, 2
  s_mul_i32 s80, s41, 3
  s_add_u32 s80, s80, s48
  s_mul_i32 s80, s80, 1792
  s_add_u32 s80, s80, 0x27000
  s_mul_i32 s81, s48, 29696
  s_add_u32 s81, s81, 28672
  s_barrier
  buffer_load_dword v10, v11, s[20:23], 0 offen sc1
  ds_read_b128 v[128:131], v252 offset:0
  ds_read_b128 v[132:135], v253 offset:0
  ds_read_b128 v[136:139], v254 offset:0
  ds_read_b128 v[140:143], v255 offset:0
  ds_read_b128 v[144:147], v252 offset:4096
  ds_read_b128 v[148:151], v253 offset:4096
  ds_read_b128 v[152:155], v254 offset:4096
  ds_read_b128 v[156:159], v255 offset:4096
  ds_read_b128 v[160:163], v252 offset:8192
  ds_read_b128 v[164:167], v253 offset:8192
  ds_read_b128 v[168:171], v254 offset:8192
  ds_read_b128 v[172:175], v255 offset:8192
  ds_read_b128 v[176:179], v252 offset:12288
  ds_read_b128 v[180:183], v253 offset:12288
  ds_read_b128 v[184:187], v254 offset:12288
  ds_read_b128 v[188:191], v255 offset:12288
  ds_read_b128 v[192:195], v252 offset:16384
  ds_read_b128 v[196:199], v253 offset:16384
  ds_read_b128 v[200:203], v254 offset:16384
  ds_read_b128 v[204:207], v255 offset:16384
  ds_read_b128 v[208:211], v252 offset:20480
  ds_read_b128 v[212:215], v253 offset:20480
  ds_read_b128 v[216:219], v254 offset:20480
  ds_read_b128 v[220:223], v255 offset:20480
  ds_read_b128 v[224:227], v252 offset:24576
  ds_read_b128 v[228:231], v253 offset:24576
  ds_read_b128 v[232:235], v254 offset:24576
  ds_read_b128 v[236:239], v255 offset:24576
  s_waitcnt lgkmcnt(15)
  v_dot2_f32_bf16 v250, v128, s62, 0
  v_dot2_f32_bf16 v251, v128, v128, 0
  v_dot2_f32_bf16 v52, v129, s62, 0
  v_dot2_f32_bf16 v53, v129, v129, 0
  v_dot2_f32_bf16 v250, v130, s62, v250
  v_dot2_f32_bf16 v251, v130, v130, v251
  v_dot2_f32_bf16 v52, v131, s62, v52
  v_dot2_f32_bf16 v53, v131, v131, v53
  v_dot2_f32_bf16 v250, v132, s62, v250
  v_dot2_f32_bf16 v251, v132, v132, v251
  v_dot2_f32_bf16 v52, v133, s62, v52
  v_dot2_f32_bf16 v53, v133, v133, v53
  v_dot2_f32_bf16 v250, v134, s62, v250
  v_dot2_f32_bf16 v251, v134, v134, v251
  v_dot2_f32_bf16 v52, v135, s62, v52
  v_dot2_f32_bf16 v53, v135, v135, v53
  v_dot2_f32_bf16 v250, v136, s62, v250
  v_dot2_f32_bf16 v251, v136, v136, v251
  v_dot2_f32_bf16 v52, v137, s62, v52
  v_dot2_f32_bf16 v53, v137, v137, v53
  v_dot2_f32_bf16 v250, v138, s62, v250
  v_dot2_f32_bf16 v251, v138, v138, v251
  v_dot2_f32_bf16 v52, v139, s62, v52
  v_dot2_f32_bf16 v53, v139, v139, v53
  v_dot2_f32_bf16 v250, v140, s62, v250
  v_dot2_f32_bf16 v251, v140, v140, v251
  v_dot2_f32_bf16 v52, v141, s62, v52
  v_dot2_f32_bf16 v53, v141, v141, v53
  v_dot2_f32_bf16 v250, v142, s62, v250
  v_dot2_f32_bf16 v251, v142, v142, v251
  v_dot2_f32_bf16 v52, v143, s62, v52
  v_dot2_f32_bf16 v53, v143, v143, v53
  v_dot2_f32_bf16 v250, v144, s62, v250
  v_dot2_f32_bf16 v251, v144, v144, v251
  v_dot2_f32_bf16 v52, v145, s62, v52
  v_dot2_f32_bf16 v53, v145, v145, v53
  v_dot2_f32_bf16 v250, v146, s62, v250
  v_dot2_f32_bf16 v251, v146, v146, v251
  v_dot2_f32_bf16 v52, v147, s62, v52
  v_dot2_f32_bf16 v53, v147, v147, v53
  v_dot2_f32_bf16 v250, v148, s62, v250
  v_dot2_f32_bf16 v251, v148, v148, v251
  v_dot2_f32_bf16 v52, v149, s62, v52
  v_dot2_f32_bf16 v53, v149, v149, v53
  v_dot2_f32_bf16 v250, v150, s62, v250
  v_dot2_f32_bf16 v251, v150, v150, v251
  v_dot2_f32_bf16 v52, v151, s62, v52
  v_dot2_f32_bf16 v53, v151, v151, v53
  s_waitcnt vmcnt(0)
  s_mov_b32 s63, 0
L_shpoll_12:
  v_cmp_ne_u32 vcc, s43, v10
  s_add_u32 s63, s63, 1
  s_nop 1
  s_cbranch_vccz L_shdone_13
  buffer_load_dword v10, v11, s[20:23], 0 offen sc1
  s_waitcnt vmcnt(0)
  s_cmp_lt_u32 s63, 262144
  s_cbranch_scc1 L_shpoll_12
L_shdone_13:
  s_add_u32 m0, s93, 0
  s_add_u32 s74, m0, s69
  buffer_load_dwordx4 v1, s[20:23], s74 offen offset:0 sc1 lds
  v_dot2_f32_bf16 v250, v152, s62, v250
  v_dot2_f32_bf16 v251, v152, v152, v251
  v_dot2_f32_bf16 v52, v153, s62, v52
  v_dot2_f32_bf16 v53, v153, v153, v53
  v_dot2_f32_bf16 v250, v154, s62, v250
  v_dot2_f32_bf16 v251, v154, v154, v251
  v_dot2_f32_bf16 v52, v155, s62, v52
  v_dot2_f32_bf16 v53, v155, v155, v53
  v_dot2_f32_bf16 v250, v156, s62, v250
  v_dot2_f32_bf16 v251, v156, v156, v251
  v_dot2_f32_bf16 v52, v157, s62, v52
  buffer_load_dwordx4 v1, s[20:23], s74 offen offset:1024 sc1 lds
  v_dot2_f32_bf16 v53, v157, v157, v53
  v_dot2_f32_bf16 v250, v158, s62, v250
  v_dot2_f32_bf16 v251, v158, v158, v251
  v_dot2_f32_bf16 v52, v159, s62, v52
  v_dot2_f32_bf16 v53, v159, v159, v53
  v_dot2_f32_bf16 v250, v160, s62, v250
  v_dot2_f32_bf16 v251, v160, v160, v251
  v_dot2_f32_bf16 v52, v161, s62, v52
  v_dot2_f32_bf16 v53, v161, v161, v53
  v_dot2_f32_bf16 v250, v162, s62, v250
  v_dot2_f32_bf16 v251, v162, v162, v251
  buffer_load_dwordx4 v1, s[20:23], s74 offen offset:2048 sc1 lds
  v_dot2_f32_bf16 v52, v163, s62, v52
  v_dot2_f32_bf16 v53, v163, v163, v53
  v_dot2_f32_bf16 v250, v164, s62, v250
  v_dot2_f32_bf16 v251, v164, v164, v251
  v_dot2_f32_bf16 v52, v165, s62, v52
  v_dot2_f32_bf16 v53, v165, v165, v53
  v_dot2_f32_bf16 v250, v166, s62, v250
  v_dot2_f32_bf16 v251, v166, v166, v251
  v_dot2_f32_bf16 v52, v167, s62, v52
  v_dot2_f32_bf16 v53, v167, v167, v53
  v_dot2_f32_bf16 v250, v168, s62, v250
  buffer_load_dwordx4 v1, s[20:23], s74 offen offset:3072 sc1 lds
  v_dot2_f32_bf16 v251, v168, v168, v251
  v_dot2_f32_bf16 v52, v169, s62, v52
  v_dot2_f32_bf16 v53, v169, v169, v53
  v_dot2_f32_bf16 v250, v170, s62, v250
  v_dot2_f32_bf16 v251, v170, v170, v251
  v_dot2_f32_bf16 v52, v171, s62, v52
  v_dot2_f32_bf16 v53, v171, v171, v53
  v_dot2_f32_bf16 v250, v172, s62, v250
  v_dot2_f32_bf16 v251, v172, v172, v251
  v_dot2_f32_bf16 v52, v173, s62, v52
  v_dot2_f32_bf16 v53, v173, v173, v53
  s_add_u32 m0, s93, 8192
  s_add_u32 s75, m0, s69
  buffer_load_dwordx4 v1, s[20:23], s75 offen offset:0 sc1 lds
  v_dot2_f32_bf16 v250, v174, s62, v250
  v_dot2_f32_bf16 v251, v174, v174, v251
  v_dot2_f32_bf16 v52, v175, s62, v52
  v_dot2_f32_bf16 v53, v175, v175, v53
  v_dot2_f32_bf16 v250, v176, s62, v250
  v_dot2_f32_bf16 v251, v176, v176, v251
  v_dot2_f32_bf16 v52, v177, s62, v52
  v_dot2_f32_bf16 v53, v177, v177, v53
  v_dot2_f32_bf16 v250, v178, s62, v250
  v_dot2_f32_bf16 v251, v178, v178, v251
  v_dot2_f32_bf16 v52, v179, s62, v52
  buffer_load_dwordx4 v1, s[20:23], s75 offen offset:1024 sc1 lds
  v_dot2_f32_bf16 v53, v179, v179, v53
  s_waitcnt lgkmcnt(14)
  v_dot2_f32_bf16 v250, v180, s62, v250
  v_dot2_f32_bf16 v251, v180, v180, v251
  v_dot2_f32_bf16 v52, v181, s62, v52
  v_dot2_f32_bf16 v53, v181, v181, v53
  v_dot2_f32_bf16 v250, v182, s62, v250
  v_dot2_f32_bf16 v251, v182, v182, v251
  v_dot2_f32_bf16 v52, v183, s62, v52
  v_dot2_f32_bf16 v53, v183, v183, v53
  s_waitcnt lgkmcnt(13)
  v_dot2_f32_bf16 v250, v184, s62, v250
  v_dot2_f32_bf16 v251, v184, v184, v251
  buffer_load_dwordx4 v1, s[20:23], s75 offen offset:2048 sc1 lds
  v_dot2_f32_bf16 v52, v185, s62, v52
  v_dot2_f32_bf16 v53, v185, v185, v53
  v_dot2_f32_bf16 v250, v186, s62, v250
  v_dot2_f32_bf16 v251, v186, v186, v251
  v_dot2_f32_bf16 v52, v187, s62, v52
  v_dot2_f32_bf16 v53, v187, v187, v53
  s_waitcnt lgkmcnt(12)
  v_dot2_f32_bf16 v250, v188, s62, v250
  v_dot2_f32_bf16 v251, v188, v188, v251
  v_dot2_f32_bf16 v52, v189, s62, v52
  v_dot2_f32_bf16 v53, v189, v189, v53
  v_dot2_f32_bf16 v250, v190, s62, v250
  buffer_load_dwordx4 v1, s[20:23], s75 offen offset:3072 sc1 lds
  v_dot2_f32_bf16 v251, v190, v190, v251
  v_dot2_f32_bf16 v52, v191, s62, v52
  v_dot2_f32_bf16 v53, v191, v191, v53
  s_waitcnt lgkmcnt(11)
  v_dot2_f32_bf16 v250, v192, s62, v250
  v_dot2_f32_bf16 v251, v192, v192, v251
  v_dot2_f32_bf16 v52, v193, s62, v52
  v_dot2_f32_bf16 v53, v193, v193, v53
  v_dot2_f32_bf16 v250, v194, s62, v250
  v_dot2_f32_bf16 v251, v194, v194, v251
  v_dot2_f32_bf16 v52, v195, s62, v52
  v_dot2_f32_bf16 v53, v195, v195, v53
  s_waitcnt lgkmcnt(10)
  v_dot2_f32_bf16 v250, v196, s62, v250
  v_dot2_f32_bf16 v251, v196, v196, v251
  v_dot2_f32_bf16 v52, v197, s62, v52
  v_dot2_f32_bf16 v53, v197, v197, v53
  v_dot2_f32_bf16 v250, v198, s62, v250
  v_dot2_f32_bf16 v251, v198, v198, v251
  v_dot2_f32_bf16 v52, v199, s62, v52
  v_dot2_f32_bf16 v53, v199, v199, v53
  s_waitcnt lgkmcnt(9)
  v_dot2_f32_bf16 v250, v200, s62, v250
  v_dot2_f32_bf16 v251, v200, v200, v251
  v_dot2_f32_bf16 v52, v201, s62, v52
  v_dot2_f32_bf16 v53, v201, v201, v53
  v_dot2_f32_bf16 v250, v202, s62, v250
  v_dot2_f32_bf16 v251, v202, v202, v251
  v_dot2_f32_bf16 v52, v203, s62, v52
  v_dot2_f32_bf16 v53, v203, v203, v53
  s_waitcnt lgkmcnt(0)
  s_barrier
  ds_write_b128 v2, v[32:35] offset:23552
  s_add_u32 m0, s93, 16384
  s_add_u32 s76, m0, s69
  buffer_load_dwordx4 v1, s[20:23], s76 offen offset:0 sc1 lds
  ds_write_b128 v2, v[36:39] offset:24576
  v_dot2_f32_bf16 v250, v204, s62, v250
  v_dot2_f32_bf16 v251, v204, v204, v251
  v_dot2_f32_bf16 v52, v205, s62, v52
  v_dot2_f32_bf16 v53, v205, v205, v53
  v_dot2_f32_bf16 v250, v206, s62, v250
  v_dot2_f32_bf16 v251, v206, v206, v251
  v_dot2_f32_bf16 v52, v207, s62, v52
  v_dot2_f32_bf16 v53, v207, v207, v53
  v_dot2_f32_bf16 v250, v208, s62, v250
  v_dot2_f32_bf16 v251, v208, v208, v251
  v_dot2_f32_bf16 v52, v209, s62, v52
  v_dot2_f32_bf16 v53, v209, v209, v53
  v_dot2_f32_bf16 v250, v210, s62, v250
  buffer_load_dwordx4 v1, s[20:23], s76 offen offset:1024 sc1 lds
  v_dot2_f32_bf16 v251, v210, v210, v251
  v_dot2_f32_bf16 v52, v211, s62, v52
  v_dot2_f32_bf16 v53, v211, v211, v53
  v_dot2_f32_bf16 v250, v212, s62, v250
  v_dot2_f32_bf16 v251, v212, v212, v251
  v_dot2_f32_bf16 v52, v213, s62, v52
  v_dot2_f32_bf16 v53, v213, v213, v53
  v_dot2_f32_bf16 v250, v214, s62, v250
  v_dot2_f32_bf16 v251, v214, v214, v251
  v_dot2_f32_bf16 v52, v215, s62, v52
  v_dot2_f32_bf16 v53, v215, v215, v53
  v_dot2_f32_bf16 v250, v216, s62, v250
  v_dot2_f32_bf16 v251, v216, v216, v251
  v_dot2_f32_bf16 v52, v217, s62, v52
  buffer_load_dwordx4 v1, s[20:23], s76 offen offset:2048 sc1 lds
  v_dot2_f32_bf16 v53, v217, v217, v53
  v_dot2_f32_bf16 v250, v218, s62, v250
  v_dot2_f32_bf16 v251, v218, v218, v251
  v_dot2_f32_bf16 v52, v219, s62, v52
  v_dot2_f32_bf16 v53, v219, v219, v53
  v_dot2_f32_bf16 v250, v220, s62, v250
  v_dot2_f32_bf16 v251, v220, v220, v251
  v_dot2_f32_bf16 v52, v221, s62, v52
  v_dot2_f32_bf16 v53, v221, v221, v53
  v_dot2_f32_bf16 v250, v222, s62, v250
  v_dot2_f32_bf16 v251, v222, v222, v251
  v_dot2_f32_bf16 v52, v223, s62, v52
  v_dot2_f32_bf16 v53, v223, v223, v53
  v_dot2_f32_bf16 v250, v224, s62, v250
  buffer_load_dwordx4 v1, s[20:23], s76 offen offset:3072 sc1 lds
  v_dot2_f32_bf16 v251, v224, v224, v251
  v_dot2_f32_bf16 v52, v225, s62, v52
  v_dot2_f32_bf16 v53, v225, v225, v53
  v_dot2_f32_bf16 v250, v226, s62, v250
  v_dot2_f32_bf16 v251, v226, v226, v251
  v_dot2_f32_bf16 v52, v227, s62, v52
  v_dot2_f32_bf16 v53, v227, v227, v53
  v_dot2_f32_bf16 v250, v228, s62, v250
  v_dot2_f32_bf16 v251, v228, v228, v251
  v_dot2_f32_bf16 v52, v229, s62, v52
  v_dot2_f32_bf16 v53, v229, v229, v53
  v_dot2_f32_bf16 v250, v230, s62, v250
  v_dot2_f32_bf16 v251, v230, v230, v251
  v_dot2_f32_bf16 v52, v231, s62, v52
  s_add_u32 m0, s78, 24576
  s_add_u32 s77, m0, s69
  buffer_load_dwordx4 v1, s[20:23], s77 offen offset:0 sc1 lds
  v_dot2_f32_bf16 v53, v231, v231, v53
  v_dot2_f32_bf16 v250, v232, s62, v250
  v_dot2_f32_bf16 v251, v232, v232, v251
  v_dot2_f32_bf16 v52, v233, s62, v52
  v_dot2_f32_bf16 v53, v233, v233, v53
  v_dot2_f32_bf16 v250, v234, s62, v250
  v_dot2_f32_bf16 v251, v234, v234, v251
  v_dot2_f32_bf16 v52, v235, s62, v52
  v_dot2_f32_bf16 v53, v235, v235, v53
  v_dot2_f32_bf16 v250, v236, s62, v250
  v_dot2_f32_bf16 v251, v236, v236, v251
  v_dot2_f32_bf16 v52, v237, s62, v52
  v_dot2_f32_bf16 v53, v237, v237, v53
  v_dot2_f32_bf16 v250, v238, s62, v250
  buffer_load_dwordx4 v1, s[20:23], s77 offen offset:1024 sc1 lds
  v_dot2_f32_bf16 v251, v238, v238, v251
  v_dot2_f32_bf16 v52, v239, s62, v52
  v_dot2_f32_bf16 v53, v239, v239, v53
  s_nop 2
  v_pk_add_f32 v[250:251], v[250:251], v[52:53]
  s_nop 1
  v_permlane32_swap_b32 v250, v251
  v_add_f32 v250, v250, v251
  v_mov_b32 v251, v250
  s_nop 1
  v_permlane32_swap_b32 v250, v251
  v_mul_f32 v250, 0x3b124925, v250
  v_mul_f32 v251, 0x3b124925, v251
  v_fma_f32 v251, -v250, v250, v251
  v_max_f32 v251, 0, v251
  v_cvt_pk_bf16_f32 v240, -v250, -v250
  v_cvt_pk_bf16_f32 v244, v251, v251
  v_and_b32 v244, 0xffff0000, v244
  v_add_f32 v244, 0x3727c5ac, v244
  v_cvt_pk_bf16_f32 v244, v244, v244
  v_and_b32 v244, 0xffff0000, v244
  v_sqrt_f32 v244, v244
  s_nop 0
  v_cvt_pk_bf16_f32 v244, v244, v244
  v_and_b32 v243, 0xffff0000, v244
  v_lshrrev_b32 v241, 16, v244
  v_rcp_f32 v242, v243
  s_nop 0
  v_mov_b32 v246, v242
  v_mul_f32 v248, 0x3fb8aa3b, v242
  v_mov_b32 v242, 0
  v_mov_b32 v243, 0
  s_lshl_b32 s34, s40, 2
  s_add_u32 s34, s34, s46
  s_lshl_b32 s56, s47, 2
  s_add_u32 s56, s56, s42
  s_mul_i32 s39, s40, 589824
  s_mul_i32 s32, s46, 28672
  s_add_u32 s32, s32, s39
  s_lshl_b32 s57, s56, 10
  s_add_u32 s32, s32, s57
  s_mul_i32 s33, s34, 7168
  s_lshr_b32 s57, s56, 1
  s_lshl_b32 s57, s57, 9
  s_add_u32 s33, s33, s57
  s_and_b32 s57, s42, 1
  s_lshl_b32 s58, s57, 3
  s_add_u32 s33, s33, s58
  s_lshl_b32 s35, s57, 8
  s_and_b32 s38, s40, 0
  s_mul_i32 s38, s38, 14336
  s_add_u32 s36, s67, s38
  s_sub_u32 s37, s67, s38
  s_waitcnt vmcnt(10) lgkmcnt(0)
  s_barrier
  ds_read_b128 v[96:99], v1 offset:0
  ds_read_b128 v[100:103], v1 offset:29696
  ds_read_b128 v[104:107], v1 offset:1024
  ds_read_b128 v[108:111], v1 offset:30720
  ds_read_b128 v[112:115], v1 offset:2048
  ds_read_b128 v[116:119], v1 offset:31744
  s_waitcnt lgkmcnt(4)
  v_mfma_f32_32x32x16_bf16 v[64:79], v[96:99], v[128:131], 0
  buffer_load_dword v56, v13, s[20:23], s80 offen offset:0 sc1
  v_mfma_f32_32x32x16_bf16 v[80:95], v[128:131], v[100:103], 0
  ds_read_b128 v[120:123], v1 offset:3072
  ds_read_b128 v[124:127], v1 offset:32768
  s_waitcnt lgkmcnt(4)
  v_mfma_f32_32x32x16_bf16 v[64:79], v[104:107], v[132:135], v[64:79]
  buffer_load_dword v57, v13, s[20:23], s80 offen offset:256 sc1
  v_mfma_f32_32x32x16_bf16 v[80:95], v[132:135], v[108:111], v[80:95]
  v_min_u32 v10, 5, v0
  v_lshlrev_b32 v10, 11, v10
  s_lshl_b32 s56, s40, 7
  s_add_u32 s56, s56, 0x1000
  buffer_load_dword a253, v10, s[20:23], s56 offen
  ds_read_b128 v[96:99], v1 offset:4096
  ds_read_b128 v[100:103], v1 offset:33792
  s_waitcnt lgkmcnt(4)
  v_mfma_f32_32x32x16_bf16 v[64:79], v[112:115], v[136:139], v[64:79]
  buffer_load_dword v58, v13, s[20:23], s80 offen offset:512 sc1
  v_mfma_f32_32x32x16_bf16 v[80:95], v[136:139], v[116:119], v[80:95]
  v_and_b32 v10, 15, v0
  v_lshlrev_b32 v10, 7, v10
  s_lshl_b32 s56, s42, 15
  s_add_u32 s56, s56, s39
  s_lshl_b32 s57, s41, 11
  s_add_u32 s56, s56, s57
  s_add_u32 s56, s56, 0x7dc000
  v_bfe_u32 v11, v0, 3, 1
  v_and_b32 v10, 896, v10
  v_mul_u32_u24 v12, 57344, v11
  v_add_u32 v12, v12, v10
  v_and_b32 v10, 384, v10
  v_mul_u32_u24 v11, 14336, v11
  v_add_u32 v11, v11, v10
  s_add_u32 s56, s32, 0x818000
  s_add_u32 s57, s33, 0x10c0000
  s_cmp_ge_u32 s41, 14
  s_cselect_b32 s56, 0x7f000000, s56
  s_cselect_b32 s57, 0x7f000000, s57
  buffer_load_dword a251, v12, s[20:23], s56 offen
  ds_read_b128 v[104:107], v1 offset:5120
  ds_read_b128 v[108:111], v1 offset:34816
  s_waitcnt lgkmcnt(4)
  v_mfma_f32_32x32x16_bf16 v[64:79], v[120:123], v[140:143], v[64:79]
  buffer_load_dword v59, v13, s[20:23], s80 offen offset:768 sc1
  v_mfma_f32_32x32x16_bf16 v[80:95], v[140:143], v[124:127], v[80:95]
  buffer_load_dword a252, v11, s[20:23], s57 offen
  ds_read_b128 v[112:115], v1 offset:6144
  ds_read_b128 v[116:119], v1 offset:35840
  s_waitcnt lgkmcnt(4)
  v_mfma_f32_32x32x16_bf16 v[64:79], v[96:99], v[144:147], v[64:79]
  buffer_load_dword v60, v13, s[20:23], s80 offen offset:1024 sc1
  v_mfma_f32_32x32x16_bf16 v[80:95], v[144:147], v[100:103], v[80:95]
  s_waitcnt vmcnt(14)
  s_barrier
  ds_read_b128 v[120:123], v1 offset:7168
  ds_read_b128 v[124:127], v1 offset:36864
  s_waitcnt lgkmcnt(4)
  v_mfma_f32_32x32x16_bf16 v[64:79], v[104:107], v[148:151], v[64:79]
  buffer_load_dword v61, v13, s[20:23], s80 offen offset:1280 sc1
  v_mfma_f32_32x32x16_bf16 v[80:95], v[148:151], v[108:111], v[80:95]
  s_mul_i32 s56, s34, 28672
  s_lshl_b32 s57, s47, 2
  s_add_u32 s57, s57, s42
  s_lshl_b32 s57, s57, 5
  s_add_u32 s56, s56, s57
  s_add_u32 s57, s56, 57344
  v_lshrrev_b32 v12, 5, v0
  v_lshlrev_b32 v12, 3, v12
  v_sub_u32 v12, v6, v12
  buffer_load_dwordx2 v[16:17], v12, s[8:11], s56 offen offset:0
  ds_read_b128 v[96:99], v1 offset:8192
  ds_read_b128 v[100:103], v1 offset:37888
  s_waitcnt lgkmcnt(4)
  v_mfma_f32_32x32x16_bf16 v[64:79], v[112:115], v[152:155], v[64:79]
  buffer_load_dword v62, v13, s[20:23], s80 offen offset:1536 sc1
  v_mfma_f32_32x32x16_bf16 v[80:95], v[152:155], v[116:119], v[80:95]
  buffer_load_dwordx2 v[18:19], v12, s[8:11], s56 offen offset:16
  ds_read_b128 v[104:107], v1 offset:9216
  ds_read_b128 v[108:111], v1 offset:38912
  s_waitcnt lgkmcnt(4)
  v_mfma_f32_32x32x16_bf16 v[64:79], v[120:123], v[156:159], v[64:79]
  v_mfma_f32_32x32x16_bf16 v[80:95], v[156:159], v[124:127], v[80:95]
  buffer_load_dwordx2 v[20:21], v12, s[8:11], s57 offen offset:0
  ds_read_b128 v[112:115], v1 offset:10240
  ds_read_b128 v[116:119], v1 offset:39936
  s_waitcnt lgkmcnt(4)
  v_mfma_f32_32x32x16_bf16 v[64:79], v[96:99], v[160:163], v[64:79]
  v_mfma_f32_32x32x16_bf16 v[80:95], v[160:163], v[100:103], v[80:95]
  buffer_load_dwordx2 v[22:23], v12, s[8:11], s57 offen offset:16
  ds_read_b128 v[120:123], v1 offset:11264
  ds_read_b128 v[124:127], v1 offset:40960
  s_waitcnt lgkmcnt(4)
  v_mfma_f32_32x32x16_bf16 v[64:79], v[104:107], v[164:167], v[64:79]
  v_mfma_f32_32x32x16_bf16 v[80:95], v[164:167], v[108:111], v[80:95]
  ds_read_b128 v[96:99], v1 offset:12288
  ds_read_b128 v[100:103], v1 offset:41984
  s_waitcnt lgkmcnt(4)
  v_mfma_f32_32x32x16_bf16 v[64:79], v[112:115], v[168:171], v[64:79]
  v_mfma_f32_32x32x16_bf16 v[80:95], v[168:171], v[116:119], v[80:95]
  ds_read_b128 v[104:107], v1 offset:13312
  ds_read_b128 v[108:111], v1 offset:43008
  s_waitcnt lgkmcnt(4)
  v_mfma_f32_32x32x16_bf16 v[64:79], v[120:123], v[172:175], v[64:79]
  v_mfma_f32_32x32x16_bf16 v[80:95], v[172:175], v[124:127], v[80:95]
  ds_read_b128 v[112:115], v1 offset:14336
  ds_read_b128 v[116:119], v1 offset:44032
  s_waitcnt lgkmcnt(4)
  v_mfma_f32_32x32x16_bf16 v[64:79], v[96:99], v[176:179], v[64:79]
  v_mfma_f32_32x32x16_bf16 v[80:95], v[176:179], v[100:103], v[80:95]
  s_waitcnt vmcnt(16)
  s_barrier
  ds_read_b128 v[120:123], v1 offset:15360
  ds_read_b128 v[124:127], v1 offset:45056
  s_waitcnt lgkmcnt(4)
  v_mfma_f32_32x32x16_bf16 v[64:79], v[104:107], v[180:183], v[64:79]
  v_mfma_f32_32x32x16_bf16 v[80:95], v[180:183], v[108:111], v[80:95]
  ds_read_b128 v[96:99], v1 offset:16384
  ds_read_b128 v[100:103], v1 offset:46080
  s_waitcnt lgkmcnt(4)
  v_mfma_f32_32x32x16_bf16 v[64:79], v[112:115], v[184:187], v[64:79]
  s_add_u32 m0, s79, 0
  s_add_u32 s74, m0, s69
  buffer_load_dwordx4 v1, s[20:23], s74 offen offset:0 sc1 lds
  v_mfma_f32_32x32x16_bf16 v[80:95], v[184:187], v[116:119], v[80:95]
  ds_read_b128 v[104:107], v1 offset:17408
  ds_read_b128 v[108:111], v1 offset:47104
  s_waitcnt lgkmcnt(4)
  v_mfma_f32_32x32x16_bf16 v[64:79], v[120:123], v[188:191], v[64:79]
  buffer_load_dwordx4 v1, s[20:23], s74 offen offset:1024 sc1 lds
  v_mfma_f32_32x32x16_bf16 v[80:95], v[188:191], v[124:127], v[80:95]
  ds_read_b128 v[112:115], v1 offset:18432
  ds_read_b128 v[116:119], v1 offset:48128
  s_waitcnt lgkmcnt(4)
  v_mfma_f32_32x32x16_bf16 v[64:79], v[96:99], v[192:195], v[64:79]
  buffer_load_dwordx4 v1, s[20:23], s74 offen offset:2048 sc1 lds
  v_mfma_f32_32x32x16_bf16 v[80:95], v[192:195], v[100:103], v[80:95]
  ds_read_b128 v[120:123], v1 offset:19456
  ds_read_b128 v[124:127], v1 offset:49152
  s_waitcnt lgkmcnt(4)
  v_mfma_f32_32x32x16_bf16 v[64:79], v[104:107], v[196:199], v[64:79]
  buffer_load_dwordx4 v1, s[20:23], s74 offen offset:3072 sc1 lds
  v_mfma_f32_32x32x16_bf16 v[80:95], v[196:199], v[108:111], v[80:95]
  ds_read_b128 v[96:99], v1 offset:20480
  ds_read_b128 v[100:103], v1 offset:50176
  s_waitcnt lgkmcnt(4)
  v_mfma_f32_32x32x16_bf16 v[64:79], v[112:115], v[200:203], v[64:79]
  s_add_u32 m0, s79, 4096
  s_add_u32 s75, m0, s69
  buffer_load_dwordx4 v1, s[20:23], s75 offen offset:0 sc1 lds
  v_mfma_f32_32x32x16_bf16 v[80:95], v[200:203], v[116:119], v[80:95]
  ds_read_b128 v[104:107], v1 offset:21504
  ds_read_b128 v[108:111], v1 offset:51200
  s_waitcnt lgkmcnt(4)
  v_mfma_f32_32x32x16_bf16 v[64:79], v[120:123], v[204:207], v[64:79]
  buffer_load_dwordx4 v1, s[20:23], s75 offen offset:1024 sc1 lds
  v_mfma_f32_32x32x16_bf16 v[80:95], v[204:207], v[124:127], v[80:95]
  ds_read_b128 v[112:115], v1 offset:22528
  ds_read_b128 v[116:119], v1 offset:52224
  s_waitcnt lgkmcnt(4)
  v_mfma_f32_32x32x16_bf16 v[64:79], v[96:99], v[208:211], v[64:79]
  buffer_load_dwordx4 v1, s[20:23], s75 offen offset:2048 sc1 lds
  v_mfma_f32_32x32x16_bf16 v[80:95], v[208:211], v[100:103], v[80:95]
  s_waitcnt vmcnt(21)
  s_barrier
  ds_read_b128 v[120:123], v1 offset:23552
  ds_read_b128 v[124:127], v1 offset:53248
  s_waitcnt lgkmcnt(4)
  v_mfma_f32_32x32x16_bf16 v[64:79], v[104:107], v[212:215], v[64:79]
  v_mfma_f32_32x32x16_bf16 v[80:95], v[212:215], v[108:111], v[80:95]
  buffer_load_dword a138, v247, s[28:31], s84 offen nt
  buffer_load_dword a142, v6, s[16:19], s86 offen nt
  ds_read_b128 v[96:99], v1 offset:24576
  ds_read_b128 v[100:103], v1 offset:54272
  s_waitcnt lgkmcnt(4)
  v_mfma_f32_32x32x16_bf16 v[64:79], v[112:115], v[216:219], v[64:79]
  v_mfma_f32_32x32x16_bf16 v[80:95], v[216:219], v[116:119], v[80:95]
  s_waitcnt vmcnt(12)
  v_add_f32 v56, v56, v57
  v_add_f32 v56, v56, v58
  v_add_f32 v56, v56, v59
  v_add_f32 v56, v56, v60
  v_add_f32 v56, v56, v61
  v_add_f32 v56, v56, v62
  v_mov_b32 v57, v56
  s_nop 1
  v_permlane32_swap_b32 v56, v57
  v_add_f32 v56, v56, v57
  v_cvt_pk_bf16_f32 v57, v56, v56
  v_and_b32 v57, 0xffff0000, v57
  v_sub_f32 v57, v56, v57
  v_cvt_pk_bf16_f32 v56, v56, v57
  v_cndmask_b32 v56, 0, v56, s[64:65]
  v_mov_b32 v57, v63
  v_mov_b32 v58, 0
  v_mov_b32 v59, 0
  v_add_u32 v8, s81, v1
  ds_write_b128 v8, v[56:59]
  ds_read_b128 v[104:107], v1 offset:25600
  ds_read_b128 v[108:111], v1 offset:55296
  s_waitcnt lgkmcnt(5)
  v_mfma_f32_32x32x16_bf16 v[64:79], v[120:123], v[220:223], v[64:79]
  v_mfma_f32_32x32x16_bf16 v[80:95], v[220:223], v[124:127], v[80:95]
  ds_read_b128 v[112:115], v1 offset:26624
  ds_read_b128 v[116:119], v1 offset:56320
  s_waitcnt lgkmcnt(5)
  v_mfma_f32_32x32x16_bf16 v[64:79], v[96:99], v[224:227], v[64:79]
  v_mfma_f32_32x32x16_bf16 v[80:95], v[224:227], v[100:103], v[80:95]
  s_waitcnt lgkmcnt(4)
  s_barrier
  ds_read_b128 v[120:123], v1 offset:27648
  ds_read_b128 v[124:127], v1 offset:57344
  s_waitcnt lgkmcnt(4)
  v_mfma_f32_32x32x16_bf16 v[64:79], v[104:107], v[228:231], v[64:79]
  v_mfma_f32_32x32x16_bf16 v[80:95], v[228:231], v[108:111], v[80:95]
  ds_read_b128 v[96:99], v1 offset:28672
  ds_read_b128 v[100:103], v1 offset:58368
  s_waitcnt lgkmcnt(4)
  v_mfma_f32_32x32x16_bf16 v[64:79], v[112:115], v[232:235], v[64:79]
  v_mfma_f32_32x32x16_bf16 v[80:95], v[232:235], v[116:119], v[80:95]
  s_waitcnt lgkmcnt(2)
  v_mfma_f32_32x32x16_bf16 v[64:79], v[120:123], v[236:239], v[64:79]
  v_mfma_f32_32x32x16_bf16 v[80:95], v[236:239], v[124:127], v[80:95]
  s_waitcnt lgkmcnt(0)
  v_mfma_f32_32x32x16_bf16 v[64:79], v[96:99], v[240:243], v[64:79]
  v_mfma_f32_32x32x16_bf16 v[80:95], v[240:243], v[100:103], v[80:95]
  ds_read_b128 v[104:107], v2 offset:23552
  ds_read_b128 v[108:111], v2 offset:24576
  s_nop 8
  v_max3_f32 v8, v64, v65, v66
  v_max3_f32 v9, -v64, -v65, -v66
  v_max3_f32 v8, v8, v67, v68
  v_max3_f32 v9, v9, -v67, -v68
  v_max3_f32 v8, v8, v69, v70
  v_max3_f32 v9, v9, -v69, -v70
  v_max3_f32 v8, v8, v71, v72
  v_max3_f32 v9, v9, -v71, -v72
  v_max3_f32 v8, v8, v73, v74
  v_max3_f32 v9, v9, -v73, -v74
  v_max3_f32 v8, v8, v75, v76
  v_max3_f32 v9, v9, -v75, -v76
  v_max_f32 v8, v8, v77
  v_max_f32 v9, v9, -v77
  s_nop 1
  v_permlane32_swap_b32 v8, v9
  v_max_f32 v8, v8, v9
  v_mul_f32 v8, v8, v248
  v_mov_b32 v9, v8
  s_nop 1
  v_permlane32_swap_b32 v8, v9
  v_pk_fma_f32 v[40:41], v[64:65], v[248:249], v[8:9] op_sel:[0,0,0] op_sel_hi:[1,0,0] neg_lo:[0,0,1] neg_hi:[0,0,1]
  v_pk_fma_f32 v[42:43], v[66:67], v[248:249], v[8:9] op_sel:[0,0,0] op_sel_hi:[1,0,0] neg_lo:[0,0,1] neg_hi:[0,0,1]
  v_pk_fma_f32 v[44:45], v[68:69], v[248:249], v[8:9] op_sel:[0,0,0] op_sel_hi:[1,0,0] neg_lo:[0,0,1] neg_hi:[0,0,1]
  v_pk_fma_f32 v[46:47], v[70:71], v[248:249], v[8:9] op_sel:[0,0,0] op_sel_hi:[1,0,0] neg_lo:[0,0,1] neg_hi:[0,0,1]
  v_pk_fma_f32 v[48:49], v[72:73], v[248:249], v[8:9] op_sel:[0,0,0] op_sel_hi:[1,0,0] neg_lo:[0,0,1] neg_hi:[0,0,1]
  v_pk_fma_f32 v[50:51], v[74:75], v[248:249], v[8:9] op_sel:[0,0,0] op_sel_hi:[1,0,0] neg_lo:[0,0,1] neg_hi:[0,0,1]
  v_pk_fma_f32 v[52:53], v[76:77], v[248:249], v[8:9] op_sel:[0,0,0] op_sel_hi:[1,0,0] neg_lo:[0,0,1] neg_hi:[0,0,1]
  v_pk_fma_f32 v[64:65], v[64:65], v[248:249], v[8:9] op_sel:[0,0,1] op_sel_hi:[1,0,1] neg_lo:[1,0,1] neg_hi:[1,0,1]
  v_pk_fma_f32 v[66:67], v[66:67], v[248:249], v[8:9] op_sel:[0,0,1] op_sel_hi:[1,0,1] neg_lo:[1,0,1] neg_hi:[1,0,1]
  v_pk_fma_f32 v[68:69], v[68:69], v[248:249], v[8:9] op_sel:[0,0,1] op_sel_hi:[1,0,1] neg_lo:[1,0,1] neg_hi:[1,0,1]
  v_pk_fma_f32 v[70:71], v[70:71], v[248:249], v[8:9] op_sel:[0,0,1] op_sel_hi:[1,0,1] neg_lo:[1,0,1] neg_hi:[1,0,1]
  v_pk_fma_f32 v[72:73], v[72:73], v[248:249], v[8:9] op_sel:[0,0,1] op_sel_hi:[1,0,1] neg_lo:[1,0,1] neg_hi:[1,0,1]
  v_pk_fma_f32 v[74:75], v[74:75], v[248:249], v[8:9] op_sel:[0,0,1] op_sel_hi:[1,0,1] neg_lo:[1,0,1] neg_hi:[1,0,1]
  v_pk_fma_f32 v[76:77], v[76:77], v[248:249], v[8:9] op_sel:[0,0,1] op_sel_hi:[1,0,1] neg_lo:[1,0,1] neg_hi:[1,0,1]
  v_exp_f32 v40, v40
  v_exp_f32 v41, v41
  v_exp_f32 v42, v42
  v_exp_f32 v43, v43
  v_exp_f32 v44, v44
  v_exp_f32 v45, v45
  v_exp_f32 v46, v46
  v_exp_f32 v47, v47
  v_exp_f32 v48, v48
  v_exp_f32 v49, v49
  v_exp_f32 v50, v50
  v_exp_f32 v51, v51
  v_exp_f32 v52, v52
  v_exp_f32 v53, v53
  v_exp_f32 v64, v64
  v_exp_f32 v65, v65
  v_exp_f32 v66, v66
  v_exp_f32 v67, v67
  v_exp_f32 v68, v68
  v_exp_f32 v69, v69
  v_exp_f32 v70, v70
  v_exp_f32 v71, v71
  v_exp_f32 v72, v72
  v_exp_f32 v73, v73
  v_exp_f32 v74, v74
  v_exp_f32 v75, v75
  v_exp_f32 v76, v76
  v_exp_f32 v77, v77
  v_pk_add_f32 v[54:55], v[40:41], v[42:43]
  v_pk_add_f32 v[78:79], v[64:65], v[66:67]
  v_pk_add_f32 v[54:55], v[54:55], v[44:45]
  v_pk_add_f32 v[78:79], v[78:79], v[68:69]
  v_pk_add_f32 v[54:55], v[54:55], v[46:47]
  v_pk_add_f32 v[78:79], v[78:79], v[70:71]
  v_pk_add_f32 v[54:55], v[54:55], v[48:49]
  v_pk_add_f32 v[78:79], v[78:79], v[72:73]
  v_pk_add_f32 v[54:55], v[54:55], v[50:51]
  v_pk_add_f32 v[78:79], v[78:79], v[74:75]
  v_pk_add_f32 v[54:55], v[54:55], v[52:53]
  v_pk_add_f32 v[78:79], v[78:79], v[76:77]
  v_add_f32 v8, v54, v55
  v_add_f32 v9, v78, v79
  s_nop 1
  v_permlane32_swap_b32 v8, v9
  v_add_f32 v8, v8, v9
  v_rcp_f32 v8, v8
  s_nop 0
  v_mul_f32 v8, v8, v246
  v_mov_b32 v9, v8
  s_nop 1
  v_permlane32_swap_b32 v8, v9
  v_pk_mul_f32 v[40:41], v[40:41], v[8:9] op_sel:[0,0] op_sel_hi:[1,0]
  v_pk_mul_f32 v[42:43], v[42:43], v[8:9] op_sel:[0,0] op_sel_hi:[1,0]
  v_pk_mul_f32 v[44:45], v[44:45], v[8:9] op_sel:[0,0] op_sel_hi:[1,0]
  v_pk_mul_f32 v[46:47], v[46:47], v[8:9] op_sel:[0,0] op_sel_hi:[1,0]
  v_pk_mul_f32 v[48:49], v[48:49], v[8:9] op_sel:[0,0] op_sel_hi:[1,0]
  v_pk_mul_f32 v[50:51], v[50:51], v[8:9] op_sel:[0,0] op_sel_hi:[1,0]
  v_pk_mul_f32 v[52:53], v[52:53], v[8:9] op_sel:[0,0] op_sel_hi:[1,0]
  v_pk_mul_f32 v[64:65], v[64:65], v[8:9] op_sel:[0,1] op_sel_hi:[1,1]
  v_pk_mul_f32 v[66:67], v[66:67], v[8:9] op_sel:[0,1] op_sel_hi:[1,1]
  v_pk_mul_f32 v[68:69], v[68:69], v[8:9] op_sel:[0,1] op_sel_hi:[1,1]
  v_pk_mul_f32 v[70:71], v[70:71], v[8:9] op_sel:[0,1] op_sel_hi:[1,1]
  v_pk_mul_f32 v[72:73], v[72:73], v[8:9] op_sel:[0,1] op_sel_hi:[1,1]
  v_pk_mul_f32 v[74:75], v[74:75], v[8:9] op_sel:[0,1] op_sel_hi:[1,1]
  v_pk_mul_f32 v[76:77], v[76:77], v[8:9] op_sel:[0,1] op_sel_hi:[1,1]
  v_cvt_pk_bf16_f32 v112, v40, v41
  v_cvt_pk_bf16_f32 v113, v42, v43
  v_cvt_pk_bf16_f32 v114, v44, v45
  v_cvt_pk_bf16_f32 v115, v46, v47
  v_cvt_pk_bf16_f32 v116, v48, v49
  v_cvt_pk_bf16_f32 v117, v50, v51
  v_cvt_pk_bf16_f32 v118, v52, v53
  v_mov_b32 v119, 0
  v_cvt_pk_bf16_f32 v120, v64, v65
  v_cvt_pk_bf16_f32 v121, v66, v67
  v_cvt_pk_bf16_f32 v122, v68, v69
  v_cvt_pk_bf16_f32 v123, v70, v71
  v_cvt_pk_bf16_f32 v124, v72, v73
  v_cvt_pk_bf16_f32 v125, v74, v75
  v_cvt_pk_bf16_f32 v126, v76, v77
  v_mov_b32 v127, 0
  s_waitcnt lgkmcnt(0)
  v_mfma_f32_32x32x16_bf16 v[64:79], v[112:115], v[104:107], 0
  v_mfma_f32_32x32x16_bf16 v[40:55], v[120:123], v[104:107], 0
  v_mfma_f32_32x32x16_bf16 v[64:79], v[116:119], v[108:111], v[64:79]
  v_mfma_f32_32x32x16_bf16 v[40:55], v[124:127], v[108:111], v[40:55]
  v_cvt_pk_bf16_f32 v56, v80, v81
  v_cvt_pk_bf16_f32 v57, v82, v83
  v_cvt_pk_bf16_f32 v58, v84, v85
  v_cvt_pk_bf16_f32 v59, v86, v87
  v_cvt_pk_bf16_f32 v60, v88, v89
  v_cvt_pk_bf16_f32 v61, v90, v91
  v_cvt_pk_bf16_f32 v62, v92, v93
  v_cvt_pk_bf16_f32 v63, v94, v95
  s_nop 2
  v_cvt_pk_bf16_f32 v96, v64, v65
  v_cvt_pk_bf16_f32 v97, v66, v67
  v_cvt_pk_bf16_f32 v98, v68, v69
  v_cvt_pk_bf16_f32 v99, v70, v71
  v_cvt_pk_bf16_f32 v100, v72, v73
  v_cvt_pk_bf16_f32 v101, v74, v75
  v_cvt_pk_bf16_f32 v102, v76, v77
  v_cvt_pk_bf16_f32 v103, v78, v79
  v_cvt_pk_bf16_f32 v104, v40, v41
  v_cvt_pk_bf16_f32 v105, v42, v43
  v_cvt_pk_bf16_f32 v106, v44, v45
  v_cvt_pk_bf16_f32 v107, v46, v47
  v_cvt_pk_bf16_f32 v108, v48, v49
  v_cvt_pk_bf16_f32 v109, v50, v51
  v_cvt_pk_bf16_f32 v110, v52, v53
  v_cvt_pk_bf16_f32 v111, v54, v55
  v_mfma_f32_32x32x16_bf16 v[64:79], v[96:99], v[56:59], 0
  v_mfma_f32_32x32x16_bf16 v[80:95], v[104:107], v[56:59], 0
  v_mfma_f32_32x32x16_bf16 v[64:79], v[100:103], v[60:63], v[64:79]
  v_mfma_f32_32x32x16_bf16 v[80:95], v[108:111], v[60:63], v[80:95]
  s_lshl_b32 s56, s42, 13
  s_add_u32 s56, s56, 0x18400
  v_add_u32 v12, s56, v1
  s_lshl_b32 s56, s42, 11
  s_add_u32 s56, s56, 0x18400
  v_add_u32 v13, s56, v1
  s_nop 4
  ds_write_b128 v12, v[64:67] offset:0
  ds_write_b128 v12, v[68:71] offset:1024
  ds_write_b128 v12, v[72:75] offset:2048
  ds_write_b128 v12, v[76:79] offset:3072
  ds_write_b128 v12, v[80:83] offset:4096
  ds_write_b128 v12, v[84:87] offset:5120
  ds_write_b128 v12, v[88:91] offset:6144
  ds_write_b128 v12, v[92:95] offset:7168
  s_waitcnt vmcnt(2) lgkmcnt(0)
  s_barrier
  ds_read_b128 v[96:99], v13 offset:0
  ds_read_b128 v[100:103], v13 offset:1024
  ds_read_b128 v[104:107], v13 offset:8192
  ds_read_b128 v[108:111], v13 offset:9216
  ds_read_b128 v[112:115], v13 offset:16384
  ds_read_b128 v[116:119], v13 offset:17408
  ds_read_b128 v[120:123], v13 offset:24576
  ds_read_b128 v[124:127], v13 offset:25600
  s_lshl_b32 s56, s41, 16
  s_lshl_b32 s57, s40, 12
  s_add_u32 s56, s56, s57
  s_lshl_b32 s57, s42, 10
  s_add_u32 s56, s56, s57
  s_add_u32 s56, s56, 0x6c0000
  s_waitcnt lgkmcnt(4)
  v_pk_add_f32 v[96:97], v[96:97], v[104:105]
  v_pk_add_f32 v[98:99], v[98:99], v[106:107]
  v_pk_add_f32 v[100:101], v[100:101], v[108:109]
  v_pk_add_f32 v[102:103], v[102:103], v[110:111]
  s_waitcnt lgkmcnt(0)
  v_pk_add_f32 v[112:113], v[112:113], v[120:121]
  v_pk_add_f32 v[114:115], v[114:115], v[122:123]
  v_pk_add_f32 v[116:117], v[116:117], v[124:125]
  v_pk_add_f32 v[118:119], v[118:119], v[126:127]
  v_pk_add_f32 v[96:97], v[96:97], v[112:113]
  v_pk_add_f32 v[98:99], v[98:99], v[114:115]
  v_pk_add_f32 v[100:101], v[100:101], v[116:117]
  v_pk_add_f32 v[102:103], v[102:103], v[118:119]
  v_cvt_pk_bf16_f32 v104, v96, v97
  v_cvt_pk_bf16_f32 v105, v98, v99
  v_cvt_pk_bf16_f32 v106, v100, v101
  v_cvt_pk_bf16_f32 v107, v102, v103
  v_mul_u32_u24 v10, 12, v0
  s_bitcmp1_b32 s42, 0
  s_cbranch_scc1 L_kv3s_14
  buffer_store_dwordx4 v[104:107], v1, s[20:23], s56 offen sc1
L_kv3j_15:
  ds_read_b128 v[112:115], v1 offset:59392
  buffer_load_dwordx4 a[96:99], v14, s[28:31], s84 offen offset:0
  ds_read_b128 v[116:119], v1 offset:60416
  ds_read_b128 v[120:123], v1 offset:61440
  s_waitcnt lgkmcnt(2)
  v_mfma_f32_32x32x16_bf16 v[64:79], v[112:115], v[128:131], 0
  ds_read_b128 v[124:127], v1 offset:62464
  s_waitcnt lgkmcnt(2)
  v_mfma_f32_32x32x16_bf16 v[64:79], v[116:119], v[132:135], v[64:79]
  ds_read_b128 v[112:115], v1 offset:63488
  s_waitcnt lgkmcnt(2)
  v_mfma_f32_32x32x16_bf16 v[64:79], v[120:123], v[136:139], v[64:79]
  buffer_load_dwordx4 a[100:103], v14, s[28:31], s84 offen offset:32
  ds_read_b128 v[116:119], v1 offset:64512
  s_waitcnt lgkmcnt(2)
  v_mfma_f32_32x32x16_bf16 v[64:79], v[124:127], v[140:143], v[64:79]
  ds_read_b128 v[120:123], v2 offset:0
  s_waitcnt lgkmcnt(2)
  v_mfma_f32_32x32x16_bf16 v[64:79], v[112:115], v[144:147], v[64:79]
  ds_read_b128 v[124:127], v2 offset:1024
  s_waitcnt lgkmcnt(2)
  v_mfma_f32_32x32x16_bf16 v[64:79], v[116:119], v[148:151], v[64:79]
  buffer_load_dwordx4 a[104:107], v14, s[28:31], s85 offen offset:0
  ds_read_b128 v[112:115], v2 offset:2048
  s_waitcnt lgkmcnt(2)
  v_mfma_f32_32x32x16_bf16 v[64:79], v[120:123], v[152:155], v[64:79]
  ds_read_b128 v[116:119], v2 offset:3072
  s_waitcnt lgkmcnt(2)
  v_mfma_f32_32x32x16_bf16 v[64:79], v[124:127], v[156:159], v[64:79]
  ds_read_b128 v[120:123], v2 offset:4096
  s_waitcnt lgkmcnt(2)
  v_mfma_f32_32x32x16_bf16 v[64:79], v[112:115], v[160:163], v[64:79]
  buffer_load_dwordx4 a[108:111], v14, s[28:31], s85 offen offset:32
  ds_read_b128 v[124:127], v2 offset:5120
  s_waitcnt lgkmcnt(2)
  v_mfma_f32_32x32x16_bf16 v[64:79], v[116:119], v[164:167], v[64:79]
  ds_read_b128 v[112:115], v2 offset:6144
  s_waitcnt lgkmcnt(2)
  v_mfma_f32_32x32x16_bf16 v[64:79], v[120:123], v[168:171], v[64:79]
  ds_read_b128 v[116:119], v2 offset:7168
  s_waitcnt lgkmcnt(2)
  v_mfma_f32_32x32x16_bf16 v[64:79], v[124:127], v[172:175], v[64:79]
  buffer_load_dwordx4 a[112:115], v6, s[16:19], s86 offen offset:0
  ds_read_b128 v[120:123], v2 offset:8192
  s_waitcnt lgkmcnt(2)
  v_mfma_f32_32x32x16_bf16 v[64:79], v[112:115], v[176:179], v[64:79]
  ds_read_b128 v[124:127], v2 offset:9216
  s_waitcnt lgkmcnt(2)
  v_mfma_f32_32x32x16_bf16 v[64:79], v[116:119], v[180:183], v[64:79]
  ds_read_b128 v[112:115], v2 offset:10240
  s_waitcnt lgkmcnt(2)
  v_mfma_f32_32x32x16_bf16 v[64:79], v[120:123], v[184:187], v[64:79]
  buffer_load_dwordx4 a[116:119], v6, s[16:19], s86 offen offset:32
  ds_read_b128 v[116:119], v2 offset:11264
  s_waitcnt lgkmcnt(2)
  v_mfma_f32_32x32x16_bf16 v[64:79], v[124:127], v[188:191], v[64:79]
  ds_read_b128 v[120:123], v2 offset:12288
  s_waitcnt lgkmcnt(2)
  v_mfma_f32_32x32x16_bf16 v[64:79], v[112:115], v[192:195], v[64:79]
  ds_read_b128 v[124:127], v2 offset:13312
  s_waitcnt lgkmcnt(2)
  v_mfma_f32_32x32x16_bf16 v[64:79], v[116:119], v[196:199], v[64:79]
  ds_read_b128 v[112:115], v2 offset:14336
  s_waitcnt lgkmcnt(2)
  v_mfma_f32_32x32x16_bf16 v[64:79], v[120:123], v[200:203], v[64:79]
  ds_read_b128 v[116:119], v2 offset:15360
  s_waitcnt lgkmcnt(2)
  v_mfma_f32_32x32x16_bf16 v[64:79], v[124:127], v[204:207], v[64:79]
  ds_read_b128 v[120:123], v2 offset:16384
  s_waitcnt lgkmcnt(2)
  v_mfma_f32_32x32x16_bf16 v[64:79], v[112:115], v[208:211], v[64:79]
  ds_read_b128 v[124:127], v2 offset:17408
  s_waitcnt lgkmcnt(2)
  v_mfma_f32_32x32x16_bf16 v[64:79], v[116:119], v[212:215], v[64:79]
  ds_read_b128 v[112:115], v2 offset:18432
  s_waitcnt lgkmcnt(2)
  v_mfma_f32_32x32x16_bf16 v[64:79], v[120:123], v[216:219], v[64:79]
  ds_read_b128 v[116:119], v2 offset:19456
  s_waitcnt vmcnt(6)
  s_barrier
  s_cmp_lg_u32 s42, 0
  s_cbranch_scc1 L_pubskip_16
  s_lshl_b32 s56, s41, 10
  s_lshl_b32 s57, s40, 6
  s_add_u32 s56, s56, s57
  s_add_u32 s56, s56, 0x7000
  v_mov_b32 v8, s43
  s_mov_b64 exec, 1
  buffer_store_dword v8, v7, s[20:23], s56 offen sc1
  s_mov_b64 exec, -1
  s_nop 0
L_pubskip_16:
  s_waitcnt lgkmcnt(2)
  v_mfma_f32_32x32x16_bf16 v[64:79], v[124:127], v[220:223], v[64:79]
  ds_read_b128 v[120:123], v2 offset:20480
  s_waitcnt lgkmcnt(2)
  v_mfma_f32_32x32x16_bf16 v[64:79], v[112:115], v[224:227], v[64:79]
  ds_read_b128 v[124:127], v2 offset:21504
  s_waitcnt lgkmcnt(2)
  v_mfma_f32_32x32x16_bf16 v[64:79], v[116:119], v[228:231], v[64:79]
  ds_read_b128 v[112:115], v2 offset:22528
  s_waitcnt lgkmcnt(2)
  v_mfma_f32_32x32x16_bf16 v[64:79], v[120:123], v[232:235], v[64:79]
  s_waitcnt lgkmcnt(1)
  v_mfma_f32_32x32x16_bf16 v[64:79], v[124:127], v[236:239], v[64:79]
  s_waitcnt lgkmcnt(0)
  v_mfma_f32_32x32x16_bf16 v[64:79], v[112:115], v[240:243], v[64:79]
  s_waitcnt vmcnt(4)
  v_mfma_f32_32x32x16_bf16 v[80:95], a[96:99], v[24:27], 0
  v_mfma_f32_32x32x16_bf16 v[80:95], a[100:103], v[28:31], v[80:95]
  s_waitcnt vmcnt(2)
  v_mfma_f32_32x32x16_bf16 v[96:111], a[104:107], v[24:27], 0
  v_mfma_f32_32x32x16_bf16 v[96:111], a[108:111], v[28:31], v[96:111]
  s_nop 8
  v_cvt_pk_bf16_f32 v32, v80, v81
  v_cvt_pk_bf16_f32 v33, v82, v83
  v_cvt_pk_bf16_f32 v34, v84, v85
  v_cvt_pk_bf16_f32 v35, v86, v87
  v_cvt_pk_bf16_f32 v36, v88, v89
  v_cvt_pk_bf16_f32 v37, v90, v91
  v_cvt_pk_bf16_f32 v38, v92, v93
  v_cvt_pk_bf16_f32 v39, v94, v95
  buffer_store_dwordx4 v[32:35], v1, s[20:23], s88 offen offset:0 sc1
  v_dot2_f32_bf16 v13, v32, s62, 0
  v_dot2_f32_bf16 v13, v33, s62, v13
  v_dot2_f32_bf16 v13, v34, s62, v13
  v_dot2_f32_bf16 v13, v35, s62, v13
  buffer_store_dwordx4 v[36:39], v1, s[20:23], s88 offen offset:1024 sc1
  v_dot2_f32_bf16 v13, v36, s62, v13
  v_dot2_f32_bf16 v13, v37, s62, v13
  v_dot2_f32_bf16 v13, v38, s62, v13
  v_dot2_f32_bf16 v13, v39, s62, v13
  s_waitcnt vmcnt(2)
  v_mfma_f32_32x32x16_bf16 v[80:95], a[112:115], v[24:27], 0
  v_mfma_f32_32x32x16_bf16 v[80:95], a[116:119], v[28:31], v[80:95]
  v_cvt_pk_bf16_f32 v112, v96, v97
  v_cvt_pk_bf16_f32 v113, v98, v99
  v_cvt_pk_bf16_f32 v114, v100, v101
  v_cvt_pk_bf16_f32 v115, v102, v103
  v_cvt_pk_bf16_f32 v116, v104, v105
  v_cvt_pk_bf16_f32 v117, v106, v107
  v_cvt_pk_bf16_f32 v118, v108, v109
  v_cvt_pk_bf16_f32 v119, v110, v111
  buffer_store_dwordx4 v[112:115], v1, s[20:23], s89 offen offset:0 sc1
  v_dot2_f32_bf16 v12, v112, s62, 0
  v_dot2_f32_bf16 v12, v113, s62, v12
  v_dot2_f32_bf16 v12, v114, s62, v12
  v_dot2_f32_bf16 v12, v115, s62, v12
  buffer_store_dwordx4 v[116:119], v1, s[20:23], s89 offen offset:1024 sc1
  v_dot2_f32_bf16 v12, v116, s62, v12
  v_dot2_f32_bf16 v12, v117, s62, v12
  v_dot2_f32_bf16 v12, v118, s62, v12
  v_dot2_f32_bf16 v12, v119, s62, v12
  s_lshl_b32 s56, s42, 8
  s_add_u32 s56, s56, 0x24400
  v_add_u32 v8, s56, v7
  ds_write_b32 v8, v13
  ds_write_b32 v8, v12 offset:1024
  v_cvt_pk_bf16_f32 v120, v80, v81
  v_cvt_pk_bf16_f32 v121, v82, v83
  v_cvt_pk_bf16_f32 v122, v84, v85
  v_cvt_pk_bf16_f32 v123, v86, v87
  v_cvt_pk_bf16_f32 v124, v88, v89
  v_cvt_pk_bf16_f32 v125, v90, v91
  v_cvt_pk_bf16_f32 v126, v92, v93
  v_cvt_pk_bf16_f32 v127, v94, v95
  buffer_store_dwordx4 v[120:123], v1, s[20:23], s90 offen offset:0 sc1
  buffer_store_dwordx4 v[124:127], v1, s[20:23], s90 offen offset:1024 sc1
  s_waitcnt lgkmcnt(0)
  s_barrier
  s_and_b32 s56, s42, 1
  s_lshl_b32 s56, s56, 10
  s_add_u32 s56, s56, 0x24400
  v_and_b32 v10, 31, v0
  v_lshl_add_u32 v11, v10, 2, s56
  v_lshlrev_b32 v10, 2, v10
  ds_read2_b32 v[40:41], v11 offset0:0 offset1:32
  ds_read2_b32 v[42:43], v11 offset0:64 offset1:96
  ds_read2_b32 v[44:45], v11 offset0:128 offset1:160
  ds_read2_b32 v[46:47], v11 offset0:192 offset1:224
  s_waitcnt lgkmcnt(0)
  v_add_f32 v40, v40, v41
  v_add_f32 v40, v40, v42
  v_add_f32 v40, v40, v43
  v_add_f32 v40, v40, v44
  v_add_f32 v40, v40, v45
  v_add_f32 v40, v40, v46
  v_add_f32 v40, v40, v47
  buffer_store_dword v40, v10, s[20:23], s92 offen sc1
  v_xor_b32 v14, s35, v1
  s_lshl_b32 s56, s40, 10
  s_add_u32 s56, s56, 0xf000
  v_and_b32 v81, 15, v0
  v_lshl_add_u32 v81, v81, 6, s56
  buffer_load_dword v80, v81, s[20:23], 0 offen sc1
  s_lshl_b32 s56, s41, 10
  s_add_u32 s56, s56, 0x7000
  v_and_b32 v83, 15, v0
  v_lshl_add_u32 v83, v83, 6, s56
  buffer_load_dword v82, v83, s[20:23], 0 offen sc1
  v_max3_f32 v8, v64, v65, v66
  v_max3_f32 v9, -v64, -v65, -v66
  v_max3_f32 v8, v8, v67, v68
  v_max3_f32 v9, v9, -v67, -v68
  v_max3_f32 v8, v8, v69, v70
  v_max3_f32 v9, v9, -v69, -v70
  v_max3_f32 v8, v8, v71, v72
  v_max3_f32 v9, v9, -v71, -v72
  v_max3_f32 v8, v8, v73, v74
  v_max3_f32 v9, v9, -v73, -v74
  v_max3_f32 v8, v8, v75, v76
  v_max3_f32 v9, v9, -v75, -v76
  v_max_f32 v8, v8, v77
  v_max_f32 v9, v9, -v77
  s_nop 1
  v_permlane32_swap_b32 v8, v9
  v_max_f32 v8, v8, v9
  v_mul_f32 v8, v8, v248
  v_mov_b32 v9, v8
  s_nop 1
  v_permlane32_swap_b32 v8, v9
  v_pk_fma_f32 v[40:41], v[64:65], v[248:249], v[8:9] op_sel:[0,0,0] op_sel_hi:[1,0,0] neg_lo:[0,0,1] neg_hi:[0,0,1]
  v_pk_fma_f32 v[42:43], v[66:67], v[248:249], v[8:9] op_sel:[0,0,0] op_sel_hi:[1,0,0] neg_lo:[0,0,1] neg_hi:[0,0,1]
  v_pk_fma_f32 v[44:45], v[68:69], v[248:249], v[8:9] op_sel:[0,0,0] op_sel_hi:[1,0,0] neg_lo:[0,0,1] neg_hi:[0,0,1]
  v_pk_fma_f32 v[46:47], v[70:71], v[248:249], v[8:9] op_sel:[0,0,0] op_sel_hi:[1,0,0] neg_lo:[0,0,1] neg_hi:[0,0,1]
  v_pk_fma_f32 v[48:49], v[72:73], v[248:249], v[8:9] op_sel:[0,0,0] op_sel_hi:[1,0,0] neg_lo:[0,0,1] neg_hi:[0,0,1]
  v_pk_fma_f32 v[50:51], v[74:75], v[248:249], v[8:9] op_sel:[0,0,0] op_sel_hi:[1,0,0] neg_lo:[0,0,1] neg_hi:[0,0,1]
  v_pk_fma_f32 v[52:53], v[76:77], v[248:249], v[8:9] op_sel:[0,0,0] op_sel_hi:[1,0,0] neg_lo:[0,0,1] neg_hi:[0,0,1]
  v_pk_fma_f32 v[64:65], v[64:65], v[248:249], v[8:9] op_sel:[0,0,1] op_sel_hi:[1,0,1] neg_lo:[1,0,1] neg_hi:[1,0,1]
  v_pk_fma_f32 v[66:67], v[66:67], v[248:249], v[8:9] op_sel:[0,0,1] op_sel_hi:[1,0,1] neg_lo:[1,0,1] neg_hi:[1,0,1]
  v_pk_fma_f32 v[68:69], v[68:69], v[248:249], v[8:9] op_sel:[0,0,1] op_sel_hi:[1,0,1] neg_lo:[1,0,1] neg_hi:[1,0,1]
  v_pk_fma_f32 v[70:71], v[70:71], v[248:249], v[8:9] op_sel:[0,0,1] op_sel_hi:[1,0,1] neg_lo:[1,0,1] neg_hi:[1,0,1]
  v_pk_fma_f32 v[72:73], v[72:73], v[248:249], v[8:9] op_sel:[0,0,1] op_sel_hi:[1,0,1] neg_lo:[1,0,1] neg_hi:[1,0,1]
  v_pk_fma_f32 v[74:75], v[74:75], v[248:249], v[8:9] op_sel:[0,0,1] op_sel_hi:[1,0,1] neg_lo:[1,0,1] neg_hi:[1,0,1]
  v_pk_fma_f32 v[76:77], v[76:77], v[248:249], v[8:9] op_sel:[0,0,1] op_sel_hi:[1,0,1] neg_lo:[1,0,1] neg_hi:[1,0,1]
  v_exp_f32 v40, v40
  v_exp_f32 v41, v41
  v_exp_f32 v42, v42
  v_exp_f32 v43, v43
  v_exp_f32 v44, v44
  v_exp_f32 v45, v45
  v_exp_f32 v46, v46
  v_exp_f32 v47, v47
  v_exp_f32 v48, v48
  v_exp_f32 v49, v49
  v_exp_f32 v50, v50
  v_exp_f32 v51, v51
  v_exp_f32 v52, v52
  v_exp_f32 v53, v53
  v_exp_f32 v64, v64
  v_exp_f32 v65, v65
  v_exp_f32 v66, v66
  v_exp_f32 v67, v67
  v_exp_f32 v68, v68
  v_exp_f32 v69, v69
  v_exp_f32 v70, v70
  v_exp_f32 v71, v71
  v_exp_f32 v72, v72
  v_exp_f32 v73, v73
  v_exp_f32 v74, v74
  v_exp_f32 v75, v75
  v_exp_f32 v76, v76
  v_exp_f32 v77, v77
  v_pk_add_f32 v[54:55], v[40:41], v[42:43]
  v_pk_add_f32 v[78:79], v[64:65], v[66:67]
  v_pk_add_f32 v[54:55], v[54:55], v[44:45]
  v_pk_add_f32 v[78:79], v[78:79], v[68:69]
  v_pk_add_f32 v[54:55], v[54:55], v[46:47]
  v_pk_add_f32 v[78:79], v[78:79], v[70:71]
  v_pk_add_f32 v[54:55], v[54:55], v[48:49]
  v_pk_add_f32 v[78:79], v[78:79], v[72:73]
  v_pk_add_f32 v[54:55], v[54:55], v[50:51]
  v_pk_add_f32 v[78:79], v[78:79], v[74:75]
  v_pk_add_f32 v[54:55], v[54:55], v[52:53]
  v_pk_add_f32 v[78:79], v[78:79], v[76:77]
  v_add_f32 v8, v54, v55
  v_add_f32 v9, v78, v79
  s_nop 1
  v_permlane32_swap_b32 v8, v9
  v_add_f32 v8, v8, v9
  v_rcp_f32 v8, v8
  s_nop 0
  v_mov_b32 v9, v8
  s_nop 1
  v_permlane32_swap_b32 v8, v9
  v_pk_mul_f32 v[40:41], v[40:41], v[8:9] op_sel:[0,0] op_sel_hi:[1,0]
  v_pk_mul_f32 v[42:43], v[42:43], v[8:9] op_sel:[0,0] op_sel_hi:[1,0]
  v_pk_mul_f32 v[44:45], v[44:45], v[8:9] op_sel:[0,0] op_sel_hi:[1,0]
  v_pk_mul_f32 v[46:47], v[46:47], v[8:9] op_sel:[0,0] op_sel_hi:[1,0]
  v_pk_mul_f32 v[48:49], v[48:49], v[8:9] op_sel:[0,0] op_sel_hi:[1,0]
  v_pk_mul_f32 v[50:51], v[50:51], v[8:9] op_sel:[0,0] op_sel_hi:[1,0]
  v_pk_mul_f32 v[52:53], v[52:53], v[8:9] op_sel:[0,0] op_sel_hi:[1,0]
  v_pk_mul_f32 v[64:65], v[64:65], v[8:9] op_sel:[0,1] op_sel_hi:[1,1]
  v_pk_mul_f32 v[66:67], v[66:67], v[8:9] op_sel:[0,1] op_sel_hi:[1,1]
  v_pk_mul_f32 v[68:69], v[68:69], v[8:9] op_sel:[0,1] op_sel_hi:[1,1]
  v_pk_mul_f32 v[70:71], v[70:71], v[8:9] op_sel:[0,1] op_sel_hi:[1,1]
  v_pk_mul_f32 v[72:73], v[72:73], v[8:9] op_sel:[0,1] op_sel_hi:[1,1]
  v_pk_mul_f32 v[74:75], v[74:75], v[8:9] op_sel:[0,1] op_sel_hi:[1,1]
  v_pk_mul_f32 v[76:77], v[76:77], v[8:9] op_sel:[0,1] op_sel_hi:[1,1]
  v_cvt_pk_bf16_f32 v24, v40, v41
  v_cvt_pk_bf16_f32 v25, v42, v43
  v_cvt_pk_bf16_f32 v26, v44, v45
  v_cvt_pk_bf16_f32 v27, v46, v47
  v_cvt_pk_bf16_f32 v28, v48, v49
  v_cvt_pk_bf16_f32 v29, v50, v51
  v_cvt_pk_bf16_f32 v30, v52, v53
  v_mov_b32 v31, 0
  v_cvt_pk_bf16_f32 v32, v64, v65
  v_cvt_pk_bf16_f32 v33, v66, v67
  v_cvt_pk_bf16_f32 v34, v68, v69
  v_cvt_pk_bf16_f32 v35, v70, v71
  v_cvt_pk_bf16_f32 v36, v72, v73
  v_cvt_pk_bf16_f32 v37, v74, v75
  v_cvt_pk_bf16_f32 v38, v76, v77
  v_mov_b32 v39, 0
  s_lshr_b32 s58, s2, 4
  s_and_b32 s59, s2, 15
  s_waitcnt vmcnt(2)
  s_barrier
  s_cmp_lg_u32 s42, 0
  s_cbranch_scc1 L_pubskip_17
  s_lshl_b32 s56, s58, 10
  s_lshl_b32 s57, s59, 6
  s_add_u32 s56, s56, s57
  s_add_u32 s56, s56, 0x13000
  v_mov_b32 v8, s43
  s_mov_b64 exec, 1
  buffer_store_dword v8, v7, s[20:23], s56 offen sc1
  s_mov_b64 exec, -1
  s_nop 0
L_pubskip_17:
  s_waitcnt vmcnt(1)
  s_mov_b32 s63, 0
L_xpoll_18:
  v_subrev_u32 v80, s43, v80
  v_cmp_lt_u32 vcc, 15, v80
  s_add_u32 s63, s63, 1
  s_nop 1
  s_cbranch_vccz L_xdone_19
  buffer_load_dword v80, v81, s[20:23], 0 offen sc1
  s_waitcnt vmcnt(0)
  s_cmp_lt_u32 s63, 262144
  s_cbranch_scc1 L_xpoll_18
L_xdone_19:
  v_cmp_ne_u32 vcc, s45, v80
  s_nop 1
  s_cmp_eq_u64 vcc, 0
  s_cselect_b32 s44, 1, 0
  s_waitcnt vmcnt(0)
  s_mov_b32 s63, 0
L_shpoll_20:
  v_cmp_ne_u32 vcc, s43, v82
  s_add_u32 s63, s63, 1
  s_nop 1
  s_cbranch_vccz L_shdone_21
  buffer_load_dword v82, v83, s[20:23], 0 offen sc1
  s_waitcnt vmcnt(0)
  s_cmp_lt_u32 s63, 262144
  s_cbranch_scc1 L_shpoll_20
L_shdone_21:
  s_lshl_b32 s69, s41, 16
  s_lshl_b32 s56, s42, 10
  s_add_u32 s69, s69, s56
  s_add_u32 s69, s69, 0x6c0000
  s_and_b32 s56, s40, 0
  s_lshl_b32 s56, s56, 15
  s_sub_u32 s93, s69, s56
  s_add_u32 s69, s69, s56
  v_mul_u32_u24 v12, 12, v0
  s_bitcmp1_b32 s42, 0
  s_cselect_b32 s57, 0, -1
  s_cbranch_scc1 L_kv3l_22
  buffer_load_dwordx4 v[128:131], v1, s[20:23], s69 offen offset:0 sc1
  s_add_u32 s48, s69, 0x1000
  buffer_load_dwordx4 v[132:135], v1, s[20:23], s48 offen offset:0 sc1
  s_add_u32 s49, s69, 0x2000
  buffer_load_dwordx4 v[136:139], v1, s[20:23], s49 offen offset:0 sc1
  s_add_u32 s50, s69, 0x3000
  buffer_load_dwordx4 v[140:143], v1, s[20:23], s50 offen offset:0 sc1
  s_add_u32 s51, s69, 0x4000
  buffer_load_dwordx4 v[144:147], v1, s[20:23], s51 offen offset:0 sc1
  s_add_u32 s52, s69, 0x5000
  buffer_load_dwordx4 v[148:151], v1, s[20:23], s52 offen offset:0 sc1
  s_add_u32 s53, s69, 0x6000
  buffer_load_dwordx4 v[152:155], v1, s[20:23], s53 offen offset:0 sc1
  s_add_u32 s54, s69, 0x7000
  buffer_load_dwordx4 v[156:159], v1, s[20:23], s54 offen offset:0 sc1
  s_add_u32 s55, s93, 0x8000
  buffer_load_dwordx4 v[160:163], v1, s[20:23], s55 offen offset:0 sc1
  s_add_u32 s48, s93, 0x9000
  buffer_load_dwordx4 v[164:167], v1, s[20:23], s48 offen offset:0 sc1
  s_add_u32 s49, s93, 0xa000
  buffer_load_dwordx4 v[168:171], v1, s[20:23], s49 offen offset:0 sc1
  s_add_u32 s50, s93, 0xb000
  buffer_load_dwordx4 v[172:175], v1, s[20:23], s50 offen offset:0 sc1
  s_add_u32 s51, s93, 0xc000
  buffer_load_dwordx4 v[176:179], v1, s[20:23], s51 offen offset:0 sc1
  s_add_u32 s52, s93, 0xd000
  buffer_load_dwordx4 v[180:183], v1, s[20:23], s52 offen offset:0 sc1
  s_add_u32 s53, s93, 0xe000
  buffer_load_dwordx4 v[184:187], v1, s[20:23], s53 offen offset:0 sc1
  s_add_u32 s54, s93, 0xf000
  buffer_load_dwordx4 v[188:191], v1, s[20:23], s54 offen offset:0 sc1
L_kv3k_23:
  s_waitcnt vmcnt(15)
  v_dot2_f32_bf16 v40, v128, s60, 0
  v_dot2_f32_bf16 v41, v128, s61, 0
  v_dot2_f32_bf16 v42, v129, s60, 0
  v_dot2_f32_bf16 v43, v129, s61, 0
  v_dot2_f32_bf16 v44, v130, s60, 0
  v_dot2_f32_bf16 v45, v130, s61, 0
  v_dot2_f32_bf16 v46, v131, s60, 0
  v_dot2_f32_bf16 v47, v131, s61, 0
  s_waitcnt vmcnt(14)
  v_dot2_f32_bf16 v40, v132, s60, v40
  v_dot2_f32_bf16 v41, v132, s61, v41
  v_dot2_f32_bf16 v42, v133, s60, v42
  v_dot2_f32_bf16 v43, v133, s61, v43
  v_dot2_f32_bf16 v44, v134, s60, v44
  v_dot2_f32_bf16 v45, v134, s61, v45
  v_dot2_f32_bf16 v46, v135, s60, v46
  v_dot2_f32_bf16 v47, v135, s61, v47
  s_waitcnt vmcnt(13)
  v_dot2_f32_bf16 v40, v136, s60, v40
  v_dot2_f32_bf16 v41, v136, s61, v41
  v_dot2_f32_bf16 v42, v137, s60, v42
  v_dot2_f32_bf16 v43, v137, s61, v43
  v_dot2_f32_bf16 v44, v138, s60, v44
  v_dot2_f32_bf16 v45, v138, s61, v45
  v_dot2_f32_bf16 v46, v139, s60, v46
  v_dot2_f32_bf16 v47, v139, s61, v47
  s_waitcnt vmcnt(12)
  v_dot2_f32_bf16 v40, v140, s60, v40
  v_dot2_f32_bf16 v41, v140, s61, v41
  v_dot2_f32_bf16 v42, v141, s60, v42
  v_dot2_f32_bf16 v43, v141, s61, v43
  v_dot2_f32_bf16 v44, v142, s60, v44
  v_dot2_f32_bf16 v45, v142, s61, v45
  v_dot2_f32_bf16 v46, v143, s60, v46
  v_dot2_f32_bf16 v47, v143, s61, v47
  s_waitcnt vmcnt(11)
  v_dot2_f32_bf16 v40, v144, s60, v40
  v_dot2_f32_bf16 v41, v144, s61, v41
  v_dot2_f32_bf16 v42, v145, s60, v42
  v_dot2_f32_bf16 v43, v145, s61, v43
  v_dot2_f32_bf16 v44, v146, s60, v44
  v_dot2_f32_bf16 v45, v146, s61, v45
  v_dot2_f32_bf16 v46, v147, s60, v46
  v_dot2_f32_bf16 v47, v147, s61, v47
  s_waitcnt vmcnt(10)
  v_dot2_f32_bf16 v40, v148, s60, v40
  v_dot2_f32_bf16 v41, v148, s61, v41
  v_dot2_f32_bf16 v42, v149, s60, v42
  v_dot2_f32_bf16 v43, v149, s61, v43
  v_dot2_f32_bf16 v44, v150, s60, v44
  v_dot2_f32_bf16 v45, v150, s61, v45
  v_dot2_f32_bf16 v46, v151, s60, v46
  v_dot2_f32_bf16 v47, v151, s61, v47
  s_waitcnt vmcnt(9)
  v_dot2_f32_bf16 v40, v152, s60, v40
  v_dot2_f32_bf16 v41, v152, s61, v41
  v_dot2_f32_bf16 v42, v153, s60, v42
  v_dot2_f32_bf16 v43, v153, s61, v43
  v_dot2_f32_bf16 v44, v154, s60, v44
  v_dot2_f32_bf16 v45, v154, s61, v45
  v_dot2_f32_bf16 v46, v155, s60, v46
  v_dot2_f32_bf16 v47, v155, s61, v47
  s_waitcnt vmcnt(8)
  v_dot2_f32_bf16 v40, v156, s60, v40
  v_dot2_f32_bf16 v41, v156, s61, v41
  v_dot2_f32_bf16 v42, v157, s60, v42
  v_dot2_f32_bf16 v43, v157, s61, v43
  v_dot2_f32_bf16 v44, v158, s60, v44
  v_dot2_f32_bf16 v45, v158, s61, v45
  v_dot2_f32_bf16 v46, v159, s60, v46
  v_dot2_f32_bf16 v47, v159, s61, v47
  s_waitcnt vmcnt(7)
  v_dot2_f32_bf16 v40, v160, s60, v40
  v_dot2_f32_bf16 v41, v160, s61, v41
  v_dot2_f32_bf16 v42, v161, s60, v42
  v_dot2_f32_bf16 v43, v161, s61, v43
  v_dot2_f32_bf16 v44, v162, s60, v44
  v_dot2_f32_bf16 v45, v162, s61, v45
  v_dot2_f32_bf16 v46, v163, s60, v46
  v_dot2_f32_bf16 v47, v163, s61, v47
  s_waitcnt vmcnt(6)
  v_dot2_f32_bf16 v40, v164, s60, v40
  v_dot2_f32_bf16 v41, v164, s61, v41
  v_dot2_f32_bf16 v42, v165, s60, v42
  v_dot2_f32_bf16 v43, v165, s61, v43
  v_dot2_f32_bf16 v44, v166, s60, v44
  v_dot2_f32_bf16 v45, v166, s61, v45
  v_dot2_f32_bf16 v46, v167, s60, v46
  v_dot2_f32_bf16 v47, v167, s61, v47
  s_waitcnt vmcnt(5)
  v_dot2_f32_bf16 v40, v168, s60, v40
  v_dot2_f32_bf16 v41, v168, s61, v41
  v_dot2_f32_bf16 v42, v169, s60, v42
  v_dot2_f32_bf16 v43, v169, s61, v43
  v_dot2_f32_bf16 v44, v170, s60, v44
  v_dot2_f32_bf16 v45, v170, s61, v45
  v_dot2_f32_bf16 v46, v171, s60, v46
  v_dot2_f32_bf16 v47, v171, s61, v47
  s_waitcnt vmcnt(4)
  v_dot2_f32_bf16 v40, v172, s60, v40
  v_dot2_f32_bf16 v41, v172, s61, v41
  v_dot2_f32_bf16 v42, v173, s60, v42
  v_dot2_f32_bf16 v43, v173, s61, v43
  v_dot2_f32_bf16 v44, v174, s60, v44
  v_dot2_f32_bf16 v45, v174, s61, v45
  v_dot2_f32_bf16 v46, v175, s60, v46
  v_dot2_f32_bf16 v47, v175, s61, v47
  s_waitcnt vmcnt(3)
  v_dot2_f32_bf16 v40, v176, s60, v40
  v_dot2_f32_bf16 v41, v176, s61, v41
  v_dot2_f32_bf16 v42, v177, s60, v42
  v_dot2_f32_bf16 v43, v177, s61, v43
  v_dot2_f32_bf16 v44, v178, s60, v44
  v_dot2_f32_bf16 v45, v178, s61, v45
  v_dot2_f32_bf16 v46, v179, s60, v46
  v_dot2_f32_bf16 v47, v179, s61, v47
  s_waitcnt vmcnt(2)
  v_dot2_f32_bf16 v40, v180, s60, v40
  v_dot2_f32_bf16 v41, v180, s61, v41
  v_dot2_f32_bf16 v42, v181, s60, v42
  v_dot2_f32_bf16 v43, v181, s61, v43
  v_dot2_f32_bf16 v44, v182, s60, v44
  v_dot2_f32_bf16 v45, v182, s61, v45
  v_dot2_f32_bf16 v46, v183, s60, v46
  v_dot2_f32_bf16 v47, v183, s61, v47
  s_waitcnt vmcnt(1)
  v_dot2_f32_bf16 v40, v184, s60, v40
  v_dot2_f32_bf16 v41, v184, s61, v41
  v_dot2_f32_bf16 v42, v185, s60, v42
  v_dot2_f32_bf16 v43, v185, s61, v43
  v_dot2_f32_bf16 v44, v186, s60, v44
  v_dot2_f32_bf16 v45, v186, s61, v45
  v_dot2_f32_bf16 v46, v187, s60, v46
  v_dot2_f32_bf16 v47, v187, s61, v47
  s_waitcnt vmcnt(0)
  v_dot2_f32_bf16 v40, v188, s60, v40
  v_dot2_f32_bf16 v41, v188, s61, v41
  v_dot2_f32_bf16 v42, v189, s60, v42
  v_dot2_f32_bf16 v43, v189, s61, v43
  v_dot2_f32_bf16 v44, v190, s60, v44
  v_dot2_f32_bf16 v45, v190, s61, v45
  v_dot2_f32_bf16 v46, v191, s60, v46
  v_dot2_f32_bf16 v47, v191, s61, v47
  v_cvt_pk_bf16_f32 v48, v40, v41
  v_cvt_pk_bf16_f32 v49, v42, v43
  v_cvt_pk_bf16_f32 v50, v44, v45
  v_cvt_pk_bf16_f32 v51, v46, v47
  v_and_b32 v51, s57, v51
  s_lshl_b32 s56, s42, 10
  s_add_u32 s56, s56, 0x20400
  v_add_u32 v8, s56, v1
  ds_write_b128 v8, v[48:51]
  s_lshl_b32 s56, s41, 4
  v_add_u32 v11, s56, v0
  v_add_u32 v10, 208, v0
  v_min_u32 v10, 255, v10
  v_cmp_gt_u32 vcc, 16, v0
  s_nop 1
  v_cndmask_b32 v11, v10, v11, vcc
  v_lshlrev_b32 v11, 6, v11
  v_add_u32 v11, 0x13000, v11
  buffer_load_dword v10, v11, s[20:23], 0 offen sc1
  s_waitcnt lgkmcnt(0)
  s_barrier
  ds_read_b128 v[96:99], v3 offset:1024
  ds_read_b128 v[100:103], v3 offset:2048
  ds_read_b128 v[104:107], v3 offset:3072
  ds_read_b128 v[108:111], v3 offset:4096
  s_lshl_b32 s56, s42, 15
  s_add_u32 s56, s56, s39
  s_lshl_b32 s57, s41, 11
  s_add_u32 s56, s56, s57
  s_add_u32 s56, s56, 0x7dc000
  s_waitcnt lgkmcnt(3)
  v_mfma_f32_32x32x16_bf16 v[64:79], v[96:99], v[24:27], 0
  s_waitcnt lgkmcnt(2)
  v_mfma_f32_32x32x16_bf16 v[64:79], v[100:103], v[28:31], v[64:79]
  s_waitcnt lgkmcnt(1)
  v_mfma_f32_32x32x16_bf16 v[64:79], v[104:107], v[32:35], v[64:79]
  s_waitcnt lgkmcnt(0)
  v_mfma_f32_32x32x16_bf16 v[64:79], v[108:111], v[36:39], v[64:79]
  s_nop 11
  v_add_f32 v8, 0x358637bd, v78
  v_rcp_f32 v8, v8
  v_mov_b32 v47, 0
  v_pk_mul_f32 v[64:65], v[64:65], v[8:9] op_sel:[0,0] op_sel_hi:[1,0]
  v_pk_mul_f32 v[66:67], v[66:67], v[8:9] op_sel:[0,0] op_sel_hi:[1,0]
  v_pk_mul_f32 v[68:69], v[68:69], v[8:9] op_sel:[0,0] op_sel_hi:[1,0]
  v_pk_mul_f32 v[70:71], v[70:71], v[8:9] op_sel:[0,0] op_sel_hi:[1,0]
  v_pk_mul_f32 v[72:73], v[72:73], v[8:9] op_sel:[0,0] op_sel_hi:[1,0]
  v_pk_mul_f32 v[74:75], v[74:75], v[8:9] op_sel:[0,0] op_sel_hi:[1,0]
  v_pk_mul_f32 v[76:77], v[76:77], v[8:9] op_sel:[0,0] op_sel_hi:[1,0]
  v_cvt_pk_bf16_f32 v40, v64, v65
  v_cvt_pk_bf16_f32 v41, v66, v67
  v_cvt_pk_bf16_f32 v42, v68, v69
  v_cvt_pk_bf16_f32 v43, v70, v71
  v_cvt_pk_bf16_f32 v44, v72, v73
  v_cvt_pk_bf16_f32 v45, v74, v75
  v_cvt_pk_bf16_f32 v46, v76, v77
  buffer_store_dwordx4 v[40:43], v1, s[20:23], s56 offen offset:0 sc1
  buffer_store_dwordx4 v[44:47], v1, s[20:23], s56 offen offset:1024 sc1
  s_waitcnt vmcnt(0) lgkmcnt(0)
  s_barrier
  s_cmp_lg_u32 s42, 0
  s_cbranch_scc1 L_pubskip_24
  s_lshl_b32 s56, s40, 7
  s_lshl_b32 s57, s41, 2
  s_add_u32 s56, s56, s57
  s_add_u32 s56, s56, 0x1000
  v_mov_b32 v8, s43
  s_mov_b64 exec, 1
  s_cmp_eq_u32 s44, 0
  s_cbranch_scc1 L_slow_25
  buffer_store_dword v8, v7, s[20:23], s56 offen
L_join_26:
  s_mov_b64 exec, -1
  s_nop 0
L_pubskip_24:
  s_cmp_ge_u32 s41, 14
  s_cbranch_scc1 L_help0
L_wo0:
  s_mov_b32 s63, 0
L_shpoll_27:
  v_cmp_ne_u32 vcc, s43, v10
  s_add_u32 s63, s63, 1
  s_nop 1
  s_cbranch_vccz L_shdone_28
  buffer_load_dword v10, v11, s[20:23], 0 offen sc1
  s_waitcnt vmcnt(0)
  s_cmp_lt_u32 s63, 262144
  s_cbranch_scc1 L_shpoll_27
L_shdone_28:
  buffer_load_dwordx4 v[192:195], v14, s[20:23], s66 offen offset:0
  buffer_load_dwordx4 v[196:199], v14, s[20:23], s66 offen offset:1024
  buffer_load_dwordx4 v[200:203], v14, s[20:23], s66 offen offset:2048
  buffer_load_dwordx4 v[204:207], v14, s[20:23], s66 offen offset:3072
  buffer_load_dwordx4 v[224:227], v14, s[20:23], s82 offen offset:0
  buffer_load_dwordx4 v[228:231], v14, s[20:23], s82 offen offset:1024
  buffer_load_dwordx4 v[232:235], v14, s[20:23], s82 offen offset:2048
  buffer_load_dwordx4 v[236:239], v14, s[20:23], s82 offen offset:3072
  s_lshl_b32 s55, s40, 7
  s_add_u32 s55, s55, 0x1000
  s_mov_b64 exec, 0xffff
  buffer_load_dword v36, v7, s[20:23], s55 offen sc1
  s_mov_b64 exec, -1
  s_add_u32 s70, s66, 0x1000
  buffer_load_dwordx4 v[208:211], v14, s[20:23], s70 offen offset:0
  buffer_load_dwordx4 v[212:215], v14, s[20:23], s70 offen offset:1024
  buffer_load_dwordx4 v[216:219], v14, s[20:23], s70 offen offset:2048
  buffer_load_dwordx4 v[220:223], v14, s[20:23], s70 offen offset:3072
  s_add_u32 s71, s82, 0x1000
  buffer_load_dwordx4 v[240:243], v14, s[20:23], s71 offen offset:0
  buffer_load_dwordx4 v[244:247], v14, s[20:23], s71 offen offset:1024
  buffer_load_dwordx4 v[248:251], v14, s[20:23], s71 offen offset:2048
  buffer_load_dwordx4 v[252:255], v14, s[20:23], s71 offen offset:3072
  v_lshrrev_b32 v12, 2, v5
  s_add_u32 s56, s67, 28672
  s_add_u32 s57, s67, 58368
  buffer_load_dword v28, v12, s[20:23], s56 offen offset:0
  buffer_load_dword v29, v12, s[20:23], s56 offen offset:256
  buffer_load_dword v30, v12, s[20:23], s57 offen offset:0
  buffer_load_dword v31, v12, s[20:23], s57 offen offset:256
  s_lshr_b32 s56, s47, 1
  s_and_b32 s56, s56, 3
  v_min_u32 v39, 55, v0
  v_lshl_add_u32 v39, v39, 2, s56
  v_lshlrev_b32 v39, 6, v39
  v_add_u32 v39, 0x13000, v39
  buffer_load_dword v38, v39, s[20:23], 0 offen sc1
  buffer_load_dwordx4 a[0:3], v1, s[20:23], s36 offen offset:0
  buffer_load_dwordx4 a[4:7], v1, s[20:23], s36 offen offset:1024
  s_lshl_b32 s69, s46, 15
  s_add_u32 s69, s69, s39
  s_lshl_b32 s56, s42, 13
  s_add_u32 s69, s69, s56
  s_add_u32 s69, s69, 0x7dc000
  s_xor_b32 s56, s42, 1
  s_mul_i32 s56, s56, 6144
  s_add_u32 s56, s56, 0x18400
  v_add_u32 v10, s56, v1
  s_xor_b32 s56, s42, 2
  s_mul_i32 s56, s56, 6144
  s_add_u32 s56, s56, 0x18c00
  v_add_u32 v11, s56, v1
  s_xor_b32 s56, s42, 3
  s_mul_i32 s56, s56, 6144
  s_add_u32 s56, s56, 0x19400
  v_add_u32 v12, s56, v1
  s_mul_i32 s56, s42, 6144
  s_add_u32 s56, s56, 0x18400
  v_add_u32 v13, s56, v1
  s_waitcnt vmcnt(15)
  v_cmp_ne_u32 vcc, s43, v36
  s_nop 1
  s_and_b32 s56, vcc_lo, 0xffff
  s_cbranch_scc1 L_fsp_31
L_fok_30:
  buffer_load_dwordx4 v[128:131], v1, s[20:23], s69 offen offset:0 sc1
  buffer_load_dwordx4 v[132:135], v1, s[20:23], s69 offen offset:1024 sc1
  buffer_load_dwordx4 v[136:139], v1, s[20:23], s69 offen offset:2048 sc1
  buffer_load_dwordx4 v[140:143], v1, s[20:23], s69 offen offset:3072 sc1
  s_add_u32 s76, s69, 0x1000
  buffer_load_dwordx4 v[144:147], v1, s[20:23], s76 offen offset:0 sc1
  buffer_load_dwordx4 v[148:151], v1, s[20:23], s76 offen offset:1024 sc1
  buffer_load_dwordx4 v[152:155], v1, s[20:23], s76 offen offset:2048 sc1
  buffer_load_dwordx4 v[156:159], v1, s[20:23], s76 offen offset:3072 sc1
  s_add_u32 s77, s69, 0x10000
  buffer_load_dwordx4 v[160:163], v1, s[20:23], s77 offen offset:0 sc1
  buffer_load_dwordx4 v[164:167], v1, s[20:23], s77 offen offset:1024 sc1
  s_waitcnt vmcnt(13)
  v_add_f32 v32, v30, v31
  v_add_f32 v24, v28, v29
  v_mov_b32 v25, v24
  v_mov_b32 v33, v32
  s_nop 0
  v_permlane32_swap_b32 v24, v25
  v_permlane32_swap_b32 v32, v33
  v_add_f32 v24, v24, v25
  v_add_f32 v32, v32, v33
  v_mov_b32 v28, 0
  v_cvt_pk_bf16_f32 v25, v24, v24
  v_and_b32 v25, 0xffff0000, v25
  v_sub_f32 v25, v24, v25
  v_cvt_pk_bf16_f32 v24, v24, v25
  v_cndmask_b32 v24, 0, v24, s[64:65]
  v_mov_b32 v25, v28
  v_mov_b32 v26, 0
  v_mov_b32 v27, 0
  v_accvgpr_write_b32 a112, v24
  v_accvgpr_write_b32 a113, v25
  v_accvgpr_write_b32 a114, v26
  v_accvgpr_write_b32 a115, v27
  v_cvt_pk_bf16_f32 v33, v32, v32
  v_and_b32 v33, 0xffff0000, v33
  v_sub_f32 v33, v32, v33
  v_cvt_pk_bf16_f32 v32, v32, v33
  v_cndmask_b32 v32, 0, v32, s[64:65]
  v_mov_b32 v33, v28
  v_mov_b32 v34, 0
  v_mov_b32 v35, 0
  v_accvgpr_write_b32 a228, v32
  v_accvgpr_write_b32 a229, v33
  v_accvgpr_write_b32 a230, v34
  v_accvgpr_write_b32 a231, v35
  s_waitcnt vmcnt(9)
  v_mfma_f32_32x32x16_bf16 v[64:79], v[192:195], v[128:131], 0
  buffer_load_dwordx4 v[168:171], v1, s[20:23], s77 offen offset:2048 sc1
  v_mfma_f32_32x32x16_bf16 v[80:95], v[224:227], v[128:131], 0
  s_waitcnt vmcnt(9)
  v_mfma_f32_32x32x16_bf16 v[64:79], v[196:199], v[132:135], v[64:79]
  buffer_load_dwordx4 v[172:175], v1, s[20:23], s77 offen offset:3072 sc1
  v_mfma_f32_32x32x16_bf16 v[80:95], v[228:231], v[132:135], v[80:95]
  s_waitcnt vmcnt(9)
  v_mfma_f32_32x32x16_bf16 v[64:79], v[200:203], v[136:139], v[64:79]
  s_add_u32 s74, s69, 0x11000
  buffer_load_dwordx4 v[176:179], v1, s[20:23], s74 offen offset:0 sc1
  v_mfma_f32_32x32x16_bf16 v[80:95], v[232:235], v[136:139], v[80:95]
  s_waitcnt vmcnt(9)
  v_mfma_f32_32x32x16_bf16 v[64:79], v[204:207], v[140:143], v[64:79]
  buffer_load_dwordx4 v[180:183], v1, s[20:23], s74 offen offset:1024 sc1
  v_mfma_f32_32x32x16_bf16 v[80:95], v[236:239], v[140:143], v[80:95]
  s_waitcnt vmcnt(9)
  v_mfma_f32_32x32x16_bf16 v[64:79], v[208:211], v[144:147], v[64:79]
  buffer_load_dwordx4 v[184:187], v1, s[20:23], s74 offen offset:2048 sc1
  v_mfma_f32_32x32x16_bf16 v[80:95], v[240:243], v[144:147], v[80:95]
  s_waitcnt vmcnt(9)
  v_mfma_f32_32x32x16_bf16 v[64:79], v[212:215], v[148:151], v[64:79]
  buffer_load_dwordx4 v[188:191], v1, s[20:23], s74 offen offset:3072 sc1
  v_mfma_f32_32x32x16_bf16 v[80:95], v[244:247], v[148:151], v[80:95]
  s_waitcnt vmcnt(9)
  v_mfma_f32_32x32x16_bf16 v[64:79], v[216:219], v[152:155], v[64:79]
  buffer_load_dwordx4 a[8:11], v1, s[20:23], s36 offen offset:2048
  v_mfma_f32_32x32x16_bf16 v[80:95], v[248:251], v[152:155], v[80:95]
  s_waitcnt vmcnt(9)
  v_mfma_f32_32x32x16_bf16 v[64:79], v[220:223], v[156:159], v[64:79]
  buffer_load_dwordx4 a[12:15], v1, s[20:23], s36 offen offset:3072
  v_mfma_f32_32x32x16_bf16 v[80:95], v[252:255], v[156:159], v[80:95]
  s_waitcnt vmcnt(9)
  v_mfma_f32_32x32x16_bf16 v[96:111], v[192:195], v[160:163], 0
  s_add_u32 s72, s36, 0x7000
  buffer_load_dwordx4 a[116:119], v1, s[20:23], s72 offen offset:1024
  v_mfma_f32_32x32x16_bf16 v[112:127], v[224:227], v[160:163], 0
  s_waitcnt vmcnt(9)
  v_mfma_f32_32x32x16_bf16 v[96:111], v[196:199], v[164:167], v[96:111]
  buffer_load_dwordx4 a[120:123], v1, s[20:23], s72 offen offset:2048
  s_nop 1
  ds_write_b128 v10, v[72:75] offset:0
  v_mfma_f32_32x32x16_bf16 v[112:127], v[228:231], v[164:167], v[112:127]
  ds_write_b128 v10, v[76:79] offset:1024
  s_waitcnt vmcnt(9)
  v_mfma_f32_32x32x16_bf16 v[96:111], v[200:203], v[168:171], v[96:111]
  buffer_load_dwordx4 a[124:127], v1, s[20:23], s72 offen offset:3072
  ds_write_b128 v11, v[80:83] offset:0
  v_mfma_f32_32x32x16_bf16 v[112:127], v[232:235], v[168:171], v[112:127]
  ds_write_b128 v11, v[84:87] offset:1024
  s_waitcnt vmcnt(9)
  v_mfma_f32_32x32x16_bf16 v[96:111], v[204:207], v[172:175], v[96:111]
  s_add_u32 s73, s36, 0x8000
  buffer_load_dwordx4 a[128:131], v1, s[20:23], s73 offen offset:0
  ds_write_b128 v12, v[88:91] offset:0
  v_mfma_f32_32x32x16_bf16 v[112:127], v[236:239], v[172:175], v[112:127]
  ds_write_b128 v12, v[92:95] offset:1024
  s_waitcnt vmcnt(9)
  v_mfma_f32_32x32x16_bf16 v[96:111], v[208:211], v[176:179], v[96:111]
  s_add_u32 s70, s36, 0x1000
  buffer_load_dwordx4 a[16:19], v1, s[20:23], s70 offen offset:0
  s_waitcnt lgkmcnt(0)
  s_barrier
  ds_read_b128 v[72:75], v13 offset:0
  ds_read_b128 v[76:79], v13 offset:1024
  ds_read_b128 v[80:83], v13 offset:2048
  ds_read_b128 v[84:87], v13 offset:3072
  v_mfma_f32_32x32x16_bf16 v[112:127], v[240:243], v[176:179], v[112:127]
  ds_read_b128 v[88:91], v13 offset:4096
  ds_read_b128 v[92:95], v13 offset:5120
  s_add_u32 s57, s32, 0x818000
  s_add_u32 s58, s33, 0x10c0000
  v_lshlrev_b32 v40, 16, v16
  s_waitcnt vmcnt(9)
  v_mfma_f32_32x32x16_bf16 v[96:111], v[212:215], v[180:183], v[96:111]
  buffer_load_dwordx4 a[20:23], v1, s[20:23], s70 offen offset:1024
  v_and_b32 v16, 0xffff0000, v16
  v_lshlrev_b32 v41, 16, v17
  v_and_b32 v17, 0xffff0000, v17
  v_lshlrev_b32 v42, 16, v18
  v_and_b32 v18, 0xffff0000, v18
  v_mfma_f32_32x32x16_bf16 v[112:127], v[244:247], v[180:183], v[112:127]
  v_lshlrev_b32 v43, 16, v19
  v_and_b32 v19, 0xffff0000, v19
  v_add_f32 v64, v64, v40
  v_add_f32 v65, v65, v16
  v_add_f32 v66, v66, v41
  s_waitcnt vmcnt(9)
  v_mfma_f32_32x32x16_bf16 v[96:111], v[216:219], v[184:187], v[96:111]
  buffer_load_dwordx4 a[24:27], v1, s[20:23], s70 offen offset:2048
  v_add_f32 v67, v67, v17
  v_add_f32 v68, v68, v42
  v_add_f32 v69, v69, v18
  v_add_f32 v70, v70, v43
  v_add_f32 v71, v71, v19
  v_mfma_f32_32x32x16_bf16 v[112:127], v[248:251], v[184:187], v[112:127]
  s_waitcnt lgkmcnt(4)
  v_add_f32 v64, v64, v72
  v_add_f32 v65, v65, v73
  v_add_f32 v66, v66, v74
  v_add_f32 v67, v67, v75
  v_add_f32 v68, v68, v76
  s_waitcnt vmcnt(9)
  v_mfma_f32_32x32x16_bf16 v[96:111], v[220:223], v[188:191], v[96:111]
  buffer_load_dwordx4 a[28:31], v1, s[20:23], s70 offen offset:3072
  v_add_f32 v69, v69, v77
  v_add_f32 v70, v70, v78
  v_add_f32 v71, v71, v79
  s_waitcnt lgkmcnt(2)
  v_add_f32 v64, v64, v80
  v_add_f32 v65, v65, v81
  v_mfma_f32_32x32x16_bf16 v[112:127], v[252:255], v[188:191], v[112:127]
  v_add_f32 v66, v66, v82
  v_add_f32 v67, v67, v83
  v_add_f32 v68, v68, v84
  v_add_f32 v69, v69, v85
  v_add_f32 v70, v70, v86
  v_add_f32 v71, v71, v87
  s_waitcnt lgkmcnt(0)
  v_add_f32 v64, v64, v88
  v_add_f32 v65, v65, v89
  v_add_f32 v66, v66, v90
  v_add_f32 v67, v67, v91
  v_add_f32 v68, v68, v92
  v_add_f32 v69, v69, v93
  v_add_f32 v70, v70, v94
  v_add_f32 v71, v71, v95
  v_cvt_pk_bf16_f32 v40, v64, v65
  v_cvt_pk_bf16_f32 v41, v66, v67
  v_cvt_pk_bf16_f32 v42, v68, v69
  s_add_u32 s71, s36, 0x8000
  buffer_load_dwordx4 a[132:135], v1, s[20:23], s71 offen offset:1024
  v_cvt_pk_bf16_f32 v43, v70, v71
  v_cvt_pk_bf16_f32 v16, v64, v65
  v_cvt_pk_bf16_f32 v17, v66, v67
  v_cvt_pk_bf16_f32 v18, v68, v69
  v_cvt_pk_bf16_f32 v19, v70, v71
  v_permlane32_swap_b32 v40, v42
  v_permlane32_swap_b32 v41, v43
  s_add_u32 s72, s36, 0x8000
  buffer_load_dwordx4 a[136:139], v1, s[20:23], s72 offen offset:2048
  s_cmp_eq_u32 s44, 0
  s_cbranch_scc1 L_slow_33
  buffer_store_dwordx4 v[40:43], v1, s[20:23], s57 offen
L_join_34:
  v_add_f32 v44, v64, v65
  v_mul_f32 v45, v64, v64
  v_fmac_f32 v45, v65, v65
  v_add_f32 v44, v44, v66
  v_fmac_f32 v45, v66, v66
  v_add_f32 v44, v44, v67
  v_fmac_f32 v45, v67, v67
  v_add_f32 v44, v44, v68
  s_add_u32 s73, s36, 0x8000
  buffer_load_dwordx4 a[140:143], v1, s[20:23], s73 offen offset:3072
  v_fmac_f32 v45, v68, v68
  v_add_f32 v44, v44, v69
  v_fmac_f32 v45, v69, v69
  v_add_f32 v44, v44, v70
  v_fmac_f32 v45, v70, v70
  v_add_f32 v44, v44, v71
  v_fmac_f32 v45, v71, v71
  s_nop 1
  v_permlane32_swap_b32 v44, v45
  v_add_f32 v44, v44, v45
  s_add_u32 s70, s36, 0x9000
  buffer_load_dwordx4 a[144:147], v1, s[20:23], s70 offen offset:0
  s_cmp_eq_u32 s44, 0
  s_cbranch_scc1 L_slow_35
  buffer_store_dword v44, v4, s[20:23], s58 offen
L_join_36:
  s_add_u32 s71, s36, 0x2000
  buffer_load_dwordx4 a[32:35], v1, s[20:23], s71 offen offset:0
  ds_write_b128 v10, v[104:107] offset:24576
  ds_write_b128 v10, v[108:111] offset:25600
  ds_write_b128 v11, v[112:115] offset:24576
  ds_write_b128 v11, v[116:119] offset:25600
  ds_write_b128 v12, v[120:123] offset:24576
  ds_write_b128 v12, v[124:127] offset:25600
  v_dot2_f32_bf16 v96, v20, s60, v96
  v_dot2_f32_bf16 v97, v20, s61, v97
  v_dot2_f32_bf16 v98, v21, s60, v98
  v_dot2_f32_bf16 v99, v21, s61, v99
  v_dot2_f32_bf16 v100, v22, s60, v100
  v_dot2_f32_bf16 v101, v22, s61, v101
  v_dot2_f32_bf16 v102, v23, s60, v102
  v_dot2_f32_bf16 v103, v23, s61, v103
  s_waitcnt vmcnt(1) lgkmcnt(0)
  s_barrier
  ds_read_b128 v[104:107], v13 offset:24576
  ds_read_b128 v[108:111], v13 offset:25600
  ds_read_b128 v[112:115], v13 offset:26624
  ds_read_b128 v[116:119], v13 offset:27648
  ds_read_b128 v[120:123], v13 offset:28672
  ds_read_b128 v[124:127], v13 offset:29696
  s_cmp_lg_u32 s42, 0
  s_cbranch_scc1 L_pubskip_37
  s_lshl_b32 s56, s40, 7
  s_lshl_b32 s57, s41, 2
  s_add_u32 s56, s56, s57
  s_add_u32 s56, s56, 0x1800
  v_mov_b32 v8, s43
  s_mov_b64 exec, 1
  s_cmp_eq_u32 s44, 0
  s_cbranch_scc1 L_slow_38
  buffer_store_dword v8, v7, s[20:23], s56 offen
L_join_39:
  s_mov_b64 exec, -1
  s_nop 0
L_pubskip_37:
  s_add_u32 s57, s32, 0x826000
  s_add_u32 s58, s33, 0x10c3800
  s_waitcnt lgkmcnt(4)
  v_pk_add_f32 v[96:97], v[96:97], v[104:105]
  v_pk_add_f32 v[98:99], v[98:99], v[106:107]
  v_pk_add_f32 v[100:101], v[100:101], v[108:109]
  v_pk_add_f32 v[102:103], v[102:103], v[110:111]
  s_waitcnt lgkmcnt(2)
  v_pk_add_f32 v[96:97], v[96:97], v[112:113]
  v_pk_add_f32 v[98:99], v[98:99], v[114:115]
  v_pk_add_f32 v[100:101], v[100:101], v[116:117]
  v_pk_add_f32 v[102:103], v[102:103], v[118:119]
  s_waitcnt lgkmcnt(0)
  v_pk_add_f32 v[96:97], v[96:97], v[120:121]
  v_pk_add_f32 v[98:99], v[98:99], v[122:123]
  v_pk_add_f32 v[100:101], v[100:101], v[124:125]
  v_pk_add_f32 v[102:103], v[102:103], v[126:127]
  v_cvt_pk_bf16_f32 v48, v96, v97
  v_cvt_pk_bf16_f32 v49, v98, v99
  v_cvt_pk_bf16_f32 v50, v100, v101
  v_cvt_pk_bf16_f32 v51, v102, v103
  v_cvt_pk_bf16_f32 v20, v96, v97
  v_cvt_pk_bf16_f32 v21, v98, v99
  v_cvt_pk_bf16_f32 v22, v100, v101
  v_cvt_pk_bf16_f32 v23, v102, v103
  v_permlane32_swap_b32 v48, v50
  v_permlane32_swap_b32 v49, v51
  s_cmp_eq_u32 s44, 0
  s_cbranch_scc1 L_slow_40
  buffer_store_dwordx4 v[48:51], v1, s[20:23], s57 offen
L_join_41:
  v_dot2_f32_bf16 v52, v20, s62, 0
  v_dot2_f32_bf16 v53, v20, v20, 0
  v_dot2_f32_bf16 v52, v21, s62, v52
  v_dot2_f32_bf16 v53, v21, v21, v53
  v_dot2_f32_bf16 v52, v22, s62, v52
  v_dot2_f32_bf16 v53, v22, v22, v53
  v_dot2_f32_bf16 v52, v23, s62, v52
  v_dot2_f32_bf16 v53, v23, v23, v53
  s_nop 2
  v_permlane32_swap_b32 v52, v53
  v_add_f32 v52, v52, v53
  s_cmp_eq_u32 s44, 0
  s_cbranch_scc1 L_slow_42
  buffer_store_dword v52, v4, s[20:23], s58 offen
L_join_43:
  s_lshl_b32 s48, s40, 7
  s_add_u32 s48, s48, 0x1800
  s_mov_b64 exec, 0x3fff
  buffer_load_dword v10, v7, s[20:23], s48 offen sc1
  s_mov_b64 exec, -1
  s_lshl_b32 s93, s42, 2
  s_min_u32 s93, s93, 10
  s_lshl_b32 s93, s93, 10
  s_add_u32 s69, s39, s93
  s_add_u32 s69, s69, 0x818000
  s_add_u32 s80, s69, s38
  s_sub_u32 s81, s69, s38
  s_add_u32 s93, s93, 0x18400
  s_lshl_b32 s56, s41, 2
  s_add_u32 s56, s56, s42
  s_lshl_b32 s56, s56, 11
  s_add_u32 s78, s39, s56
  s_mul_i32 s56, s42, 28672
  s_add_u32 s56, s56, s39
  s_mul_i32 s79, s46, 0x1c000
  s_add_u32 s79, s79, 0x7c0000
  s_add_u32 s79, s79, s56
  s_mul_i32 s88, s46, 0x1c000
  s_add_u32 s88, s88, 0x7fc000
  s_add_u32 s88, s88, s56
  s_add_u32 s72, s36, 0x2000
  buffer_load_dwordx4 a[36:39], v1, s[20:23], s72 offen offset:1024
  buffer_load_dwordx4 a[40:43], v1, s[20:23], s72 offen offset:2048
  buffer_load_dwordx4 a[44:47], v1, s[20:23], s72 offen offset:3072
  s_add_u32 s73, s36, 0x9000
  buffer_load_dwordx4 a[148:151], v1, s[20:23], s73 offen offset:1024
  buffer_load_dwordx4 a[152:155], v1, s[20:23], s73 offen offset:2048
  buffer_load_dwordx4 a[156:159], v1, s[20:23], s73 offen offset:3072
  s_add_u32 s70, s36, 0xa000
  buffer_load_dwordx4 a[160:163], v1, s[20:23], s70 offen offset:0
  s_add_u32 s71, s36, 0x3000
  buffer_load_dwordx4 a[48:51], v1, s[20:23], s71 offen offset:0
L_gu0:
  s_waitcnt vmcnt(8)
  v_cmp_ne_u32 vcc, s43, v10
  s_nop 1
  s_and_b32 s56, vcc_lo, 0x3fff
  s_cbranch_scc1 L_fsp_46
L_fok_45:
  s_add_u32 s75, s80, 0x0
  s_add_u32 m0, s93, 0x0
  s_nop 0
  buffer_load_dwordx4 v1, s[20:23], s75 offen offset:0 sc1 lds
  buffer_load_dwordx4 v1, s[20:23], s75 offen offset:1024 sc1 lds
  buffer_load_dwordx4 v1, s[20:23], s75 offen offset:2048 sc1 lds
  buffer_load_dwordx4 v1, s[20:23], s75 offen offset:3072 sc1 lds
  s_waitcnt lgkmcnt(0)
  s_barrier
  s_cmp_lg_u32 s42, 0
  s_cbranch_scc1 L_pubskip_48
  s_lshl_b32 s56, s40, 7
  s_lshl_b32 s57, s41, 2
  s_add_u32 s56, s56, s57
  s_add_u32 s56, s56, 0x2000
  v_mov_b32 v8, s43
  s_mov_b64 exec, 1
  s_cmp_eq_u32 s44, 0
  s_cbranch_scc1 L_slow_49
  buffer_store_dword v8, v7, s[20:23], s56 offen
L_join_50:
  s_mov_b64 exec, -1
  s_nop 0
L_pubskip_48:
  s_add_u32 s76, s81, 0x3800
  s_add_u32 m0, s93, 0x3800
  s_nop 0
  buffer_load_dwordx4 v1, s[20:23], s76 offen offset:0 sc1 lds
  buffer_load_dwordx4 v1, s[20:23], s76 offen offset:1024 sc1 lds
  s_add_u32 s72, s36, 0x3000
  buffer_load_dwordx4 a[52:55], v1, s[20:23], s72 offen offset:1024
  s_add_u32 s73, s37, 0x3000
  buffer_load_dwordx4 a[56:59], v1, s[20:23], s73 offen offset:2048
  buffer_load_dwordx4 a[60:63], v1, s[20:23], s73 offen offset:3072
  s_add_u32 s70, s36, 0xa000
  buffer_load_dwordx4 a[164:167], v1, s[20:23], s70 offen offset:1024
  buffer_load_dwordx4 v1, s[20:23], s76 offen offset:2048 sc1 lds
  buffer_load_dwordx4 v1, s[20:23], s76 offen offset:3072 sc1 lds
  s_waitcnt vmcnt(8)
  s_barrier
  ds_read_b128 v[48:51], v2 offset:33792
  ds_read_b128 v[52:55], v2 offset:34816
  ds_read_b128 v[56:59], v2 offset:35840
  s_waitcnt lgkmcnt(2)
  v_mfma_f32_32x32x16_bf16 v[64:79], a[0:3], v[48:51], 0
  s_lshl_b32 s49, s40, 7
  s_add_u32 s49, s49, 0x2000
  s_mov_b64 exec, 0x3fff
  buffer_load_dword v12, v7, s[20:23], s49 offen sc1
  s_mov_b64 exec, -1
  s_nop 0
  v_mfma_f32_32x32x16_bf16 v[80:95], a[116:119], v[48:51], 0
  buffer_load_dwordx4 a[168:171], v1, s[20:23], s70 offen offset:2048
  ds_read_b128 v[60:63], v2 offset:36864
  s_waitcnt lgkmcnt(2)
  v_mfma_f32_32x32x16_bf16 v[64:79], a[4:7], v[52:55], v[64:79]
  s_add_u32 s71, s37, 0xa000
  buffer_load_dwordx4 a[172:175], v1, s[20:23], s71 offen offset:3072
  v_mfma_f32_32x32x16_bf16 v[80:95], a[120:123], v[52:55], v[80:95]
  s_add_u32 s77, s80, 0x7000
  s_add_u32 m0, s93, 0x7000
  s_nop 0
  buffer_load_dwordx4 v1, s[20:23], s77 offen offset:0 sc1 lds
  ds_read_b128 v[48:51], v2 offset:37888
  s_waitcnt lgkmcnt(2)
  v_mfma_f32_32x32x16_bf16 v[64:79], a[8:11], v[56:59], v[64:79]
  s_add_u32 s72, s37, 0xb000
  buffer_load_dwordx4 a[176:179], v1, s[20:23], s72 offen offset:0
  v_mfma_f32_32x32x16_bf16 v[80:95], a[124:127], v[56:59], v[80:95]
  s_add_u32 s73, s37, 0x4000
  buffer_load_dwordx4 a[64:67], v1, s[20:23], s73 offen offset:0
  ds_read_b128 v[52:55], v2 offset:38912
  s_waitcnt lgkmcnt(2)
  v_mfma_f32_32x32x16_bf16 v[64:79], a[12:15], v[60:63], v[64:79]
  buffer_load_dwordx4 a[68:71], v1, s[20:23], s73 offen offset:1024
  v_mfma_f32_32x32x16_bf16 v[80:95], a[128:131], v[60:63], v[80:95]
  buffer_load_dwordx4 v1, s[20:23], s77 offen offset:1024 sc1 lds
  ds_read_b128 v[56:59], v2 offset:39936
  s_waitcnt lgkmcnt(2)
  v_mfma_f32_32x32x16_bf16 v[64:79], a[16:19], v[48:51], v[64:79]
  buffer_load_dwordx4 a[72:75], v1, s[20:23], s73 offen offset:2048
  v_mfma_f32_32x32x16_bf16 v[80:95], a[132:135], v[48:51], v[80:95]
  buffer_load_dwordx4 a[76:79], v1, s[20:23], s73 offen offset:3072
  ds_read_b128 v[60:63], v2 offset:40960
  s_waitcnt lgkmcnt(2)
  v_mfma_f32_32x32x16_bf16 v[64:79], a[20:23], v[52:55], v[64:79]
  s_add_u32 s70, s37, 0xb000
  buffer_load_dwordx4 a[180:183], v1, s[20:23], s70 offen offset:1024
  v_mfma_f32_32x32x16_bf16 v[80:95], a[136:139], v[52:55], v[80:95]
  buffer_load_dwordx4 v1, s[20:23], s77 offen offset:2048 sc1 lds
  ds_read_b128 v[48:51], v2 offset:41984
  s_waitcnt lgkmcnt(2)
  v_mfma_f32_32x32x16_bf16 v[64:79], a[24:27], v[56:59], v[64:79]
  buffer_load_dwordx4 a[184:187], v1, s[20:23], s70 offen offset:2048
  v_mfma_f32_32x32x16_bf16 v[80:95], a[140:143], v[56:59], v[80:95]
  buffer_load_dwordx4 a[188:191], v1, s[20:23], s70 offen offset:3072
  ds_read_b128 v[52:55], v2 offset:43008
  s_waitcnt lgkmcnt(2)
  v_mfma_f32_32x32x16_bf16 v[64:79], a[28:31], v[60:63], v[64:79]
  s_add_u32 s71, s37, 0xc000
  buffer_load_dwordx4 a[192:195], v1, s[20:23], s71 offen offset:0
  v_mfma_f32_32x32x16_bf16 v[80:95], a[144:147], v[60:63], v[80:95]
  buffer_load_dwordx4 v1, s[20:23], s77 offen offset:3072 sc1 lds
  ds_read_b128 v[56:59], v2 offset:44032
  s_waitcnt vmcnt(15)
  v_cmp_ne_u32 vcc, s43, v12
  s_nop 1
  s_and_b32 s56, vcc_lo, 0x3fff
  s_cbranch_scc1 L_fsp_53
L_fok_52:
  s_waitcnt lgkmcnt(2)
  v_mfma_f32_32x32x16_bf16 v[64:79], a[32:35], v[48:51], v[64:79]
  s_lshl_b32 s91, s40, 2
  s_add_u32 s91, s91, s42
  s_mul_i32 s91, s91, 7168
  s_add_u32 s91, s91, 0x10c0000
  buffer_load_dwordx4 v[96:99], v5, s[20:23], s91 offen offset:0 sc1
  v_mfma_f32_32x32x16_bf16 v[80:95], a[148:151], v[48:51], v[80:95]
  buffer_load_dwordx4 v[100:103], v5, s[20:23], s91 offen offset:1024 sc1
  ds_read_b128 v[60:63], v2 offset:45056
  s_waitcnt lgkmcnt(2)
  v_mfma_f32_32x32x16_bf16 v[64:79], a[36:39], v[52:55], v[64:79]
  buffer_load_dwordx4 v[104:107], v5, s[20:23], s91 offen offset:2048 sc1
  v_mfma_f32_32x32x16_bf16 v[80:95], a[152:155], v[52:55], v[80:95]
  buffer_load_dwordx4 v[108:111], v5, s[20:23], s91 offen offset:3072 sc1
  ds_read_b128 v[48:51], v2 offset:46080
  s_waitcnt lgkmcnt(2)
  v_mfma_f32_32x32x16_bf16 v[64:79], a[40:43], v[56:59], v[64:79]
  s_add_u32 s91, s91, 4096
  buffer_load_dwordx4 v[112:115], v5, s[20:23], s91 offen offset:0 sc1
  v_mfma_f32_32x32x16_bf16 v[80:95], a[156:159], v[56:59], v[80:95]
  buffer_load_dwordx4 v[116:119], v5, s[20:23], s91 offen offset:1024 sc1
  s_barrier
  ds_read_b128 v[52:55], v2 offset:47104
  s_waitcnt lgkmcnt(2)
  v_mfma_f32_32x32x16_bf16 v[64:79], a[44:47], v[60:63], v[64:79]
  buffer_load_dwordx4 v[120:123], v5, s[20:23], s91 offen offset:2048 sc1
  v_mfma_f32_32x32x16_bf16 v[80:95], a[160:163], v[60:63], v[80:95]
  s_add_u32 s74, s81, 0xa800
  s_add_u32 m0, s93, 0xa800
  s_nop 0
  buffer_load_dwordx4 v1, s[20:23], s74 offen offset:0 sc1 lds
  ds_read_b128 v[56:59], v2 offset:48128
  s_waitcnt lgkmcnt(2)
  v_mfma_f32_32x32x16_bf16 v[64:79], a[48:51], v[48:51], v[64:79]
  s_add_u32 s72, s37, 0x5000
  buffer_load_dwordx4 a[80:83], v1, s[20:23], s72 offen offset:0
  v_mfma_f32_32x32x16_bf16 v[80:95], a[164:167], v[48:51], v[80:95]
  buffer_load_dwordx4 a[84:87], v1, s[20:23], s72 offen offset:1024
  ds_read_b128 v[60:63], v2 offset:49152
  s_waitcnt vmcnt(24) lgkmcnt(2)
  v_mfma_f32_32x32x16_bf16 v[64:79], a[52:55], v[52:55], v[64:79]
  buffer_load_dwordx4 a[88:91], v1, s[20:23], s72 offen offset:2048
  v_mfma_f32_32x32x16_bf16 v[80:95], a[168:171], v[52:55], v[80:95]
  buffer_load_dwordx4 v1, s[20:23], s74 offen offset:1024 sc1 lds
  ds_read_b128 v[48:51], v2 offset:50176
  s_waitcnt vmcnt(25) lgkmcnt(2)
  v_mfma_f32_32x32x16_bf16 v[64:79], a[56:59], v[56:59], v[64:79]
  buffer_load_dwordx4 a[92:95], v1, s[20:23], s72 offen offset:3072
  v_mfma_f32_32x32x16_bf16 v[80:95], a[172:175], v[56:59], v[80:95]
  s_add_u32 s73, s37, 0xc000
  buffer_load_dwordx4 a[196:199], v1, s[20:23], s73 offen offset:1024
  ds_read_b128 v[52:55], v2 offset:51200
  s_waitcnt vmcnt(25) lgkmcnt(2)
  v_mfma_f32_32x32x16_bf16 v[64:79], a[60:63], v[60:63], v[64:79]
  buffer_load_dwordx4 a[200:203], v1, s[20:23], s73 offen offset:2048
  v_mfma_f32_32x32x16_bf16 v[80:95], a[176:179], v[60:63], v[80:95]
  buffer_load_dwordx4 v1, s[20:23], s74 offen offset:2048 sc1 lds
  ds_read_b128 v[56:59], v2 offset:52224
  s_waitcnt vmcnt(21) lgkmcnt(2)
  v_mfma_f32_32x32x16_bf16 v[64:79], a[64:67], v[48:51], v[64:79]
  buffer_load_dwordx4 a[204:207], v1, s[20:23], s73 offen offset:3072
  v_mfma_f32_32x32x16_bf16 v[80:95], a[180:183], v[48:51], v[80:95]
  s_add_u32 s70, s37, 0xd000
  buffer_load_dwordx4 a[208:211], v1, s[20:23], s70 offen offset:0
  ds_read_b128 v[60:63], v2 offset:53248
  s_waitcnt vmcnt(21) lgkmcnt(2)
  v_mfma_f32_32x32x16_bf16 v[64:79], a[68:71], v[52:55], v[64:79]
  s_add_u32 s71, s37, 0x6000
  buffer_load_dwordx4 a[96:99], v1, s[20:23], s71 offen offset:0
  v_mfma_f32_32x32x16_bf16 v[80:95], a[184:187], v[52:55], v[80:95]
  buffer_load_dwordx4 v1, s[20:23], s74 offen offset:3072 sc1 lds
  ds_read_b128 v[48:51], v2 offset:54272
  s_waitcnt vmcnt(22) lgkmcnt(2)
  v_mfma_f32_32x32x16_bf16 v[64:79], a[72:75], v[56:59], v[64:79]
  buffer_load_dwordx4 a[100:103], v1, s[20:23], s71 offen offset:1024
  v_mfma_f32_32x32x16_bf16 v[80:95], a[188:191], v[56:59], v[80:95]
  buffer_load_dwordx4 a[104:107], v1, s[20:23], s71 offen offset:2048
  ds_read_b128 v[52:55], v2 offset:55296
  s_waitcnt vmcnt(23) lgkmcnt(2)
  v_mfma_f32_32x32x16_bf16 v[64:79], a[76:79], v[60:63], v[64:79]
  buffer_load_dwordx4 a[108:111], v1, s[20:23], s71 offen offset:3072
  v_mfma_f32_32x32x16_bf16 v[80:95], a[192:195], v[60:63], v[80:95]
  s_add_u32 s72, s37, 0xd000
  buffer_load_dwordx4 a[212:215], v1, s[20:23], s72 offen offset:1024
  ds_read_b128 v[56:59], v2 offset:56320
  s_mov_b32 s63, 0
L_shpoll_55:
  v_cmp_ne_u32 vcc, s43, v38
  s_add_u32 s63, s63, 1
  s_nop 1
  s_cbranch_vccz L_shdone_56
  buffer_load_dword v38, v39, s[20:23], 0 offen sc1
  s_waitcnt vmcnt(0)
  s_cmp_lt_u32 s63, 262144
  s_cbranch_scc1 L_shpoll_55
L_shdone_56:
  s_waitcnt vmcnt(10) lgkmcnt(2)
  v_mfma_f32_32x32x16_bf16 v[64:79], a[80:83], v[48:51], v[64:79]
  buffer_load_dwordx4 a[216:219], v1, s[20:23], s72 offen offset:2048
  v_add_f32 v96, v96, v98
  v_add_f32 v97, v97, v99
  v_add_f32 v96, v96, v100
  v_add_f32 v97, v97, v101
  v_mfma_f32_32x32x16_bf16 v[80:95], a[196:199], v[48:51], v[80:95]
  buffer_load_dwordx4 a[220:223], v1, s[20:23], s72 offen offset:3072
  ds_read_b128 v[60:63], v2 offset:57344
  v_add_f32 v96, v96, v102
  v_add_f32 v97, v97, v103
  v_add_f32 v96, v96, v104
  v_add_f32 v97, v97, v105
  s_waitcnt vmcnt(11) lgkmcnt(2)
  v_mfma_f32_32x32x16_bf16 v[64:79], a[84:87], v[52:55], v[64:79]
  s_add_u32 s73, s37, 0xe000
  buffer_load_dwordx4 a[224:227], v1, s[20:23], s73 offen offset:0
  v_add_f32 v96, v96, v106
  v_add_f32 v97, v97, v107
  v_add_f32 v96, v96, v108
  v_add_f32 v97, v97, v109
  v_mfma_f32_32x32x16_bf16 v[80:95], a[200:203], v[52:55], v[80:95]
  ds_read_b128 v[48:51], v2 offset:58368
  v_add_f32 v96, v96, v110
  v_add_f32 v97, v97, v111
  v_add_f32 v96, v96, v112
  v_add_f32 v97, v97, v113
  s_waitcnt vmcnt(10) lgkmcnt(2)
  v_mfma_f32_32x32x16_bf16 v[64:79], a[88:91], v[56:59], v[64:79]
  buffer_load_dwordx4 v[128:131], v14, s[20:23], s68 offen offset:0
  v_add_f32 v96, v96, v114
  v_add_f32 v97, v97, v115
  v_add_f32 v96, v96, v116
  v_add_f32 v97, v97, v117
  v_mfma_f32_32x32x16_bf16 v[80:95], a[204:207], v[56:59], v[80:95]
  ds_read_b128 v[52:55], v2 offset:59392
  v_add_f32 v96, v96, v118
  v_add_f32 v97, v97, v119
  v_add_f32 v96, v96, v120
  v_add_f32 v97, v97, v121
  s_waitcnt vmcnt(10) lgkmcnt(2)
  v_mfma_f32_32x32x16_bf16 v[64:79], a[92:95], v[60:63], v[64:79]
  buffer_load_dwordx4 v[136:139], v14, s[20:23], s68 offen offset:1024
  v_add_f32 v96, v96, v122
  v_add_f32 v97, v97, v123
  s_nop 1
  v_permlane32_swap_b32 v96, v97
  v_add_f32 v96, v96, v97
  v_mfma_f32_32x32x16_bf16 v[80:95], a[208:211], v[60:63], v[80:95]
  ds_read_b128 v[56:59], v2 offset:60416
  v_mov_b32 v97, v96
  s_nop 1
  v_permlane32_swap_b32 v96, v97
  v_mul_f32 v96, 0x3b124925, v96
  v_mul_f32 v97, 0x3b124925, v97
  s_waitcnt vmcnt(5) lgkmcnt(2)
  v_mfma_f32_32x32x16_bf16 v[64:79], a[96:99], v[48:51], v[64:79]
  buffer_load_dwordx4 v[144:147], v14, s[20:23], s68 offen offset:2048
  v_fma_f32 v97, -v96, v96, v97
  v_max_f32 v97, 0, v97
  v_cvt_pk_bf16_f32 v24, -v96, -v96
  v_cvt_pk_bf16_f32 v28, v97, v97
  v_mfma_f32_32x32x16_bf16 v[80:95], a[212:215], v[48:51], v[80:95]
  s_barrier
  ds_read_b128 v[60:63], v2 offset:61440
  v_and_b32 v28, 0xffff0000, v28
  v_add_f32 v28, 0x3727c5ac, v28
  v_cvt_pk_bf16_f32 v28, v28, v28
  v_and_b32 v28, 0xffff0000, v28
  s_waitcnt vmcnt(5) lgkmcnt(2)
  v_mfma_f32_32x32x16_bf16 v[64:79], a[100:103], v[52:55], v[64:79]
  buffer_load_dwordx4 v[152:155], v14, s[20:23], s68 offen offset:3072
  v_sqrt_f32 v28, v28
  s_nop 0
  v_cvt_pk_bf16_f32 v28, v28, v28
  v_and_b32 v27, 0xffff0000, v28
  v_mfma_f32_32x32x16_bf16 v[80:95], a[216:219], v[52:55], v[80:95]
  s_add_u32 s75, s80, 0xe000
  s_add_u32 m0, s93, 0x0
  s_nop 0
  buffer_load_dwordx4 v1, s[20:23], s75 offen offset:0 sc1 lds
  ds_read_b128 v[48:51], v2 offset:62464
  v_lshrrev_b32 v25, 16, v28
  v_rcp_f32 v26, v27
  s_waitcnt vmcnt(6) lgkmcnt(2)
  v_mfma_f32_32x32x16_bf16 v[64:79], a[104:107], v[56:59], v[64:79]
  buffer_load_dwordx4 v[132:135], v14, s[20:23], s83 offen offset:0
  v_mul_f32 v32, 0xc0135761, v26
  v_mul_f32 v33, v26, v26
  v_mul_f32 v33, v33, v32
  v_mul_f32 v33, 0x3d372713, v33
  v_mfma_f32_32x32x16_bf16 v[80:95], a[220:223], v[56:59], v[80:95]
  buffer_load_dwordx4 v1, s[20:23], s75 offen offset:1024 sc1 lds
  ds_read_b128 v[52:55], v2 offset:63488
  v_mul_f32 v34, v27, v27
  v_mov_b32 v35, 0
  v_mov_b32 v26, 0
  s_waitcnt vmcnt(7) lgkmcnt(2)
  v_mfma_f32_32x32x16_bf16 v[64:79], a[108:111], v[60:63], v[64:79]
  buffer_load_dwordx4 v[140:143], v14, s[20:23], s83 offen offset:1024
  v_mov_b32 v27, 0
  s_lshl_b32 s56, s42, 11
  s_add_u32 s56, s56, 0x16400
  v_add_u32 v8, s56, v1
  v_mfma_f32_32x32x16_bf16 v[80:95], a[224:227], v[60:63], v[80:95]
  buffer_load_dwordx4 v1, s[20:23], s75 offen offset:2048 sc1 lds
  ds_read_b128 v[56:59], v2 offset:64512
  ds_write_b128 v8, v[24:27]
  ds_write_b128 v8, v[32:35] offset:1024
  s_waitcnt lgkmcnt(0)
  s_barrier
  v_mfma_f32_32x32x16_bf16 v[96:111], a[0:3], v[48:51], 0
  buffer_load_dwordx4 v[148:151], v14, s[20:23], s83 offen offset:2048
  v_mfma_f32_32x32x16_bf16 v[112:127], a[116:119], v[48:51], 0
  buffer_load_dwordx4 v1, s[20:23], s75 offen offset:3072 sc1 lds
  ds_read_b128 v[60:63], v2 offset:25600
  v_mfma_f32_32x32x16_bf16 v[96:111], a[4:7], v[52:55], v[96:111]
  buffer_load_dwordx4 v[156:159], v14, s[20:23], s83 offen offset:3072
  v_mfma_f32_32x32x16_bf16 v[112:127], a[120:123], v[52:55], v[112:127]
  ds_read_b128 v[48:51], v3 offset:0
  v_mfma_f32_32x32x16_bf16 v[96:111], a[8:11], v[56:59], v[96:111]
  s_add_u32 s70, s68, 0x1000
  buffer_load_dwordx4 v[160:163], v14, s[20:23], s70 offen offset:0
  v_mfma_f32_32x32x16_bf16 v[112:127], a[124:127], v[56:59], v[112:127]
  ds_read_b128 v[52:55], v3 offset:1024
  s_waitcnt lgkmcnt(2)
  v_mfma_f32_32x32x16_bf16 v[64:79], a[112:115], v[60:63], v[64:79]
  buffer_load_dwordx4 v[168:171], v14, s[20:23], s70 offen offset:1024
  v_mfma_f32_32x32x16_bf16 v[80:95], a[228:231], v[60:63], v[80:95]
  ds_read_b128 v[56:59], v3 offset:2048
  s_waitcnt lgkmcnt(2)
  v_mfma_f32_32x32x16_bf16 v[96:111], a[12:15], v[48:51], v[96:111]
  buffer_load_dwordx4 v[176:179], v14, s[20:23], s70 offen offset:2048
  v_mfma_f32_32x32x16_bf16 v[112:127], a[128:131], v[48:51], v[112:127]
  ds_read_b128 v[60:63], v3 offset:3072
  s_waitcnt lgkmcnt(2)
  v_mfma_f32_32x32x16_bf16 v[96:111], a[16:19], v[52:55], v[96:111]
  buffer_load_dwordx4 v[184:187], v14, s[20:23], s70 offen offset:3072
  ds_read_b128 v[40:43], v2 offset:26624
  s_waitcnt lgkmcnt(0)
  v_mul_f32 v8, v64, v64
  v_mul_f32 v9, v65, v65
  v_mul_f32 v10, v66, v66
  v_mfma_f32_32x32x16_bf16 v[112:127], a[132:135], v[52:55], v[112:127]
  ds_read_b128 v[48:51], v3 offset:4096
  v_mul_f32 v11, v67, v67
  v_fma_f32 v8, v8, v41, v40
  v_fma_f32 v9, v9, v41, v40
  v_fma_f32 v10, v10, v41, v40
  v_mfma_f32_32x32x16_bf16 v[96:111], a[20:23], v[56:59], v[96:111]
  v_fma_f32 v11, v11, v41, v40
  v_mul_f32 v8, v8, v64
  v_mul_f32 v9, v9, v65
  v_mul_f32 v10, v10, v66
  v_mfma_f32_32x32x16_bf16 v[112:127], a[136:139], v[56:59], v[112:127]
  ds_read_b128 v[52:55], v3 offset:5120
  v_mul_f32 v11, v11, v67
  v_exp_f32 v8, v8
  v_exp_f32 v9, v9
  v_mfma_f32_32x32x16_bf16 v[96:111], a[24:27], v[60:63], v[96:111]
  s_add_u32 s71, s83, 0x1000
  buffer_load_dwordx4 v[164:167], v14, s[20:23], s71 offen offset:0
  v_exp_f32 v10, v10
  v_exp_f32 v11, v11
  v_mfma_f32_32x32x16_bf16 v[112:127], a[140:143], v[60:63], v[112:127]
  ds_read_b128 v[56:59], v3 offset:6144
  v_mul_f32 v80, v80, v64
  v_mul_f32 v81, v81, v65
  v_mul_f32 v82, v82, v66
  v_mul_f32 v83, v83, v67
  s_waitcnt lgkmcnt(2)
  v_mfma_f32_32x32x16_bf16 v[96:111], a[28:31], v[48:51], v[96:111]
  v_fma_f32 v8, v8, v42, v42
  v_fma_f32 v9, v9, v42, v42
  v_fma_f32 v10, v10, v42, v42
  v_fma_f32 v11, v11, v42, v42
  v_mfma_f32_32x32x16_bf16 v[112:127], a[144:147], v[48:51], v[112:127]
  ds_read_b128 v[60:63], v3 offset:7168
  v_rcp_f32 v8, v8
  v_rcp_f32 v9, v9
  s_waitcnt lgkmcnt(2)
  v_mfma_f32_32x32x16_bf16 v[96:111], a[32:35], v[52:55], v[96:111]
  buffer_load_dwordx4 v[172:175], v14, s[20:23], s71 offen offset:1024
  v_rcp_f32 v10, v10
  v_rcp_f32 v11, v11
  v_mfma_f32_32x32x16_bf16 v[112:127], a[148:151], v[52:55], v[112:127]
  ds_read_b128 v[48:51], v3 offset:8192
  v_mul_f32 v80, v80, v8
  v_mul_f32 v81, v81, v9
  v_mul_f32 v82, v82, v10
  v_mul_f32 v83, v83, v11
  s_waitcnt lgkmcnt(2)
  v_mfma_f32_32x32x16_bf16 v[96:111], a[36:39], v[56:59], v[96:111]
  v_cvt_pk_bf16_f32 v24, v80, v81
  v_cvt_pk_bf16_f32 v25, v82, v83
  v_mul_f32 v8, v68, v68
  v_mul_f32 v9, v69, v69
  v_mfma_f32_32x32x16_bf16 v[112:127], a[152:155], v[56:59], v[112:127]
  ds_read_b128 v[52:55], v3 offset:9216
  v_mul_f32 v10, v70, v70
  v_mul_f32 v11, v71, v71
  v_fma_f32 v8, v8, v41, v40
  v_fma_f32 v9, v9, v41, v40
  s_waitcnt lgkmcnt(2)
  v_mfma_f32_32x32x16_bf16 v[96:111], a[40:43], v[60:63], v[96:111]
  buffer_load_dwordx4 v[180:183], v14, s[20:23], s71 offen offset:2048
  v_fma_f32 v10, v10, v41, v40
  v_fma_f32 v11, v11, v41, v40
  v_mul_f32 v8, v8, v68
  v_mul_f32 v9, v9, v69
  v_mfma_f32_32x32x16_bf16 v[112:127], a[156:159], v[60:63], v[112:127]
  s_barrier
  ds_read_b128 v[56:59], v3 offset:10240
  v_mul_f32 v10, v10, v70
  v_mul_f32 v11, v11, v71
  v_exp_f32 v8, v8
  s_waitcnt lgkmcnt(2)
  v_mfma_f32_32x32x16_bf16 v[96:111], a[44:47], v[48:51], v[96:111]
  v_exp_f32 v9, v9
  v_exp_f32 v10, v10
  v_mfma_f32_32x32x16_bf16 v[112:127], a[160:163], v[48:51], v[112:127]
  s_add_u32 s76, s81, 0x11800
  s_add_u32 m0, s93, 0x3800
  s_nop 0
  buffer_load_dwordx4 v1, s[20:23], s76 offen offset:0 sc1 lds
  ds_read_b128 v[60:63], v3 offset:11264
  v_exp_f32 v11, v11
  v_mul_f32 v84, v84, v68
  s_waitcnt lgkmcnt(2)
  v_mfma_f32_32x32x16_bf16 v[96:111], a[48:51], v[52:55], v[96:111]
  buffer_load_dwordx4 v[188:191], v14, s[20:23], s71 offen offset:3072
  v_mul_f32 v85, v85, v69
  v_mul_f32 v86, v86, v70
  v_mul_f32 v87, v87, v71
  v_fma_f32 v8, v8, v42, v42
  v_mfma_f32_32x32x16_bf16 v[112:127], a[164:167], v[52:55], v[112:127]
  buffer_load_dwordx4 v1, s[20:23], s76 offen offset:1024 sc1 lds
  ds_read_b128 v[48:51], v3 offset:12288
  v_fma_f32 v9, v9, v42, v42
  v_fma_f32 v10, v10, v42, v42
  v_fma_f32 v11, v11, v42, v42
  s_waitcnt lgkmcnt(2)
  v_mfma_f32_32x32x16_bf16 v[96:111], a[52:55], v[56:59], v[96:111]
  v_rcp_f32 v8, v8
  v_rcp_f32 v9, v9
  v_mfma_f32_32x32x16_bf16 v[112:127], a[168:171], v[56:59], v[112:127]
  buffer_load_dwordx4 v1, s[20:23], s76 offen offset:2048 sc1 lds
  ds_read_b128 v[52:55], v3 offset:13312
  v_rcp_f32 v10, v10
  v_rcp_f32 v11, v11
  s_waitcnt lgkmcnt(2)
  v_mfma_f32_32x32x16_bf16 v[96:111], a[56:59], v[60:63], v[96:111]
  s_add_u32 s72, s68, 0x2000
  buffer_load_dwordx4 v[192:195], v14, s[20:23], s72 offen offset:0
  v_mul_f32 v84, v84, v8
  v_mul_f32 v85, v85, v9
  v_mul_f32 v86, v86, v10
  v_mul_f32 v87, v87, v11
  v_mfma_f32_32x32x16_bf16 v[112:127], a[172:175], v[60:63], v[112:127]
  buffer_load_dwordx4 v1, s[20:23], s76 offen offset:3072 sc1 lds
  ds_read_b128 v[56:59], v3 offset:14336
  v_cvt_pk_bf16_f32 v26, v84, v85
  v_cvt_pk_bf16_f32 v27, v86, v87
  v_mul_f32 v8, v72, v72
  s_waitcnt lgkmcnt(2)
  v_mfma_f32_32x32x16_bf16 v[96:111], a[60:63], v[48:51], v[96:111]
  v_mul_f32 v9, v73, v73
  v_mul_f32 v10, v74, v74
  v_mul_f32 v11, v75, v75
  v_fma_f32 v8, v8, v41, v40
  v_mfma_f32_32x32x16_bf16 v[112:127], a[176:179], v[48:51], v[112:127]
  ds_read_b128 v[60:63], v3 offset:15360
  v_fma_f32 v9, v9, v41, v40
  v_fma_f32 v10, v10, v41, v40
  v_fma_f32 v11, v11, v41, v40
  v_mul_f32 v8, v8, v72
  s_waitcnt lgkmcnt(2)
  v_mfma_f32_32x32x16_bf16 v[96:111], a[64:67], v[52:55], v[96:111]
  buffer_load_dwordx4 v[200:203], v14, s[20:23], s72 offen offset:1024
  v_mul_f32 v9, v9, v73
  v_mul_f32 v10, v10, v74
  v_mul_f32 v11, v11, v75
  v_exp_f32 v8, v8
  v_mfma_f32_32x32x16_bf16 v[112:127], a[180:183], v[52:55], v[112:127]
  ds_read_b128 v[48:51], v3 offset:16384
  v_exp_f32 v9, v9
  v_exp_f32 v10, v10
  s_waitcnt lgkmcnt(2)
  v_mfma_f32_32x32x16_bf16 v[96:111], a[68:71], v[56:59], v[96:111]
  s_add_u32 s50, s78, 0x7c0000
  buffer_store_dwordx4 v[24:27], v1, s[20:23], s50 offen offset:0 sc1
  v_exp_f32 v11, v11
  v_mfma_f32_32x32x16_bf16 v[112:127], a[184:187], v[56:59], v[112:127]
  ds_read_b128 v[52:55], v3 offset:17408
  v_mul_f32 v88, v88, v72
  v_mul_f32 v89, v89, v73
  v_mul_f32 v90, v90, v74
  v_mul_f32 v91, v91, v75
  s_waitcnt lgkmcnt(2)
  v_mfma_f32_32x32x16_bf16 v[96:111], a[72:75], v[60:63], v[96:111]
  buffer_load_dwordx4 v[208:211], v14, s[20:23], s72 offen offset:2048
  v_fma_f32 v8, v8, v42, v42
  v_fma_f32 v9, v9, v42, v42
  v_fma_f32 v10, v10, v42, v42
  v_fma_f32 v11, v11, v42, v42
  v_mfma_f32_32x32x16_bf16 v[112:127], a[188:191], v[60:63], v[112:127]
  ds_read_b128 v[56:59], v3 offset:18432
  v_rcp_f32 v8, v8
  v_rcp_f32 v9, v9
  s_waitcnt lgkmcnt(2)
  v_mfma_f32_32x32x16_bf16 v[96:111], a[76:79], v[48:51], v[96:111]
  v_rcp_f32 v10, v10
  v_rcp_f32 v11, v11
  v_mfma_f32_32x32x16_bf16 v[112:127], a[192:195], v[48:51], v[112:127]
  ds_read_b128 v[60:63], v3 offset:19456
  v_mul_f32 v88, v88, v8
  v_mul_f32 v89, v89, v9
  v_mul_f32 v90, v90, v10
  v_mul_f32 v91, v91, v11
  s_waitcnt lgkmcnt(2)
  v_mfma_f32_32x32x16_bf16 v[96:111], a[80:83], v[52:55], v[96:111]
  buffer_load_dwordx4 v[216:219], v14, s[20:23], s72 offen offset:3072
  v_cvt_pk_bf16_f32 v28, v88, v89
  v_cvt_pk_bf16_f32 v29, v90, v91
  v_mul_f32 v8, v76, v76
  v_mul_f32 v9, v77, v77
  v_mfma_f32_32x32x16_bf16 v[112:127], a[196:199], v[52:55], v[112:127]
  ds_read_b128 v[48:51], v3 offset:20480
  v_mul_f32 v10, v78, v78
  v_mul_f32 v11, v79, v79
  v_fma_f32 v8, v8, v41, v40
  v_fma_f32 v9, v9, v41, v40
  s_waitcnt lgkmcnt(2)
  v_mfma_f32_32x32x16_bf16 v[96:111], a[84:87], v[56:59], v[96:111]
  v_fma_f32 v10, v10, v41, v40
  v_fma_f32 v11, v11, v41, v40
  v_mul_f32 v8, v8, v76
  v_mul_f32 v9, v9, v77
  v_mfma_f32_32x32x16_bf16 v[112:127], a[200:203], v[56:59], v[112:127]
  ds_read_b128 v[52:55], v3 offset:21504
  v_mul_f32 v10, v10, v78
  v_mul_f32 v11, v11, v79
  v_exp_f32 v8, v8
  s_waitcnt lgkmcnt(2)
  v_mfma_f32_32x32x16_bf16 v[96:111], a[88:91], v[60:63], v[96:111]
  s_add_u32 s73, s83, 0x2000
  buffer_load_dwordx4 v[196:199], v14, s[20:23], s73 offen offset:0
  v_exp_f32 v9, v9
  v_exp_f32 v10, v10
  v_mfma_f32_32x32x16_bf16 v[112:127], a[204:207], v[60:63], v[112:127]
  ds_read_b128 v[56:59], v3 offset:22528
  v_exp_f32 v11, v11
  v_mul_f32 v92, v92, v76
  v_mul_f32 v93, v93, v77
  s_waitcnt lgkmcnt(2)
  v_mfma_f32_32x32x16_bf16 v[96:111], a[92:95], v[48:51], v[96:111]
  v_mul_f32 v94, v94, v78
  v_mul_f32 v95, v95, v79
  v_fma_f32 v8, v8, v42, v42
  v_fma_f32 v9, v9, v42, v42
  v_mfma_f32_32x32x16_bf16 v[112:127], a[208:211], v[48:51], v[112:127]
  ds_read_b128 v[60:63], v3 offset:23552
  v_fma_f32 v10, v10, v42, v42
  v_fma_f32 v11, v11, v42, v42
  v_rcp_f32 v8, v8
  s_waitcnt lgkmcnt(2)
  v_mfma_f32_32x32x16_bf16 v[96:111], a[96:99], v[52:55], v[96:111]
  buffer_load_dwordx4 v[204:207], v14, s[20:23], s73 offen offset:1024
  v_rcp_f32 v9, v9
  v_rcp_f32 v10, v10
  v_mfma_f32_32x32x16_bf16 v[112:127], a[212:215], v[52:55], v[112:127]
  s_waitcnt vmcnt(20)
  s_barrier
  ds_read_b128 v[48:51], v3 offset:24576
  v_rcp_f32 v11, v11
  v_mul_f32 v92, v92, v8
  v_mul_f32 v93, v93, v9
  s_waitcnt lgkmcnt(2)
  v_mfma_f32_32x32x16_bf16 v[96:111], a[100:103], v[56:59], v[96:111]
  v_mul_f32 v94, v94, v10
  v_mul_f32 v95, v95, v11
  v_cvt_pk_bf16_f32 v30, v92, v93
  v_cvt_pk_bf16_f32 v31, v94, v95
  v_mfma_f32_32x32x16_bf16 v[112:127], a[216:219], v[56:59], v[112:127]
  s_add_u32 s77, s80, 0x15000
  s_add_u32 m0, s93, 0x7000
  s_nop 0
  buffer_load_dwordx4 v1, s[20:23], s77 offen offset:0 sc1 lds
  ds_read_b128 v[52:55], v2 offset:27648
  s_waitcnt lgkmcnt(2)
  v_mfma_f32_32x32x16_bf16 v[96:111], a[104:107], v[60:63], v[96:111]
  buffer_load_dwordx4 v[212:215], v14, s[20:23], s73 offen offset:2048
  v_mfma_f32_32x32x16_bf16 v[112:127], a[220:223], v[60:63], v[112:127]
  buffer_load_dwordx4 v1, s[20:23], s77 offen offset:1024 sc1 lds
  ds_read_b128 v[56:59], v2 offset:33792
  s_waitcnt lgkmcnt(2)
  v_mfma_f32_32x32x16_bf16 v[96:111], a[108:111], v[48:51], v[96:111]
  v_mfma_f32_32x32x16_bf16 v[112:127], a[224:227], v[48:51], v[112:127]
  buffer_load_dwordx4 v1, s[20:23], s77 offen offset:2048 sc1 lds
  ds_read_b128 v[60:63], v2 offset:34816
  s_waitcnt lgkmcnt(2)
  v_mfma_f32_32x32x16_bf16 v[96:111], a[112:115], v[52:55], v[96:111]
  s_add_u32 s51, s78, 0x7c0000
  buffer_store_dwordx4 v[28:31], v1, s[20:23], s51 offen offset:1024 sc1
  v_mfma_f32_32x32x16_bf16 v[112:127], a[228:231], v[52:55], v[112:127]
  buffer_load_dwordx4 v1, s[20:23], s77 offen offset:3072 sc1 lds
  ds_read_b128 v[48:51], v2 offset:35840
  s_waitcnt lgkmcnt(2)
  v_mfma_f32_32x32x16_bf16 v[64:79], a[0:3], v[56:59], 0
  buffer_load_dwordx4 v[220:223], v14, s[20:23], s73 offen offset:3072
  v_mfma_f32_32x32x16_bf16 v[80:95], a[116:119], v[56:59], 0
  ds_read_b128 v[52:55], v2 offset:36864
  s_waitcnt lgkmcnt(2)
  v_mfma_f32_32x32x16_bf16 v[64:79], a[4:7], v[60:63], v[64:79]
  s_add_u32 s70, s68, 0x3000
  buffer_load_dwordx4 v[224:227], v14, s[20:23], s70 offen offset:0
  v_mfma_f32_32x32x16_bf16 v[80:95], a[120:123], v[60:63], v[80:95]
  ds_read_b128 v[56:59], v2 offset:37888
  s_waitcnt lgkmcnt(2)
  v_mfma_f32_32x32x16_bf16 v[64:79], a[8:11], v[48:51], v[64:79]
  ds_read_b128 v[44:47], v2 offset:28672
  s_waitcnt lgkmcnt(0)
  v_mul_f32 v8, v96, v96
  v_mul_f32 v9, v97, v97
  v_mul_f32 v10, v98, v98
  v_mfma_f32_32x32x16_bf16 v[80:95], a[124:127], v[48:51], v[80:95]
  ds_read_b128 v[60:63], v2 offset:38912
  v_mul_f32 v11, v99, v99
  v_fma_f32 v8, v8, v45, v44
  v_fma_f32 v9, v9, v45, v44
  v_mfma_f32_32x32x16_bf16 v[64:79], a[12:15], v[52:55], v[64:79]
  buffer_load_dwordx4 v[232:235], v14, s[20:23], s70 offen offset:1024
  v_fma_f32 v10, v10, v45, v44
  v_fma_f32 v11, v11, v45, v44
  v_mul_f32 v8, v8, v96
  v_mul_f32 v9, v9, v97
  v_mfma_f32_32x32x16_bf16 v[80:95], a[128:131], v[52:55], v[80:95]
  ds_read_b128 v[48:51], v2 offset:39936
  v_mul_f32 v10, v10, v98
  v_mul_f32 v11, v11, v99
  v_exp_f32 v8, v8
  v_mfma_f32_32x32x16_bf16 v[64:79], a[16:19], v[56:59], v[64:79]
  v_exp_f32 v9, v9
  v_exp_f32 v10, v10
  v_mfma_f32_32x32x16_bf16 v[80:95], a[132:135], v[56:59], v[80:95]
  ds_read_b128 v[52:55], v2 offset:40960
  v_exp_f32 v11, v11
  v_mul_f32 v112, v112, v96
  s_waitcnt lgkmcnt(2)
  v_mfma_f32_32x32x16_bf16 v[64:79], a[20:23], v[60:63], v[64:79]
  buffer_load_dwordx4 v[240:243], v14, s[20:23], s70 offen offset:2048
  v_mul_f32 v113, v113, v97
  v_mul_f32 v114, v114, v98
  v_mul_f32 v115, v115, v99
  v_fma_f32 v8, v8, v46, v46
  v_mfma_f32_32x32x16_bf16 v[80:95], a[136:139], v[60:63], v[80:95]
  ds_read_b128 v[56:59], v2 offset:41984
  v_fma_f32 v9, v9, v46, v46
  v_fma_f32 v10, v10, v46, v46
  v_fma_f32 v11, v11, v46, v46
  s_waitcnt lgkmcnt(2)
  v_mfma_f32_32x32x16_bf16 v[64:79], a[24:27], v[48:51], v[64:79]
  v_rcp_f32 v8, v8
  v_rcp_f32 v9, v9
  v_mfma_f32_32x32x16_bf16 v[80:95], a[140:143], v[48:51], v[80:95]
  ds_read_b128 v[60:63], v2 offset:43008
  v_rcp_f32 v10, v10
  v_rcp_f32 v11, v11
  s_waitcnt lgkmcnt(2)
  v_mfma_f32_32x32x16_bf16 v[64:79], a[28:31], v[52:55], v[64:79]
  buffer_load_dwordx4 v[248:251], v14, s[20:23], s70 offen offset:3072
  v_mul_f32 v112, v112, v8
  v_mul_f32 v113, v113, v9
  v_mul_f32 v114, v114, v10
  v_mul_f32 v115, v115, v11
  v_mfma_f32_32x32x16_bf16 v[80:95], a[144:147], v[52:55], v[80:95]
  ds_read_b128 v[48:51], v2 offset:44032
  v_cvt_pk_bf16_f32 v32, v112, v113
  v_cvt_pk_bf16_f32 v33, v114, v115
  v_mul_f32 v8, v100, v100
  s_waitcnt lgkmcnt(2)
  v_mfma_f32_32x32x16_bf16 v[64:79], a[32:35], v[56:59], v[64:79]
  v_mul_f32 v9, v101, v101
  v_mul_f32 v10, v102, v102
  v_mul_f32 v11, v103, v103
  v_fma_f32 v8, v8, v45, v44
  v_mfma_f32_32x32x16_bf16 v[80:95], a[148:151], v[56:59], v[80:95]
  ds_read_b128 v[52:55], v2 offset:45056
  v_fma_f32 v9, v9, v45, v44
  v_fma_f32 v10, v10, v45, v44
  v_fma_f32 v11, v11, v45, v44
  s_waitcnt lgkmcnt(2)
  v_mfma_f32_32x32x16_bf16 v[64:79], a[36:39], v[60:63], v[64:79]
  s_add_u32 s71, s83, 0x3000
  buffer_load_dwordx4 v[228:231], v14, s[20:23], s71 offen offset:0
  v_mul_f32 v8, v8, v100
  v_mul_f32 v9, v9, v101
  v_mul_f32 v10, v10, v102
  v_mul_f32 v11, v11, v103
  v_mfma_f32_32x32x16_bf16 v[80:95], a[152:155], v[60:63], v[80:95]
  ds_read_b128 v[56:59], v2 offset:46080
  v_exp_f32 v8, v8
  v_exp_f32 v9, v9
  s_waitcnt lgkmcnt(2)
  v_mfma_f32_32x32x16_bf16 v[64:79], a[40:43], v[48:51], v[64:79]
  v_exp_f32 v10, v10
  v_exp_f32 v11, v11
  v_mfma_f32_32x32x16_bf16 v[80:95], a[156:159], v[48:51], v[80:95]
  s_waitcnt vmcnt(18)
  s_barrier
  ds_read_b128 v[60:63], v2 offset:47104
  v_mul_f32 v116, v116, v100
  v_mul_f32 v117, v117, v101
  v_mul_f32 v118, v118, v102
  s_waitcnt lgkmcnt(2)
  v_mfma_f32_32x32x16_bf16 v[64:79], a[44:47], v[52:55], v[64:79]
  buffer_load_dwordx4 v[236:239], v14, s[20:23], s71 offen offset:1024
  v_mul_f32 v119, v119, v103
  v_fma_f32 v8, v8, v46, v46
  v_fma_f32 v9, v9, v46, v46
  v_fma_f32 v10, v10, v46, v46
  v_mfma_f32_32x32x16_bf16 v[80:95], a[160:163], v[52:55], v[80:95]
  s_add_u32 s74, s81, 0x18800
  s_add_u32 m0, s93, 0xa800
  s_nop 0
  buffer_load_dwordx4 v1, s[20:23], s74 offen offset:0 sc1 lds
  ds_read_b128 v[48:51], v2 offset:48128
  v_fma_f32 v11, v11, v46, v46
  v_rcp_f32 v8, v8
  s_waitcnt lgkmcnt(2)
  v_mfma_f32_32x32x16_bf16 v[64:79], a[48:51], v[56:59], v[64:79]
  v_rcp_f32 v9, v9
  v_rcp_f32 v10, v10
  v_mfma_f32_32x32x16_bf16 v[80:95], a[164:167], v[56:59], v[80:95]
  buffer_load_dwordx4 v1, s[20:23], s74 offen offset:1024 sc1 lds
  ds_read_b128 v[52:55], v2 offset:49152
  v_rcp_f32 v11, v11
  s_waitcnt lgkmcnt(2)
  v_mfma_f32_32x32x16_bf16 v[64:79], a[52:55], v[60:63], v[64:79]
  buffer_load_dwordx4 v[244:247], v14, s[20:23], s71 offen offset:2048
  v_mul_f32 v116, v116, v8
  v_mul_f32 v117, v117, v9
  v_mul_f32 v118, v118, v10
  v_mul_f32 v119, v119, v11
  v_mfma_f32_32x32x16_bf16 v[80:95], a[168:171], v[60:63], v[80:95]
  buffer_load_dwordx4 v1, s[20:23], s74 offen offset:2048 sc1 lds
  ds_read_b128 v[56:59], v2 offset:50176
  v_cvt_pk_bf16_f32 v34, v116, v117
  v_cvt_pk_bf16_f32 v35, v118, v119
  s_waitcnt lgkmcnt(2)
  v_mfma_f32_32x32x16_bf16 v[64:79], a[56:59], v[48:51], v[64:79]
  v_mul_f32 v8, v104, v104
  v_mul_f32 v9, v105, v105
  v_mul_f32 v10, v106, v106
  v_mul_f32 v11, v107, v107
  v_mfma_f32_32x32x16_bf16 v[80:95], a[172:175], v[48:51], v[80:95]
  buffer_load_dwordx4 v1, s[20:23], s74 offen offset:3072 sc1 lds
  ds_read_b128 v[60:63], v2 offset:51200
  v_fma_f32 v8, v8, v45, v44
  v_fma_f32 v9, v9, v45, v44
  s_waitcnt lgkmcnt(2)
  v_mfma_f32_32x32x16_bf16 v[64:79], a[60:63], v[52:55], v[64:79]
  buffer_load_dwordx4 v[252:255], v14, s[20:23], s71 offen offset:3072
  v_fma_f32 v10, v10, v45, v44
  v_fma_f32 v11, v11, v45, v44
  v_mul_f32 v8, v8, v104
  v_mul_f32 v9, v9, v105
  v_mfma_f32_32x32x16_bf16 v[80:95], a[176:179], v[52:55], v[80:95]
  ds_read_b128 v[48:51], v2 offset:52224
  v_mul_f32 v10, v10, v106
  v_mul_f32 v11, v11, v107
  v_exp_f32 v8, v8
  s_waitcnt lgkmcnt(2)
  v_mfma_f32_32x32x16_bf16 v[64:79], a[64:67], v[56:59], v[64:79]
  v_exp_f32 v9, v9
  v_exp_f32 v10, v10
  v_mfma_f32_32x32x16_bf16 v[80:95], a[180:183], v[56:59], v[80:95]
  ds_read_b128 v[52:55], v2 offset:53248
  v_exp_f32 v11, v11
  v_mul_f32 v120, v120, v104
  s_waitcnt lgkmcnt(2)
  v_mfma_f32_32x32x16_bf16 v[64:79], a[68:71], v[60:63], v[64:79]
  s_add_u32 s52, s78, 0x7dc000
  buffer_store_dwordx4 v[32:35], v1, s[20:23], s52 offen offset:0 sc1
  v_mul_f32 v121, v121, v105
  v_mfma_f32_32x32x16_bf16 v[80:95], a[184:187], v[60:63], v[80:95]
  ds_read_b128 v[56:59], v2 offset:54272
  v_mul_f32 v122, v122, v106
  v_mul_f32 v123, v123, v107
  v_fma_f32 v8, v8, v46, v46
  s_waitcnt lgkmcnt(2)
  v_mfma_f32_32x32x16_bf16 v[64:79], a[72:75], v[48:51], v[64:79]
  s_add_u32 s72, s68, 0x4000
  buffer_load_dwordx4 a[232:235], v14, s[20:23], s72 offen offset:0
  v_fma_f32 v9, v9, v46, v46
  v_fma_f32 v10, v10, v46, v46
  v_fma_f32 v11, v11, v46, v46
  v_rcp_f32 v8, v8
  v_mfma_f32_32x32x16_bf16 v[80:95], a[188:191], v[48:51], v[80:95]
  ds_read_b128 v[60:63], v2 offset:55296
  v_rcp_f32 v9, v9
  v_rcp_f32 v10, v10
  s_waitcnt lgkmcnt(2)
  v_mfma_f32_32x32x16_bf16 v[64:79], a[76:79], v[52:55], v[64:79]
  buffer_load_dwordx4 a[240:243], v14, s[20:23], s72 offen offset:1024
  v_rcp_f32 v11, v11
  v_mul_f32 v120, v120, v8
  v_mul_f32 v121, v121, v9
  v_mfma_f32_32x32x16_bf16 v[80:95], a[192:195], v[52:55], v[80:95]
  ds_read_b128 v[48:51], v2 offset:56320
  v_mul_f32 v122, v122, v10
  v_mul_f32 v123, v123, v11
  v_cvt_pk_bf16_f32 v36, v120, v121
  s_waitcnt lgkmcnt(2)
  v_mfma_f32_32x32x16_bf16 v[64:79], a[80:83], v[56:59], v[64:79]
  v_cvt_pk_bf16_f32 v37, v122, v123
  v_mul_f32 v8, v108, v108
  v_mul_f32 v9, v109, v109
  v_mul_f32 v10, v110, v110
  v_mfma_f32_32x32x16_bf16 v[80:95], a[196:199], v[56:59], v[80:95]
  ds_read_b128 v[52:55], v2 offset:57344
  v_mul_f32 v11, v111, v111
  v_fma_f32 v8, v8, v45, v44
  v_fma_f32 v9, v9, v45, v44
  s_waitcnt lgkmcnt(2)
  v_mfma_f32_32x32x16_bf16 v[64:79], a[84:87], v[60:63], v[64:79]
  buffer_load_dwordx4 a[248:251], v14, s[20:23], s72 offen offset:2048
  v_fma_f32 v10, v10, v45, v44
  v_fma_f32 v11, v11, v45, v44
  v_mul_f32 v8, v8, v108
  v_mul_f32 v9, v9, v109
  v_mfma_f32_32x32x16_bf16 v[80:95], a[200:203], v[60:63], v[80:95]
  ds_read_b128 v[56:59], v2 offset:58368
  v_mul_f32 v10, v10, v110
  v_mul_f32 v11, v11, v111
  v_exp_f32 v8, v8
  s_waitcnt lgkmcnt(2)
  v_mfma_f32_32x32x16_bf16 v[64:79], a[88:91], v[48:51], v[64:79]
  v_exp_f32 v9, v9
  v_exp_f32 v10, v10
  v_mfma_f32_32x32x16_bf16 v[80:95], a[204:207], v[48:51], v[80:95]
  ds_read_b128 v[60:63], v2 offset:59392
  v_exp_f32 v11, v11
  v_mul_f32 v124, v124, v108
  s_waitcnt lgkmcnt(2)
  v_mfma_f32_32x32x16_bf16 v[64:79], a[92:95], v[52:55], v[64:79]
  s_add_u32 s73, s83, 0x4000
  buffer_load_dwordx4 a[236:239], v14, s[20:23], s73 offen offset:0
  v_mul_f32 v125, v125, v109
  v_mul_f32 v126, v126, v110
  v_mul_f32 v127, v127, v111
  v_fma_f32 v8, v8, v46, v46
  v_mfma_f32_32x32x16_bf16 v[80:95], a[208:211], v[52:55], v[80:95]
  ds_read_b128 v[48:51], v2 offset:60416
  v_fma_f32 v9, v9, v46, v46
  v_fma_f32 v10, v10, v46, v46
  v_fma_f32 v11, v11, v46, v46
  s_waitcnt lgkmcnt(2)
  v_mfma_f32_32x32x16_bf16 v[64:79], a[96:99], v[56:59], v[64:79]
  v_rcp_f32 v8, v8
  v_rcp_f32 v9, v9
  v_mfma_f32_32x32x16_bf16 v[80:95], a[212:215], v[56:59], v[80:95]
  s_waitcnt vmcnt(18)
  s_barrier
  ds_read_b128 v[52:55], v2 offset:61440
  v_rcp_f32 v10, v10
  v_rcp_f32 v11, v11
  s_waitcnt lgkmcnt(2)
  v_mfma_f32_32x32x16_bf16 v[64:79], a[100:103], v[60:63], v[64:79]
  buffer_load_dwordx4 a[244:247], v14, s[20:23], s73 offen offset:1024
  v_mul_f32 v124, v124, v8
  v_mul_f32 v125, v125, v9
  v_mul_f32 v126, v126, v10
  v_mul_f32 v127, v127, v11
  v_mfma_f32_32x32x16_bf16 v[80:95], a[216:219], v[60:63], v[80:95]
  ds_read_b128 v[56:59], v2 offset:29696
  v_cvt_pk_bf16_f32 v38, v124, v125
  v_cvt_pk_bf16_f32 v39, v126, v127
  s_waitcnt lgkmcnt(2)
  v_mfma_f32_32x32x16_bf16 v[64:79], a[104:107], v[48:51], v[64:79]
  v_mfma_f32_32x32x16_bf16 v[80:95], a[220:223], v[48:51], v[80:95]
  ds_read_b128 v[60:63], v2 offset:62464
  s_waitcnt lgkmcnt(2)
  v_mfma_f32_32x32x16_bf16 v[64:79], a[108:111], v[52:55], v[64:79]
  buffer_load_dwordx4 a[252:255], v14, s[20:23], s73 offen offset:2048
  v_mfma_f32_32x32x16_bf16 v[80:95], a[224:227], v[52:55], v[80:95]
  ds_read_b128 v[48:51], v2 offset:63488
  s_waitcnt lgkmcnt(2)
  v_mfma_f32_32x32x16_bf16 v[64:79], a[112:115], v[56:59], v[64:79]
  s_add_u32 s53, s78, 0x7dc000
  buffer_store_dwordx4 v[36:39], v1, s[20:23], s53 offen offset:1024 sc1
  v_mfma_f32_32x32x16_bf16 v[80:95], a[228:231], v[56:59], v[80:95]
  ds_read_b128 v[52:55], v2 offset:64512
  s_waitcnt lgkmcnt(2)
  v_mfma_f32_32x32x16_bf16 v[96:111], a[0:3], v[60:63], 0
  v_mfma_f32_32x32x16_bf16 v[112:127], a[116:119], v[60:63], 0
  ds_read_b128 v[56:59], v3 offset:0
  s_waitcnt lgkmcnt(2)
  v_mfma_f32_32x32x16_bf16 v[96:111], a[4:7], v[48:51], v[96:111]
  s_add_u32 s84, s68, 0x4000
  buffer_load_dwordx4 a[0:3], v14, s[20:23], s84 offen offset:3072
  v_mfma_f32_32x32x16_bf16 v[112:127], a[120:123], v[48:51], v[112:127]
  ds_read_b128 v[60:63], v3 offset:1024
  s_waitcnt lgkmcnt(2)
  v_mfma_f32_32x32x16_bf16 v[96:111], a[8:11], v[52:55], v[96:111]
  s_add_u32 s85, s83, 0x4000
  buffer_load_dwordx4 a[4:7], v14, s[20:23], s85 offen offset:3072
  ds_read_b128 v[40:43], v2 offset:30720
  s_waitcnt lgkmcnt(0)
  v_mul_f32 v8, v64, v64
  v_mul_f32 v9, v65, v65
  v_mul_f32 v10, v66, v66
  v_mfma_f32_32x32x16_bf16 v[112:127], a[124:127], v[52:55], v[112:127]
  ds_read_b128 v[48:51], v3 offset:2048
  v_mul_f32 v11, v67, v67
  v_fma_f32 v8, v8, v41, v40
  v_fma_f32 v9, v9, v41, v40
  v_mfma_f32_32x32x16_bf16 v[96:111], a[12:15], v[56:59], v[96:111]
  s_add_u32 s86, s68, 0x5000
  buffer_load_dwordx4 a[8:11], v14, s[20:23], s86 offen offset:0
  v_fma_f32 v10, v10, v41, v40
  v_fma_f32 v11, v11, v41, v40
  v_mul_f32 v8, v8, v64
  v_mul_f32 v9, v9, v65
  v_mfma_f32_32x32x16_bf16 v[112:127], a[128:131], v[56:59], v[112:127]
  ds_read_b128 v[52:55], v3 offset:3072
  v_mul_f32 v10, v10, v66
  v_mul_f32 v11, v11, v67
  v_exp_f32 v8, v8
  v_mfma_f32_32x32x16_bf16 v[96:111], a[16:19], v[60:63], v[96:111]
  s_add_u32 s87, s83, 0x5000
  buffer_load_dwordx4 a[12:15], v14, s[20:23], s87 offen offset:0
  v_exp_f32 v9, v9
  v_exp_f32 v10, v10
  v_mfma_f32_32x32x16_bf16 v[112:127], a[132:135], v[60:63], v[112:127]
  ds_read_b128 v[56:59], v3 offset:4096
  v_exp_f32 v11, v11
  v_mul_f32 v80, v80, v64
  s_waitcnt lgkmcnt(2)
  v_mfma_f32_32x32x16_bf16 v[96:111], a[20:23], v[48:51], v[96:111]
  s_add_u32 s84, s68, 0x5000
  buffer_load_dwordx4 a[16:19], v14, s[20:23], s84 offen offset:1024
  v_mul_f32 v81, v81, v65
  v_mul_f32 v82, v82, v66
  v_mul_f32 v83, v83, v67
  v_fma_f32 v8, v8, v42, v42
  v_mfma_f32_32x32x16_bf16 v[112:127], a[136:139], v[48:51], v[112:127]
  ds_read_b128 v[60:63], v3 offset:5120
  v_fma_f32 v9, v9, v42, v42
  v_fma_f32 v10, v10, v42, v42
  v_fma_f32 v11, v11, v42, v42
  s_waitcnt lgkmcnt(2)
  v_mfma_f32_32x32x16_bf16 v[96:111], a[24:27], v[52:55], v[96:111]
  s_add_u32 s85, s83, 0x5000
  buffer_load_dwordx4 a[20:23], v14, s[20:23], s85 offen offset:1024
  v_rcp_f32 v8, v8
  v_rcp_f32 v9, v9
  v_mfma_f32_32x32x16_bf16 v[112:127], a[140:143], v[52:55], v[112:127]
  ds_read_b128 v[48:51], v3 offset:6144
  v_rcp_f32 v10, v10
  v_rcp_f32 v11, v11
  s_waitcnt lgkmcnt(2)
  v_mfma_f32_32x32x16_bf16 v[96:111], a[28:31], v[56:59], v[96:111]
  s_add_u32 s86, s68, 0x5000
  buffer_load_dwordx4 a[24:27], v14, s[20:23], s86 offen offset:2048
  v_mul_f32 v80, v80, v8
  v_mul_f32 v81, v81, v9
  v_mul_f32 v82, v82, v10
  v_mul_f32 v83, v83, v11
  v_mfma_f32_32x32x16_bf16 v[112:127], a[144:147], v[56:59], v[112:127]
  ds_read_b128 v[52:55], v3 offset:7168
  v_cvt_pk_bf16_f32 v24, v80, v81
  v_cvt_pk_bf16_f32 v25, v82, v83
  v_mul_f32 v8, v68, v68
  s_waitcnt lgkmcnt(2)
  v_mfma_f32_32x32x16_bf16 v[96:111], a[32:35], v[60:63], v[96:111]
  s_add_u32 s87, s83, 0x5000
  buffer_load_dwordx4 a[28:31], v14, s[20:23], s87 offen offset:2048
  v_mul_f32 v9, v69, v69
  v_mul_f32 v10, v70, v70
  v_mul_f32 v11, v71, v71
  v_fma_f32 v8, v8, v41, v40
  v_mfma_f32_32x32x16_bf16 v[112:127], a[148:151], v[60:63], v[112:127]
  ds_read_b128 v[56:59], v3 offset:8192
  v_fma_f32 v9, v9, v41, v40
  v_fma_f32 v10, v10, v41, v40
  v_fma_f32 v11, v11, v41, v40
  s_waitcnt lgkmcnt(2)
  v_mfma_f32_32x32x16_bf16 v[96:111], a[36:39], v[48:51], v[96:111]
  s_add_u32 s84, s68, 0x5000
  buffer_load_dwordx4 a[32:35], v14, s[20:23], s84 offen offset:3072
  v_mul_f32 v8, v8, v68
  v_mul_f32 v9, v9, v69
  v_mul_f32 v10, v10, v70
  v_mul_f32 v11, v11, v71
  v_mfma_f32_32x32x16_bf16 v[112:127], a[152:155], v[48:51], v[112:127]
  ds_read_b128 v[60:63], v3 offset:9216
  v_exp_f32 v8, v8
  v_exp_f32 v9, v9
  s_waitcnt lgkmcnt(2)
  v_mfma_f32_32x32x16_bf16 v[96:111], a[40:43], v[52:55], v[96:111]
  s_add_u32 s85, s83, 0x5000
  buffer_load_dwordx4 a[36:39], v14, s[20:23], s85 offen offset:3072
  v_exp_f32 v10, v10
  v_exp_f32 v11, v11
  v_mfma_f32_32x32x16_bf16 v[112:127], a[156:159], v[52:55], v[112:127]
  s_waitcnt vmcnt(10)
  s_barrier
  s_cmp_lg_u32 s42, 0
  s_cbranch_scc1 L_pubskip_57
  s_lshl_b32 s56, s40, 7
  s_lshl_b32 s57, s41, 2
  s_add_u32 s56, s56, s57
  s_add_u32 s56, s56, 0x2800
  s_mov_b64 exec, 1
  v_mov_b32 v13, s43
  s_cmp_eq_u32 s44, 0
  s_cbranch_scc1 L_slow_58
  buffer_store_dword v13, v7, s[20:23], s56 offen
L_join_59:
  s_mov_b64 exec, -1
  s_nop 0
L_pubskip_57:
  ds_read_b128 v[48:51], v3 offset:10240
  v_mul_f32 v84, v84, v68
  v_mul_f32 v85, v85, v69
  v_mul_f32 v86, v86, v70
  s_waitcnt lgkmcnt(2)
  v_mfma_f32_32x32x16_bf16 v[96:111], a[44:47], v[56:59], v[96:111]
  s_add_u32 s86, s68, 0x6000
  buffer_load_dwordx4 a[40:43], v14, s[20:23], s86 offen offset:0
  v_mul_f32 v87, v87, v71
  v_fma_f32 v8, v8, v42, v42
  v_fma_f32 v9, v9, v42, v42
  v_fma_f32 v10, v10, v42, v42
  v_mfma_f32_32x32x16_bf16 v[112:127], a[160:163], v[56:59], v[112:127]
  ds_read_b128 v[52:55], v3 offset:11264
  v_fma_f32 v11, v11, v42, v42
  v_rcp_f32 v8, v8
  s_waitcnt lgkmcnt(2)
  v_mfma_f32_32x32x16_bf16 v[96:111], a[48:51], v[60:63], v[96:111]
  s_add_u32 s87, s83, 0x6000
  buffer_load_dwordx4 a[44:47], v14, s[20:23], s87 offen offset:0
  v_rcp_f32 v9, v9
  v_rcp_f32 v10, v10
  v_mfma_f32_32x32x16_bf16 v[112:127], a[164:167], v[60:63], v[112:127]
  ds_read_b128 v[56:59], v3 offset:12288
  v_rcp_f32 v11, v11
  v_mul_f32 v84, v84, v8
  s_waitcnt lgkmcnt(2)
  v_mfma_f32_32x32x16_bf16 v[96:111], a[52:55], v[48:51], v[96:111]
  s_add_u32 s84, s68, 0x6000
  buffer_load_dwordx4 a[48:51], v14, s[20:23], s84 offen offset:1024
  v_mul_f32 v85, v85, v9
  v_mul_f32 v86, v86, v10
  v_mul_f32 v87, v87, v11
  v_cvt_pk_bf16_f32 v26, v84, v85
  v_mfma_f32_32x32x16_bf16 v[112:127], a[168:171], v[48:51], v[112:127]
  ds_read_b128 v[60:63], v3 offset:13312
  v_cvt_pk_bf16_f32 v27, v86, v87
  v_mul_f32 v8, v72, v72
  v_mul_f32 v9, v73, v73
  s_waitcnt lgkmcnt(2)
  v_mfma_f32_32x32x16_bf16 v[96:111], a[56:59], v[52:55], v[96:111]
  s_add_u32 s85, s83, 0x6000
  buffer_load_dwordx4 a[52:55], v14, s[20:23], s85 offen offset:1024
  v_mul_f32 v10, v74, v74
  v_mul_f32 v11, v75, v75
  v_fma_f32 v8, v8, v41, v40
  v_fma_f32 v9, v9, v41, v40
  v_mfma_f32_32x32x16_bf16 v[112:127], a[172:175], v[52:55], v[112:127]
  ds_read_b128 v[48:51], v3 offset:14336
  v_fma_f32 v10, v10, v41, v40
  v_fma_f32 v11, v11, v41, v40
  v_mul_f32 v8, v8, v72
  s_waitcnt lgkmcnt(2)
  v_mfma_f32_32x32x16_bf16 v[96:111], a[60:63], v[56:59], v[96:111]
  s_add_u32 s86, s68, 0x6000
  buffer_load_dwordx4 a[56:59], v14, s[20:23], s86 offen offset:2048
  v_mul_f32 v9, v9, v73
  v_mul_f32 v10, v10, v74
  v_mul_f32 v11, v11, v75
  v_exp_f32 v8, v8
  v_mfma_f32_32x32x16_bf16 v[112:127], a[176:179], v[56:59], v[112:127]
  ds_read_b128 v[52:55], v3 offset:15360
  v_exp_f32 v9, v9
  v_exp_f32 v10, v10
  s_waitcnt lgkmcnt(2)
  v_mfma_f32_32x32x16_bf16 v[96:111], a[64:67], v[60:63], v[96:111]
  s_add_u32 s87, s83, 0x6000
  buffer_load_dwordx4 a[60:63], v14, s[20:23], s87 offen offset:2048
  v_exp_f32 v11, v11
  v_mul_f32 v88, v88, v72
  v_mul_f32 v89, v89, v73
  v_mfma_f32_32x32x16_bf16 v[112:127], a[180:183], v[60:63], v[112:127]
  ds_read_b128 v[56:59], v3 offset:16384
  v_mul_f32 v90, v90, v74
  v_mul_f32 v91, v91, v75
  v_fma_f32 v8, v8, v42, v42
  s_waitcnt lgkmcnt(2)
  v_mfma_f32_32x32x16_bf16 v[96:111], a[68:71], v[48:51], v[96:111]
  s_add_u32 s54, s78, 0x7fc000
  buffer_store_dwordx4 v[24:27], v1, s[20:23], s54 offen offset:0 sc1
  v_fma_f32 v9, v9, v42, v42
  v_mfma_f32_32x32x16_bf16 v[112:127], a[184:187], v[48:51], v[112:127]
  ds_read_b128 v[60:63], v3 offset:17408
  v_fma_f32 v10, v10, v42, v42
  v_fma_f32 v11, v11, v42, v42
  v_rcp_f32 v8, v8
  s_waitcnt lgkmcnt(2)
  v_mfma_f32_32x32x16_bf16 v[96:111], a[72:75], v[52:55], v[96:111]
  s_lshl_b32 s55, s40, 7
  s_add_u32 s55, s55, 0x2800
  s_mov_b64 exec, 0x3fff
  buffer_load_dword v12, v7, s[20:23], s55 offen sc1
  s_mov_b64 exec, -1
  v_rcp_f32 v9, v9
  v_mfma_f32_32x32x16_bf16 v[112:127], a[188:191], v[52:55], v[112:127]
  ds_read_b128 v[48:51], v3 offset:18432
  v_rcp_f32 v10, v10
  v_rcp_f32 v11, v11
  s_waitcnt lgkmcnt(2)
  v_mfma_f32_32x32x16_bf16 v[96:111], a[76:79], v[56:59], v[96:111]
  s_add_u32 s84, s68, 0x6000
  buffer_load_dwordx4 a[64:67], v14, s[20:23], s84 offen offset:3072
  v_mul_f32 v88, v88, v8
  v_mul_f32 v89, v89, v9
  v_mul_f32 v90, v90, v10
  v_mul_f32 v91, v91, v11
  v_mfma_f32_32x32x16_bf16 v[112:127], a[192:195], v[56:59], v[112:127]
  ds_read_b128 v[52:55], v3 offset:19456
  v_cvt_pk_bf16_f32 v28, v88, v89
  v_cvt_pk_bf16_f32 v29, v90, v91
  v_mul_f32 v8, v76, v76
  s_waitcnt lgkmcnt(2)
  v_mfma_f32_32x32x16_bf16 v[96:111], a[80:83], v[60:63], v[96:111]
  s_add_u32 s85, s83, 0x6000
  buffer_load_dwordx4 a[68:71], v14, s[20:23], s85 offen offset:3072
  v_mul_f32 v9, v77, v77
  v_mul_f32 v10, v78, v78
  v_mul_f32 v11, v79, v79
  v_fma_f32 v8, v8, v41, v40
  v_mfma_f32_32x32x16_bf16 v[112:127], a[196:199], v[60:63], v[112:127]
  ds_read_b128 v[56:59], v3 offset:20480
  v_fma_f32 v9, v9, v41, v40
  v_fma_f32 v10, v10, v41, v40
  v_fma_f32 v11, v11, v41, v40
  s_waitcnt lgkmcnt(2)
  v_mfma_f32_32x32x16_bf16 v[96:111], a[84:87], v[48:51], v[96:111]
  v_mul_f32 v8, v8, v76
  v_mul_f32 v9, v9, v77
  v_mul_f32 v10, v10, v78
  v_mul_f32 v11, v11, v79
  v_mfma_f32_32x32x16_bf16 v[112:127], a[200:203], v[48:51], v[112:127]
  ds_read_b128 v[60:63], v3 offset:21504
  v_exp_f32 v8, v8
  v_exp_f32 v9, v9
  s_waitcnt lgkmcnt(2)
  v_mfma_f32_32x32x16_bf16 v[96:111], a[88:91], v[52:55], v[96:111]
  v_exp_f32 v10, v10
  v_exp_f32 v11, v11
  v_mfma_f32_32x32x16_bf16 v[112:127], a[204:207], v[52:55], v[112:127]
  ds_read_b128 v[48:51], v3 offset:22528
  v_mul_f32 v92, v92, v76
  v_mul_f32 v93, v93, v77
  v_mul_f32 v94, v94, v78
  s_waitcnt lgkmcnt(2)
  v_mfma_f32_32x32x16_bf16 v[96:111], a[92:95], v[56:59], v[96:111]
  v_mul_f32 v95, v95, v79
  v_fma_f32 v8, v8, v42, v42
  v_fma_f32 v9, v9, v42, v42
  v_fma_f32 v10, v10, v42, v42
  v_mfma_f32_32x32x16_bf16 v[112:127], a[208:211], v[56:59], v[112:127]
  ds_read_b128 v[52:55], v3 offset:23552
  v_fma_f32 v11, v11, v42, v42
  v_rcp_f32 v8, v8
  s_waitcnt lgkmcnt(2)
  v_mfma_f32_32x32x16_bf16 v[96:111], a[96:99], v[60:63], v[96:111]
  v_rcp_f32 v9, v9
  v_rcp_f32 v10, v10
  v_mfma_f32_32x32x16_bf16 v[112:127], a[212:215], v[60:63], v[112:127]
  ds_read_b128 v[56:59], v3 offset:24576
  v_rcp_f32 v11, v11
  v_mul_f32 v92, v92, v8
  s_waitcnt lgkmcnt(2)
  v_mfma_f32_32x32x16_bf16 v[96:111], a[100:103], v[48:51], v[96:111]
  v_mul_f32 v93, v93, v9
  v_mul_f32 v94, v94, v10
  v_mul_f32 v95, v95, v11
  v_cvt_pk_bf16_f32 v30, v92, v93
  v_mfma_f32_32x32x16_bf16 v[112:127], a[216:219], v[48:51], v[112:127]
  ds_read_b128 v[60:63], v2 offset:31744
  v_cvt_pk_bf16_f32 v31, v94, v95
  s_waitcnt vmcnt(2)
  v_cmp_ne_u32 vcc, s43, v12
  s_nop 1
  s_and_b32 s56, vcc_lo, 0x3fff
  s_cbranch_scc1 L_fsp_62
L_fok_61:
  s_waitcnt lgkmcnt(2)
  v_mfma_f32_32x32x16_bf16 v[96:111], a[104:107], v[52:55], v[96:111]
  buffer_load_dwordx4 a[136:139], v1, s[20:23], s79 offen offset:0 sc1
  v_mfma_f32_32x32x16_bf16 v[112:127], a[220:223], v[52:55], v[112:127]
  buffer_load_dwordx4 a[140:143], v1, s[20:23], s79 offen offset:1024 sc1
  s_waitcnt lgkmcnt(1)
  v_mfma_f32_32x32x16_bf16 v[96:111], a[108:111], v[56:59], v[96:111]
  buffer_load_dwordx4 a[144:147], v1, s[20:23], s79 offen offset:2048 sc1
  v_mfma_f32_32x32x16_bf16 v[112:127], a[224:227], v[56:59], v[112:127]
  buffer_load_dwordx4 a[148:151], v1, s[20:23], s79 offen offset:3072 sc1
  s_waitcnt lgkmcnt(0)
  v_mfma_f32_32x32x16_bf16 v[96:111], a[112:115], v[60:63], v[96:111]
  s_add_u32 s48, s78, 0x7fc000
  buffer_store_dwordx4 v[28:31], v1, s[20:23], s48 offen offset:1024 sc1
  v_mfma_f32_32x32x16_bf16 v[112:127], a[228:231], v[60:63], v[112:127]
  s_add_u32 s75, s79, 0x1000
  buffer_load_dwordx4 a[152:155], v1, s[20:23], s75 offen offset:0 sc1
  ds_read_b128 v[44:47], v2 offset:32768
  buffer_load_dwordx4 a[156:159], v1, s[20:23], s75 offen offset:1024 sc1
  s_waitcnt lgkmcnt(0)
  s_nop 3
  v_pk_mul_f32 v[48:49], v[96:97], v[96:97]
  v_pk_mul_f32 v[50:51], v[98:99], v[98:99]
  v_pk_mul_f32 v[52:53], v[100:101], v[100:101]
  v_pk_mul_f32 v[54:55], v[102:103], v[102:103]
  v_pk_fma_f32 v[48:49], v[48:49], v[44:45], v[44:45] op_sel:[0,1,0] op_sel_hi:[1,1,0]
  v_pk_fma_f32 v[50:51], v[50:51], v[44:45], v[44:45] op_sel:[0,1,0] op_sel_hi:[1,1,0]
  v_pk_fma_f32 v[52:53], v[52:53], v[44:45], v[44:45] op_sel:[0,1,0] op_sel_hi:[1,1,0]
  v_pk_fma_f32 v[54:55], v[54:55], v[44:45], v[44:45] op_sel:[0,1,0] op_sel_hi:[1,1,0]
  buffer_load_dwordx4 a[160:163], v1, s[20:23], s75 offen offset:2048 sc1
  v_pk_mul_f32 v[48:49], v[48:49], v[96:97]
  v_pk_mul_f32 v[50:51], v[50:51], v[98:99]
  v_pk_mul_f32 v[52:53], v[52:53], v[100:101]
  v_pk_mul_f32 v[54:55], v[54:55], v[102:103]
  v_exp_f32 v48, v48
  v_exp_f32 v49, v49
  buffer_load_dwordx4 a[164:167], v1, s[20:23], s75 offen offset:3072 sc1
  v_exp_f32 v50, v50
  v_exp_f32 v51, v51
  v_exp_f32 v52, v52
  v_exp_f32 v53, v53
  s_add_u32 s76, s79, 0x2000
  buffer_load_dwordx4 a[168:171], v1, s[20:23], s76 offen offset:0 sc1
  v_exp_f32 v54, v54
  v_exp_f32 v55, v55
  v_pk_mul_f32 v[112:113], v[112:113], v[96:97]
  v_pk_mul_f32 v[114:115], v[114:115], v[98:99]
  v_pk_mul_f32 v[116:117], v[116:117], v[100:101]
  v_pk_mul_f32 v[118:119], v[118:119], v[102:103]
  buffer_load_dwordx4 a[172:175], v1, s[20:23], s76 offen offset:1024 sc1
  v_pk_fma_f32 v[48:49], v[48:49], v[46:47], v[46:47] op_sel:[0,0,0] op_sel_hi:[1,0,0]
  v_pk_fma_f32 v[50:51], v[50:51], v[46:47], v[46:47] op_sel:[0,0,0] op_sel_hi:[1,0,0]
  v_pk_fma_f32 v[52:53], v[52:53], v[46:47], v[46:47] op_sel:[0,0,0] op_sel_hi:[1,0,0]
  v_pk_fma_f32 v[54:55], v[54:55], v[46:47], v[46:47] op_sel:[0,0,0] op_sel_hi:[1,0,0]
  v_rcp_f32 v48, v48
  v_rcp_f32 v49, v49
  buffer_load_dwordx4 a[176:179], v1, s[20:23], s76 offen offset:2048 sc1
  v_rcp_f32 v50, v50
  v_rcp_f32 v51, v51
  v_rcp_f32 v52, v52
  v_rcp_f32 v53, v53
  buffer_load_dwordx4 a[180:183], v1, s[20:23], s76 offen offset:3072 sc1
  v_rcp_f32 v54, v54
  v_rcp_f32 v55, v55
  v_pk_mul_f32 v[112:113], v[112:113], v[48:49]
  v_pk_mul_f32 v[114:115], v[114:115], v[50:51]
  v_pk_mul_f32 v[116:117], v[116:117], v[52:53]
  v_pk_mul_f32 v[118:119], v[118:119], v[54:55]
  v_cvt_pk_bf16_f32 v32, v112, v113
  v_cvt_pk_bf16_f32 v33, v114, v115
  v_cvt_pk_bf16_f32 v34, v116, v117
  v_cvt_pk_bf16_f32 v35, v118, v119
  s_add_u32 s49, s78, 0x818000
  s_cmp_eq_u32 s44, 0
  s_cbranch_scc1 L_slow_64
  buffer_store_dwordx4 v[32:35], v1, s[20:23], s49 offen offset:0 nt
L_join_65:
  v_pk_mul_f32 v[48:49], v[104:105], v[104:105]
  v_pk_mul_f32 v[50:51], v[106:107], v[106:107]
  v_pk_mul_f32 v[52:53], v[108:109], v[108:109]
  v_pk_mul_f32 v[54:55], v[110:111], v[110:111]
  v_pk_fma_f32 v[48:49], v[48:49], v[44:45], v[44:45] op_sel:[0,1,0] op_sel_hi:[1,1,0]
  v_pk_fma_f32 v[50:51], v[50:51], v[44:45], v[44:45] op_sel:[0,1,0] op_sel_hi:[1,1,0]
  v_pk_fma_f32 v[52:53], v[52:53], v[44:45], v[44:45] op_sel:[0,1,0] op_sel_hi:[1,1,0]
  v_pk_fma_f32 v[54:55], v[54:55], v[44:45], v[44:45] op_sel:[0,1,0] op_sel_hi:[1,1,0]
  v_pk_mul_f32 v[48:49], v[48:49], v[104:105]
  v_pk_mul_f32 v[50:51], v[50:51], v[106:107]
  v_pk_mul_f32 v[52:53], v[52:53], v[108:109]
  v_pk_mul_f32 v[54:55], v[54:55], v[110:111]
  v_exp_f32 v48, v48
  v_exp_f32 v49, v49
  v_exp_f32 v50, v50
  v_exp_f32 v51, v51
  v_exp_f32 v52, v52
  v_exp_f32 v53, v53
  v_exp_f32 v54, v54
  v_exp_f32 v55, v55
  v_pk_mul_f32 v[120:121], v[120:121], v[104:105]
  v_pk_mul_f32 v[122:123], v[122:123], v[106:107]
  v_pk_mul_f32 v[124:125], v[124:125], v[108:109]
  v_pk_mul_f32 v[126:127], v[126:127], v[110:111]
  v_pk_fma_f32 v[48:49], v[48:49], v[46:47], v[46:47] op_sel:[0,0,0] op_sel_hi:[1,0,0]
  v_pk_fma_f32 v[50:51], v[50:51], v[46:47], v[46:47] op_sel:[0,0,0] op_sel_hi:[1,0,0]
  v_pk_fma_f32 v[52:53], v[52:53], v[46:47], v[46:47] op_sel:[0,0,0] op_sel_hi:[1,0,0]
  v_pk_fma_f32 v[54:55], v[54:55], v[46:47], v[46:47] op_sel:[0,0,0] op_sel_hi:[1,0,0]
  v_rcp_f32 v48, v48
  v_rcp_f32 v49, v49
  v_rcp_f32 v50, v50
  v_rcp_f32 v51, v51
  v_rcp_f32 v52, v52
  v_rcp_f32 v53, v53
  v_rcp_f32 v54, v54
  v_rcp_f32 v55, v55
  v_pk_mul_f32 v[120:121], v[120:121], v[48:49]
  v_pk_mul_f32 v[122:123], v[122:123], v[50:51]
  v_pk_mul_f32 v[124:125], v[124:125], v[52:53]
  v_pk_mul_f32 v[126:127], v[126:127], v[54:55]
  v_cvt_pk_bf16_f32 v36, v120, v121
  v_cvt_pk_bf16_f32 v37, v122, v123
  v_cvt_pk_bf16_f32 v38, v124, v125
  v_cvt_pk_bf16_f32 v39, v126, v127
  s_add_u32 s50, s78, 0x818000
  s_cmp_eq_u32 s44, 0
  s_cbranch_scc1 L_slow_66
  buffer_store_dwordx4 v[36:39], v1, s[20:23], s50 offen offset:1024 nt
L_join_67:
  s_waitcnt vmcnt(14)
  v_mfma_f32_32x32x16_bf16 v[64:79], v[128:131], a[136:139], 0
  s_add_u32 s77, s79, 0x3000
  buffer_load_dwordx4 a[184:187], v1, s[20:23], s77 offen offset:0 sc1
  s_xor_b32 s56, s42, 1
  s_mul_i32 s56, s56, 6144
  s_add_u32 s56, s56, 0x18400
  v_add_u32 v10, s56, v1
  v_mfma_f32_32x32x16_bf16 v[80:95], v[132:135], a[136:139], 0
  s_xor_b32 s56, s42, 2
  s_mul_i32 s56, s56, 6144
  s_add_u32 s56, s56, 0x18c00
  v_add_u32 v11, s56, v1
  s_waitcnt vmcnt(14)
  v_mfma_f32_32x32x16_bf16 v[64:79], v[136:139], a[140:143], v[64:79]
  buffer_load_dwordx4 a[188:191], v1, s[20:23], s77 offen offset:1024 sc1
  s_xor_b32 s56, s42, 3
  s_mul_i32 s56, s56, 6144
  s_add_u32 s56, s56, 0x19400
  v_add_u32 v12, s56, v1
  v_mfma_f32_32x32x16_bf16 v[80:95], v[140:143], a[140:143], v[80:95]
  s_mul_i32 s56, s42, 6144
  s_add_u32 s56, s56, 0x18400
  v_add_u32 v13, s56, v1
  s_waitcnt vmcnt(14)
  v_mfma_f32_32x32x16_bf16 v[64:79], v[144:147], a[144:147], v[64:79]
  buffer_load_dwordx4 a[192:195], v1, s[20:23], s77 offen offset:2048 sc1
  v_mfma_f32_32x32x16_bf16 v[80:95], v[148:151], a[144:147], v[80:95]
  s_waitcnt vmcnt(14)
  v_mfma_f32_32x32x16_bf16 v[64:79], v[152:155], a[148:151], v[64:79]
  buffer_load_dwordx4 a[196:199], v1, s[20:23], s77 offen offset:3072 sc1
  v_mfma_f32_32x32x16_bf16 v[80:95], v[156:159], a[148:151], v[80:95]
  s_waitcnt vmcnt(13)
  v_mfma_f32_32x32x16_bf16 v[64:79], v[160:163], a[152:155], v[64:79]
  s_add_u32 s74, s79, 0x4000
  buffer_load_dwordx4 a[136:139], v1, s[20:23], s74 offen offset:0 sc1
  v_mfma_f32_32x32x16_bf16 v[80:95], v[164:167], a[152:155], v[80:95]
  s_waitcnt vmcnt(13)
  v_mfma_f32_32x32x16_bf16 v[64:79], v[168:171], a[156:159], v[64:79]
  buffer_load_dwordx4 a[140:143], v1, s[20:23], s74 offen offset:1024 sc1
  v_mfma_f32_32x32x16_bf16 v[80:95], v[172:175], a[156:159], v[80:95]
  s_waitcnt vmcnt(6)
  s_barrier
  s_cmp_lg_u32 s42, 0
  s_cbranch_scc1 L_pubskip_68
  s_lshl_b32 s56, s40, 7
  s_lshl_b32 s57, s41, 2
  s_add_u32 s56, s56, s57
  s_add_u32 s56, s56, 0x3000
  s_mov_b64 exec, 1
  v_mov_b32 v57, s43
  s_cmp_eq_u32 s44, 0
  s_cbranch_scc1 L_slow_69
  buffer_store_dword v57, v7, s[20:23], s56 offen
L_join_70:
  s_mov_b64 exec, -1
  s_nop 0
L_pubskip_68:
  v_mfma_f32_32x32x16_bf16 v[64:79], v[176:179], a[160:163], v[64:79]
  buffer_load_dwordx4 a[144:147], v1, s[20:23], s74 offen offset:2048 sc1
  v_mfma_f32_32x32x16_bf16 v[80:95], v[180:183], a[160:163], v[80:95]
  v_mfma_f32_32x32x16_bf16 v[64:79], v[184:187], a[164:167], v[64:79]
  buffer_load_dwordx4 a[148:151], v1, s[20:23], s74 offen offset:3072 sc1
  v_mfma_f32_32x32x16_bf16 v[80:95], v[188:191], a[164:167], v[80:95]
  v_mfma_f32_32x32x16_bf16 v[64:79], v[192:195], a[168:171], v[64:79]
  s_add_u32 s75, s79, 0x5000
  buffer_load_dwordx4 a[152:155], v1, s[20:23], s75 offen offset:0 sc1
  v_mfma_f32_32x32x16_bf16 v[80:95], v[196:199], a[168:171], v[80:95]
  v_mfma_f32_32x32x16_bf16 v[64:79], v[200:203], a[172:175], v[64:79]
  buffer_load_dwordx4 a[156:159], v1, s[20:23], s75 offen offset:1024 sc1
  v_mfma_f32_32x32x16_bf16 v[80:95], v[204:207], a[172:175], v[80:95]
  v_mfma_f32_32x32x16_bf16 v[64:79], v[208:211], a[176:179], v[64:79]
  buffer_load_dwordx4 a[160:163], v1, s[20:23], s75 offen offset:2048 sc1
  v_mfma_f32_32x32x16_bf16 v[80:95], v[212:215], a[176:179], v[80:95]
  v_mfma_f32_32x32x16_bf16 v[64:79], v[216:219], a[180:183], v[64:79]
  buffer_load_dwordx4 a[164:167], v1, s[20:23], s75 offen offset:3072 sc1
  v_mfma_f32_32x32x16_bf16 v[80:95], v[220:223], a[180:183], v[80:95]
  s_lshl_b32 s51, s40, 7
  s_add_u32 s51, s51, 0x3000
  s_mov_b64 exec, 0x3fff
  buffer_load_dword v56, v7, s[20:23], s51 offen sc1
  s_mov_b64 exec, -1
  s_waitcnt vmcnt(12)
  v_mfma_f32_32x32x16_bf16 v[64:79], v[224:227], a[184:187], v[64:79]
  s_add_u32 s76, s79, 0x6000
  buffer_load_dwordx4 a[168:171], v1, s[20:23], s76 offen offset:0 sc1
  v_mfma_f32_32x32x16_bf16 v[80:95], v[228:231], a[184:187], v[80:95]
  s_waitcnt vmcnt(12)
  v_mfma_f32_32x32x16_bf16 v[64:79], v[232:235], a[188:191], v[64:79]
  buffer_load_dwordx4 a[172:175], v1, s[20:23], s76 offen offset:1024 sc1
  v_mfma_f32_32x32x16_bf16 v[80:95], v[236:239], a[188:191], v[80:95]
  s_waitcnt vmcnt(12)
  v_mfma_f32_32x32x16_bf16 v[64:79], v[240:243], a[192:195], v[64:79]
  buffer_load_dwordx4 a[176:179], v1, s[20:23], s76 offen offset:2048 sc1
  v_mfma_f32_32x32x16_bf16 v[80:95], v[244:247], a[192:195], v[80:95]
  s_waitcnt vmcnt(12)
  v_mfma_f32_32x32x16_bf16 v[64:79], v[248:251], a[196:199], v[64:79]
  buffer_load_dwordx4 a[180:183], v1, s[20:23], s76 offen offset:3072 sc1
  v_mfma_f32_32x32x16_bf16 v[80:95], v[252:255], a[196:199], v[80:95]
  s_waitcnt vmcnt(12)
  v_mfma_f32_32x32x16_bf16 v[64:79], a[232:235], a[136:139], v[64:79]
  v_mfma_f32_32x32x16_bf16 v[80:95], a[236:239], a[136:139], v[80:95]
  s_waitcnt vmcnt(4)
  v_cmp_ne_u32 vcc, s43, v56
  s_nop 1
  s_and_b32 s56, vcc_lo, 0x3fff
  s_cbranch_scc1 L_fsp_73
L_fok_72:
  v_mfma_f32_32x32x16_bf16 v[64:79], a[240:243], a[140:143], v[64:79]
  buffer_load_dwordx4 a[184:187], v1, s[20:23], s88 offen offset:0 sc1
  v_mfma_f32_32x32x16_bf16 v[80:95], a[244:247], a[140:143], v[80:95]
  v_mfma_f32_32x32x16_bf16 v[64:79], a[248:251], a[144:147], v[64:79]
  buffer_load_dwordx4 a[188:191], v1, s[20:23], s88 offen offset:1024 sc1
  v_mfma_f32_32x32x16_bf16 v[80:95], a[252:255], a[144:147], v[80:95]
  v_mfma_f32_32x32x16_bf16 v[64:79], a[0:3], a[148:151], v[64:79]
  buffer_load_dwordx4 a[192:195], v1, s[20:23], s88 offen offset:2048 sc1
  v_mfma_f32_32x32x16_bf16 v[80:95], a[4:7], a[148:151], v[80:95]
  v_mfma_f32_32x32x16_bf16 v[64:79], a[8:11], a[152:155], v[64:79]
  buffer_load_dwordx4 a[196:199], v1, s[20:23], s88 offen offset:3072 sc1
  v_mfma_f32_32x32x16_bf16 v[80:95], a[12:15], a[152:155], v[80:95]
  v_mfma_f32_32x32x16_bf16 v[64:79], a[16:19], a[156:159], v[64:79]
  s_add_u32 s77, s88, 0x1000
  buffer_load_dwordx4 a[136:139], v1, s[20:23], s77 offen offset:0 sc1
  v_mfma_f32_32x32x16_bf16 v[80:95], a[20:23], a[156:159], v[80:95]
  v_mfma_f32_32x32x16_bf16 v[64:79], a[24:27], a[160:163], v[64:79]
  buffer_load_dwordx4 a[140:143], v1, s[20:23], s77 offen offset:1024 sc1
  v_mfma_f32_32x32x16_bf16 v[80:95], a[28:31], a[160:163], v[80:95]
  v_mfma_f32_32x32x16_bf16 v[64:79], a[32:35], a[164:167], v[64:79]
  buffer_load_dwordx4 a[144:147], v1, s[20:23], s77 offen offset:2048 sc1
  v_mfma_f32_32x32x16_bf16 v[80:95], a[36:39], a[164:167], v[80:95]
  s_waitcnt vmcnt(10)
  v_mfma_f32_32x32x16_bf16 v[64:79], a[40:43], a[168:171], v[64:79]
  buffer_load_dwordx4 a[148:151], v1, s[20:23], s77 offen offset:3072 sc1
  v_mfma_f32_32x32x16_bf16 v[80:95], a[44:47], a[168:171], v[80:95]
  s_waitcnt vmcnt(10)
  v_mfma_f32_32x32x16_bf16 v[64:79], a[48:51], a[172:175], v[64:79]
  s_add_u32 s74, s88, 0x2000
  buffer_load_dwordx4 a[152:155], v1, s[20:23], s74 offen offset:0 sc1
  v_mfma_f32_32x32x16_bf16 v[80:95], a[52:55], a[172:175], v[80:95]
  s_waitcnt vmcnt(10)
  v_mfma_f32_32x32x16_bf16 v[64:79], a[56:59], a[176:179], v[64:79]
  buffer_load_dwordx4 a[156:159], v1, s[20:23], s74 offen offset:1024 sc1
  v_mfma_f32_32x32x16_bf16 v[80:95], a[60:63], a[176:179], v[80:95]
  s_waitcnt vmcnt(10)
  v_mfma_f32_32x32x16_bf16 v[64:79], a[64:67], a[180:183], v[64:79]
  buffer_load_dwordx4 a[160:163], v1, s[20:23], s74 offen offset:2048 sc1
  v_mfma_f32_32x32x16_bf16 v[80:95], a[68:71], a[180:183], v[80:95]
  s_waitcnt vmcnt(10)
  v_mfma_f32_32x32x16_bf16 v[96:111], v[128:131], a[184:187], 0
  buffer_load_dwordx4 a[164:167], v1, s[20:23], s74 offen offset:3072 sc1
  v_mfma_f32_32x32x16_bf16 v[112:127], v[132:135], a[184:187], 0
  s_waitcnt vmcnt(10)
  v_mfma_f32_32x32x16_bf16 v[96:111], v[136:139], a[188:191], v[96:111]
  s_add_u32 s75, s88, 0x3000
  buffer_load_dwordx4 a[168:171], v1, s[20:23], s75 offen offset:0 sc1
  v_mfma_f32_32x32x16_bf16 v[112:127], v[140:143], a[188:191], v[112:127]
  s_waitcnt vmcnt(10)
  v_mfma_f32_32x32x16_bf16 v[96:111], v[144:147], a[192:195], v[96:111]
  buffer_load_dwordx4 a[172:175], v1, s[20:23], s75 offen offset:1024 sc1
  ds_write_b128 v10, v[72:75] offset:0
  v_mfma_f32_32x32x16_bf16 v[112:127], v[148:151], a[192:195], v[112:127]
  ds_write_b128 v10, v[76:79] offset:1024
  s_waitcnt vmcnt(10)
  v_mfma_f32_32x32x16_bf16 v[96:111], v[152:155], a[196:199], v[96:111]
  buffer_load_dwordx4 a[176:179], v1, s[20:23], s75 offen offset:2048 sc1
  ds_write_b128 v11, v[80:83] offset:0
  v_mfma_f32_32x32x16_bf16 v[112:127], v[156:159], a[196:199], v[112:127]
  ds_write_b128 v11, v[84:87] offset:1024
  s_waitcnt vmcnt(10)
  v_mfma_f32_32x32x16_bf16 v[96:111], v[160:163], a[136:139], v[96:111]
  buffer_load_dwordx4 a[180:183], v1, s[20:23], s75 offen offset:3072 sc1
  ds_write_b128 v12, v[88:91] offset:0
  v_mfma_f32_32x32x16_bf16 v[112:127], v[164:167], a[136:139], v[112:127]
  ds_write_b128 v12, v[92:95] offset:1024
  s_waitcnt vmcnt(10)
  v_mfma_f32_32x32x16_bf16 v[96:111], v[168:171], a[140:143], v[96:111]
  s_add_u32 s76, s88, 0x4000
  buffer_load_dwordx4 a[184:187], v1, s[20:23], s76 offen offset:0 sc1
  v_mfma_f32_32x32x16_bf16 v[112:127], v[172:175], a[140:143], v[112:127]
  s_waitcnt vmcnt(10)
  v_mfma_f32_32x32x16_bf16 v[96:111], v[176:179], a[144:147], v[96:111]
  buffer_load_dwordx4 a[188:191], v1, s[20:23], s76 offen offset:1024 sc1
  v_mfma_f32_32x32x16_bf16 v[112:127], v[180:183], a[144:147], v[112:127]
  s_waitcnt lgkmcnt(0)
  s_barrier
  ds_read_b128 v[72:75], v13 offset:0
  ds_read_b128 v[76:79], v13 offset:1024
  ds_read_b128 v[80:83], v13 offset:2048
  s_waitcnt vmcnt(10)
  v_mfma_f32_32x32x16_bf16 v[96:111], v[184:187], a[148:151], v[96:111]
  buffer_load_dwordx4 a[192:195], v1, s[20:23], s76 offen offset:2048 sc1
  ds_read_b128 v[84:87], v13 offset:3072
  ds_read_b128 v[88:91], v13 offset:4096
  ds_read_b128 v[92:95], v13 offset:5120
  s_add_u32 s57, s32, 0x834000
  v_mfma_f32_32x32x16_bf16 v[112:127], v[188:191], a[148:151], v[112:127]
  s_add_u32 s58, s33, 0x1130000
  v_lshlrev_b32 v40, 16, v16
  v_and_b32 v16, 0xffff0000, v16
  v_lshlrev_b32 v41, 16, v17
  s_waitcnt vmcnt(10)
  v_mfma_f32_32x32x16_bf16 v[96:111], v[192:195], a[152:155], v[96:111]
  buffer_load_dwordx4 a[196:199], v1, s[20:23], s76 offen offset:3072 sc1
  v_and_b32 v17, 0xffff0000, v17
  v_lshlrev_b32 v42, 16, v18
  v_and_b32 v18, 0xffff0000, v18
  v_lshlrev_b32 v43, 16, v19
  v_mfma_f32_32x32x16_bf16 v[112:127], v[196:199], a[152:155], v[112:127]
  v_and_b32 v19, 0xffff0000, v19
  v_add_f32 v64, v64, v40
  v_add_f32 v65, v65, v16
  v_add_f32 v66, v66, v41
  s_waitcnt vmcnt(10)
  v_mfma_f32_32x32x16_bf16 v[96:111], v[200:203], a[156:159], v[96:111]
  s_add_u32 s77, s88, 0x5000
  buffer_load_dwordx4 a[136:139], v1, s[20:23], s77 offen offset:0 sc1
  v_add_f32 v67, v67, v17
  v_add_f32 v68, v68, v42
  v_add_f32 v69, v69, v18
  v_add_f32 v70, v70, v43
  v_mfma_f32_32x32x16_bf16 v[112:127], v[204:207], a[156:159], v[112:127]
  v_add_f32 v71, v71, v19
  s_waitcnt lgkmcnt(4)
  v_add_f32 v64, v64, v72
  v_add_f32 v65, v65, v73
  v_add_f32 v66, v66, v74
  s_waitcnt vmcnt(10)
  v_mfma_f32_32x32x16_bf16 v[96:111], v[208:211], a[160:163], v[96:111]
  buffer_load_dwordx4 a[140:143], v1, s[20:23], s77 offen offset:1024 sc1
  v_add_f32 v67, v67, v75
  v_add_f32 v68, v68, v76
  v_add_f32 v69, v69, v77
  v_add_f32 v70, v70, v78
  v_mfma_f32_32x32x16_bf16 v[112:127], v[212:215], a[160:163], v[112:127]
  v_add_f32 v71, v71, v79
  s_waitcnt lgkmcnt(2)
  v_add_f32 v64, v64, v80
  v_add_f32 v65, v65, v81
  v_add_f32 v66, v66, v82
  s_waitcnt vmcnt(10)
  v_mfma_f32_32x32x16_bf16 v[96:111], v[216:219], a[164:167], v[96:111]
  buffer_load_dwordx4 a[144:147], v1, s[20:23], s77 offen offset:2048 sc1
  v_add_f32 v67, v67, v83
  v_add_f32 v68, v68, v84
  v_add_f32 v69, v69, v85
  v_add_f32 v70, v70, v86
  v_mfma_f32_32x32x16_bf16 v[112:127], v[220:223], a[164:167], v[112:127]
  v_add_f32 v71, v71, v87
  s_waitcnt lgkmcnt(0)
  v_add_f32 v64, v64, v88
  v_add_f32 v65, v65, v89
  v_add_f32 v66, v66, v90
  s_waitcnt vmcnt(10)
  v_mfma_f32_32x32x16_bf16 v[96:111], v[224:227], a[168:171], v[96:111]
  buffer_load_dwordx4 a[148:151], v1, s[20:23], s77 offen offset:3072 sc1
  v_add_f32 v67, v67, v91
  v_add_f32 v68, v68, v92
  v_add_f32 v69, v69, v93
  v_add_f32 v70, v70, v94
  v_mfma_f32_32x32x16_bf16 v[112:127], v[228:231], a[168:171], v[112:127]
  v_add_f32 v71, v71, v95
  v_cvt_pk_bf16_f32 v40, v64, v65
  v_cvt_pk_bf16_f32 v41, v66, v67
  v_cvt_pk_bf16_f32 v42, v68, v69
  s_waitcnt vmcnt(10)
  v_mfma_f32_32x32x16_bf16 v[96:111], v[232:235], a[172:175], v[96:111]
  s_add_u32 s74, s88, 0x6000
  buffer_load_dwordx4 a[152:155], v1, s[20:23], s74 offen offset:0 sc1
  v_cvt_pk_bf16_f32 v43, v70, v71
  v_cvt_pk_bf16_f32 v16, v64, v65
  v_cvt_pk_bf16_f32 v17, v66, v67
  v_cvt_pk_bf16_f32 v18, v68, v69
  v_mfma_f32_32x32x16_bf16 v[112:127], v[236:239], a[172:175], v[112:127]
  v_cvt_pk_bf16_f32 v19, v70, v71
  v_permlane32_swap_b32 v40, v42
  v_permlane32_swap_b32 v41, v43
  s_waitcnt vmcnt(10)
  v_mfma_f32_32x32x16_bf16 v[96:111], v[240:243], a[176:179], v[96:111]
  buffer_load_dwordx4 a[156:159], v1, s[20:23], s74 offen offset:1024 sc1
  s_cmp_eq_u32 s44, 0
  s_cbranch_scc1 L_slow_75
  buffer_store_dwordx4 v[40:43], v1, s[20:23], s57 offen nt
L_join_76:
  v_mfma_f32_32x32x16_bf16 v[112:127], v[244:247], a[176:179], v[112:127]
  v_add_f32 v44, v64, v65
  v_mul_f32 v45, v64, v64
  v_fmac_f32 v45, v65, v65
  v_add_f32 v44, v44, v66
  s_waitcnt vmcnt(11)
  v_mfma_f32_32x32x16_bf16 v[96:111], v[248:251], a[180:183], v[96:111]
  buffer_load_dwordx4 a[160:163], v1, s[20:23], s74 offen offset:2048 sc1
  v_fmac_f32 v45, v66, v66
  v_add_f32 v44, v44, v67
  v_fmac_f32 v45, v67, v67
  v_add_f32 v44, v44, v68
  v_mfma_f32_32x32x16_bf16 v[112:127], v[252:255], a[180:183], v[112:127]
  v_fmac_f32 v45, v68, v68
  v_add_f32 v44, v44, v69
  v_fmac_f32 v45, v69, v69
  v_add_f32 v44, v44, v70
  s_waitcnt vmcnt(11)
  v_mfma_f32_32x32x16_bf16 v[96:111], a[232:235], a[184:187], v[96:111]
  buffer_load_dwordx4 a[164:167], v1, s[20:23], s74 offen offset:3072 sc1
  v_fmac_f32 v45, v70, v70
  v_add_f32 v44, v44, v71
  v_fmac_f32 v45, v71, v71
  s_nop 1
  v_permlane32_swap_b32 v44, v45
  v_mfma_f32_32x32x16_bf16 v[112:127], a[236:239], a[184:187], v[112:127]
  v_add_f32 v44, v44, v45
  s_waitcnt vmcnt(11)
  v_mfma_f32_32x32x16_bf16 v[96:111], a[240:243], a[188:191], v[96:111]
  s_cmp_eq_u32 s44, 0
  s_cbranch_scc1 L_slow_77
  buffer_store_dword v44, v4, s[20:23], s58 offen nt
L_join_78:
  v_mfma_f32_32x32x16_bf16 v[112:127], a[244:247], a[188:191], v[112:127]
  s_waitcnt vmcnt(11)
  v_mfma_f32_32x32x16_bf16 v[96:111], a[248:251], a[192:195], v[96:111]
  v_mfma_f32_32x32x16_bf16 v[112:127], a[252:255], a[192:195], v[112:127]
  s_waitcnt vmcnt(10)
  v_mfma_f32_32x32x16_bf16 v[96:111], a[0:3], a[196:199], v[96:111]
  v_mfma_f32_32x32x16_bf16 v[112:127], a[4:7], a[196:199], v[112:127]
  s_waitcnt vmcnt(9)
  v_mfma_f32_32x32x16_bf16 v[96:111], a[8:11], a[136:139], v[96:111]
  v_mfma_f32_32x32x16_bf16 v[112:127], a[12:15], a[136:139], v[112:127]
  s_waitcnt vmcnt(8)
  v_mfma_f32_32x32x16_bf16 v[96:111], a[16:19], a[140:143], v[96:111]
  v_mfma_f32_32x32x16_bf16 v[112:127], a[20:23], a[140:143], v[112:127]
  s_waitcnt vmcnt(7)
  v_mfma_f32_32x32x16_bf16 v[96:111], a[24:27], a[144:147], v[96:111]
  v_mfma_f32_32x32x16_bf16 v[112:127], a[28:31], a[144:147], v[112:127]
  s_waitcnt vmcnt(6)
  v_mfma_f32_32x32x16_bf16 v[96:111], a[32:35], a[148:151], v[96:111]
  v_mfma_f32_32x32x16_bf16 v[112:127], a[36:39], a[148:151], v[112:127]
  s_waitcnt vmcnt(5)
  v_mfma_f32_32x32x16_bf16 v[96:111], a[40:43], a[152:155], v[96:111]
  v_mfma_f32_32x32x16_bf16 v[112:127], a[44:47], a[152:155], v[112:127]
  s_waitcnt vmcnt(4)
  v_mfma_f32_32x32x16_bf16 v[96:111], a[48:51], a[156:159], v[96:111]
  v_mfma_f32_32x32x16_bf16 v[112:127], a[52:55], a[156:159], v[112:127]
  s_waitcnt vmcnt(2)
  v_mfma_f32_32x32x16_bf16 v[96:111], a[56:59], a[160:163], v[96:111]
  v_mfma_f32_32x32x16_bf16 v[112:127], a[60:63], a[160:163], v[112:127]
  s_waitcnt vmcnt(1)
  v_mfma_f32_32x32x16_bf16 v[96:111], a[64:67], a[164:167], v[96:111]
  v_mfma_f32_32x32x16_bf16 v[112:127], a[68:71], a[164:167], v[112:127]
  s_nop 10
  ds_write_b128 v10, v[104:107] offset:24576
  ds_write_b128 v10, v[108:111] offset:25600
  ds_write_b128 v11, v[112:115] offset:24576
  ds_write_b128 v11, v[116:119] offset:25600
  ds_write_b128 v12, v[120:123] offset:24576
  ds_write_b128 v12, v[124:127] offset:25600
  v_dot2_f32_bf16 v96, v20, s60, v96
  v_dot2_f32_bf16 v97, v20, s61, v97
  v_dot2_f32_bf16 v98, v21, s60, v98
  v_dot2_f32_bf16 v99, v21, s61, v99
  v_dot2_f32_bf16 v100, v22, s60, v100
  v_dot2_f32_bf16 v101, v22, s61, v101
  v_dot2_f32_bf16 v102, v23, s60, v102
  v_dot2_f32_bf16 v103, v23, s61, v103
  s_waitcnt lgkmcnt(0)
  s_barrier
  ds_read_b128 v[104:107], v13 offset:24576
  ds_read_b128 v[108:111], v13 offset:25600
  ds_read_b128 v[112:115], v13 offset:26624
  ds_read_b128 v[116:119], v13 offset:27648
  ds_read_b128 v[120:123], v13 offset:28672
  ds_read_b128 v[124:127], v13 offset:29696
  s_add_u32 s57, s32, 0x842000
  s_add_u32 s58, s33, 0x1133800
  s_waitcnt lgkmcnt(4)
  v_pk_add_f32 v[96:97], v[96:97], v[104:105]
  v_pk_add_f32 v[98:99], v[98:99], v[106:107]
  v_pk_add_f32 v[100:101], v[100:101], v[108:109]
  v_pk_add_f32 v[102:103], v[102:103], v[110:111]
  s_waitcnt lgkmcnt(2)
  v_pk_add_f32 v[96:97], v[96:97], v[112:113]
  v_pk_add_f32 v[98:99], v[98:99], v[114:115]
  v_pk_add_f32 v[100:101], v[100:101], v[116:117]
  v_pk_add_f32 v[102:103], v[102:103], v[118:119]
  s_waitcnt lgkmcnt(0)
  v_pk_add_f32 v[96:97], v[96:97], v[120:121]
  v_pk_add_f32 v[98:99], v[98:99], v[122:123]
  v_pk_add_f32 v[100:101], v[100:101], v[124:125]
  v_pk_add_f32 v[102:103], v[102:103], v[126:127]
  v_cvt_pk_bf16_f32 v48, v96, v97
  v_cvt_pk_bf16_f32 v49, v98, v99
  v_cvt_pk_bf16_f32 v50, v100, v101
  v_cvt_pk_bf16_f32 v51, v102, v103
  v_cvt_pk_bf16_f32 v20, v96, v97
  v_cvt_pk_bf16_f32 v21, v98, v99
  v_cvt_pk_bf16_f32 v22, v100, v101
  v_cvt_pk_bf16_f32 v23, v102, v103
  v_permlane32_swap_b32 v48, v50
  v_permlane32_swap_b32 v49, v51
  s_cmp_eq_u32 s44, 0
  s_cbranch_scc1 L_slow_79
  buffer_store_dwordx4 v[48:51], v1, s[20:23], s57 offen nt
L_join_80:
  v_dot2_f32_bf16 v52, v20, s62, 0
  v_dot2_f32_bf16 v53, v20, v20, 0
  v_dot2_f32_bf16 v52, v21, s62, v52
  v_dot2_f32_bf16 v53, v21, v21, v53
  v_dot2_f32_bf16 v52, v22, s62, v52
  v_dot2_f32_bf16 v53, v22, v22, v53
  v_dot2_f32_bf16 v52, v23, s62, v52
  v_dot2_f32_bf16 v53, v23, v23, v53
  s_nop 2
  v_permlane32_swap_b32 v52, v53
  v_add_f32 v52, v52, v53
  s_cmp_eq_u32 s44, 0
  s_cbranch_scc1 L_slow_81
  buffer_store_dword v52, v4, s[20:23], s58 offen nt
L_join_82:
  s_waitcnt vmcnt(0) lgkmcnt(0)
  s_barrier
  s_cmp_lg_u32 s42, 0
  s_cbranch_scc1 L_pubskip_83
  s_lshl_b32 s56, s40, 7
  s_lshl_b32 s57, s41, 2
  s_add_u32 s56, s56, s57
  s_add_u32 s56, s56, 0x3800
  v_mov_b32 v8, s43
  s_mov_b64 exec, 1
  s_cmp_eq_u32 s44, 0
  s_cbranch_scc1 L_slow_84
  buffer_store_dword v8, v7, s[20:23], s56 offen
L_join_85:
  s_mov_b64 exec, -1
  s_nop 0
L_pubskip_83:
L_join0:
  s_mul_i32 s69, s42, 28672
  s_add_u32 s69, s69, s39
  s_add_u32 s69, s69, 0x834000
  s_cmp_lg_u32 s42, 0
  s_cbranch_scc1 L_pollskip_86
  s_lshl_b32 s56, s40, 7
  s_add_u32 s56, s56, 0x3800
  s_mov_b32 s63, 0
  s_mov_b64 exec, 0x3fff
L_poll_87:
  buffer_load_dword v8, v7, s[20:23], s56 offen sc1
  s_waitcnt vmcnt(0)
  v_cmp_ne_u32 vcc, s43, v8
  s_add_u32 s63, s63, 1
  s_nop 1
  s_cbranch_vccz L_polldone_88
  s_cmp_lt_u32 s63, 262144
  s_cbranch_scc1 L_poll_87
L_polldone_88:
  s_mov_b64 exec, -1
L_pollskip_86:
  s_barrier
  buffer_load_dwordx4 v[128:131], v1, s[20:23], s69 offen offset:0 sc1
  buffer_load_dwordx4 v[132:135], v1, s[20:23], s69 offen offset:1024 sc1
  buffer_load_dwordx4 v[136:139], v1, s[20:23], s69 offen offset:2048 sc1
  buffer_load_dwordx4 v[140:143], v1, s[20:23], s69 offen offset:3072 sc1
  s_add_u32 s75, s69, 0x1000
  buffer_load_dwordx4 v[144:147], v1, s[20:23], s75 offen offset:0 sc1
  buffer_load_dwordx4 v[148:151], v1, s[20:23], s75 offen offset:1024 sc1
  buffer_load_dwordx4 v[152:155], v1, s[20:23], s75 offen offset:2048 sc1
  buffer_load_dwordx4 v[156:159], v1, s[20:23], s75 offen offset:3072 sc1
  s_add_u32 s76, s69, 0x2000
  buffer_load_dwordx4 v[160:163], v1, s[20:23], s76 offen offset:0 sc1
  ds_read_b128 v[96:99], v1 offset:0
  ds_read_b128 v[100:103], v1 offset:29696
  ds_read_b128 v[104:107], v1 offset:1024
  ds_read_b128 v[108:111], v1 offset:30720
  ds_read_b128 v[112:115], v1 offset:2048
  ds_read_b128 v[116:119], v1 offset:31744
  s_waitcnt vmcnt(8) lgkmcnt(4)
  v_mfma_f32_32x32x16_bf16 v[64:79], v[96:99], v[128:131], 0
  buffer_load_dwordx4 v[164:167], v1, s[20:23], s76 offen offset:1024 sc1
  v_mfma_f32_32x32x16_bf16 v[80:95], v[128:131], v[100:103], 0
  ds_read_b128 v[120:123], v1 offset:3072
  ds_read_b128 v[124:127], v1 offset:32768
  s_waitcnt vmcnt(8) lgkmcnt(4)
  v_mfma_f32_32x32x16_bf16 v[64:79], v[104:107], v[132:135], v[64:79]
  buffer_load_dwordx4 v[168:171], v1, s[20:23], s76 offen offset:2048 sc1
  v_mfma_f32_32x32x16_bf16 v[80:95], v[132:135], v[108:111], v[80:95]
  buffer_load_dwordx4 v[172:175], v1, s[20:23], s76 offen offset:3072 sc1
  ds_read_b128 v[96:99], v1 offset:4096
  ds_read_b128 v[100:103], v1 offset:33792
  s_waitcnt vmcnt(9) lgkmcnt(4)
  v_mfma_f32_32x32x16_bf16 v[64:79], v[112:115], v[136:139], v[64:79]
  s_add_u32 s77, s69, 0x3000
  buffer_load_dwordx4 v[176:179], v1, s[20:23], s77 offen offset:0 sc1
  v_mfma_f32_32x32x16_bf16 v[80:95], v[136:139], v[116:119], v[80:95]
  ds_read_b128 v[104:107], v1 offset:5120
  ds_read_b128 v[108:111], v1 offset:34816
  s_waitcnt vmcnt(9) lgkmcnt(4)
  v_mfma_f32_32x32x16_bf16 v[64:79], v[120:123], v[140:143], v[64:79]
  buffer_load_dwordx4 v[180:183], v1, s[20:23], s77 offen offset:1024 sc1
  v_mfma_f32_32x32x16_bf16 v[80:95], v[140:143], v[124:127], v[80:95]
  ds_read_b128 v[112:115], v1 offset:6144
  ds_read_b128 v[116:119], v1 offset:35840
  s_waitcnt vmcnt(9) lgkmcnt(4)
  v_mfma_f32_32x32x16_bf16 v[64:79], v[96:99], v[144:147], v[64:79]
  buffer_load_dwordx4 v[184:187], v1, s[20:23], s77 offen offset:2048 sc1
  v_mfma_f32_32x32x16_bf16 v[80:95], v[144:147], v[100:103], v[80:95]
  ds_read_b128 v[120:123], v1 offset:7168
  ds_read_b128 v[124:127], v1 offset:36864
  s_waitcnt vmcnt(9) lgkmcnt(4)
  v_mfma_f32_32x32x16_bf16 v[64:79], v[104:107], v[148:151], v[64:79]
  buffer_load_dwordx4 v[188:191], v1, s[20:23], s77 offen offset:3072 sc1
  v_mfma_f32_32x32x16_bf16 v[80:95], v[148:151], v[108:111], v[80:95]
  s_add_u32 s74, s69, 0x4000
  buffer_load_dwordx4 v[192:195], v1, s[20:23], s74 offen offset:0 sc1
  ds_read_b128 v[96:99], v1 offset:8192
  ds_read_b128 v[100:103], v1 offset:37888
  s_waitcnt vmcnt(10) lgkmcnt(4)
  v_mfma_f32_32x32x16_bf16 v[64:79], v[112:115], v[152:155], v[64:79]
  buffer_load_dwordx4 v[196:199], v1, s[20:23], s74 offen offset:1024 sc1
  v_mfma_f32_32x32x16_bf16 v[80:95], v[152:155], v[116:119], v[80:95]
  ds_read_b128 v[104:107], v1 offset:9216
  ds_read_b128 v[108:111], v1 offset:38912
  s_waitcnt vmcnt(10) lgkmcnt(4)
  v_mfma_f32_32x32x16_bf16 v[64:79], v[120:123], v[156:159], v[64:79]
  buffer_load_dwordx4 v[200:203], v1, s[20:23], s74 offen offset:2048 sc1
  v_mfma_f32_32x32x16_bf16 v[80:95], v[156:159], v[124:127], v[80:95]
  ds_read_b128 v[112:115], v1 offset:10240
  ds_read_b128 v[116:119], v1 offset:39936
  s_waitcnt vmcnt(10) lgkmcnt(4)
  v_mfma_f32_32x32x16_bf16 v[64:79], v[96:99], v[160:163], v[64:79]
  buffer_load_dwordx4 v[204:207], v1, s[20:23], s74 offen offset:3072 sc1
  v_mfma_f32_32x32x16_bf16 v[80:95], v[160:163], v[100:103], v[80:95]
  ds_read_b128 v[120:123], v1 offset:11264
  ds_read_b128 v[124:127], v1 offset:40960
  s_waitcnt vmcnt(10) lgkmcnt(4)
  v_mfma_f32_32x32x16_bf16 v[64:79], v[104:107], v[164:167], v[64:79]
  s_add_u32 s75, s69, 0x5000
  buffer_load_dwordx4 v[208:211], v1, s[20:23], s75 offen offset:0 sc1
  v_mfma_f32_32x32x16_bf16 v[80:95], v[164:167], v[108:111], v[80:95]
  buffer_load_dwordx4 v[212:215], v1, s[20:23], s75 offen offset:1024 sc1
  ds_read_b128 v[96:99], v1 offset:12288
  ds_read_b128 v[100:103], v1 offset:41984
  s_waitcnt vmcnt(11) lgkmcnt(4)
  v_mfma_f32_32x32x16_bf16 v[64:79], v[112:115], v[168:171], v[64:79]
  buffer_load_dwordx4 v[216:219], v1, s[20:23], s75 offen offset:2048 sc1
  v_mfma_f32_32x32x16_bf16 v[80:95], v[168:171], v[116:119], v[80:95]
  ds_read_b128 v[104:107], v1 offset:13312
  ds_read_b128 v[108:111], v1 offset:43008
  s_waitcnt vmcnt(11) lgkmcnt(4)
  v_mfma_f32_32x32x16_bf16 v[64:79], v[120:123], v[172:175], v[64:79]
  buffer_load_dwordx4 v[220:223], v1, s[20:23], s75 offen offset:3072 sc1
  v_mfma_f32_32x32x16_bf16 v[80:95], v[172:175], v[124:127], v[80:95]
  ds_read_b128 v[112:115], v1 offset:14336
  ds_read_b128 v[116:119], v1 offset:44032
  s_waitcnt vmcnt(11) lgkmcnt(4)
  v_mfma_f32_32x32x16_bf16 v[64:79], v[96:99], v[176:179], v[64:79]
  s_add_u32 s76, s69, 0x6000
  buffer_load_dwordx4 v[224:227], v1, s[20:23], s76 offen offset:0 sc1
  v_mfma_f32_32x32x16_bf16 v[80:95], v[176:179], v[100:103], v[80:95]
  ds_read_b128 v[120:123], v1 offset:15360
  ds_read_b128 v[124:127], v1 offset:45056
  s_waitcnt vmcnt(11) lgkmcnt(4)
  v_mfma_f32_32x32x16_bf16 v[64:79], v[104:107], v[180:183], v[64:79]
  buffer_load_dwordx4 v[228:231], v1, s[20:23], s76 offen offset:1024 sc1
  v_mfma_f32_32x32x16_bf16 v[80:95], v[180:183], v[108:111], v[80:95]
  buffer_load_dwordx4 v[232:235], v1, s[20:23], s76 offen offset:2048 sc1
  ds_read_b128 v[96:99], v1 offset:16384
  ds_read_b128 v[100:103], v1 offset:46080
  s_waitcnt vmcnt(12) lgkmcnt(4)
  v_mfma_f32_32x32x16_bf16 v[64:79], v[112:115], v[184:187], v[64:79]
  buffer_load_dwordx4 v[236:239], v1, s[20:23], s76 offen offset:3072 sc1
  v_mfma_f32_32x32x16_bf16 v[80:95], v[184:187], v[116:119], v[80:95]
  ds_read_b128 v[104:107], v1 offset:17408
  ds_read_b128 v[108:111], v1 offset:47104
  s_waitcnt vmcnt(12) lgkmcnt(4)
  v_mfma_f32_32x32x16_bf16 v[64:79], v[120:123], v[188:191], v[64:79]
  s_lshl_b32 s91, s40, 2
  s_add_u32 s91, s91, s42
  s_mul_i32 s91, s91, 7168
  s_add_u32 s91, s91, 0x1130000
  buffer_load_dwordx4 v[24:27], v5, s[20:23], s91 offen offset:0 sc1
  v_mfma_f32_32x32x16_bf16 v[80:95], v[188:191], v[124:127], v[80:95]
  ds_read_b128 v[112:115], v1 offset:18432
  ds_read_b128 v[116:119], v1 offset:48128
  s_waitcnt vmcnt(12) lgkmcnt(4)
  v_mfma_f32_32x32x16_bf16 v[64:79], v[96:99], v[192:195], v[64:79]
  buffer_load_dwordx4 v[28:31], v5, s[20:23], s91 offen offset:1024 sc1
  v_mfma_f32_32x32x16_bf16 v[80:95], v[192:195], v[100:103], v[80:95]
  ds_read_b128 v[120:123], v1 offset:19456
  ds_read_b128 v[124:127], v1 offset:49152
  s_waitcnt vmcnt(12) lgkmcnt(4)
  v_mfma_f32_32x32x16_bf16 v[64:79], v[104:107], v[196:199], v[64:79]
  buffer_load_dwordx4 v[32:35], v5, s[20:23], s91 offen offset:2048 sc1
  v_mfma_f32_32x32x16_bf16 v[80:95], v[196:199], v[108:111], v[80:95]
  buffer_load_dwordx4 v[36:39], v5, s[20:23], s91 offen offset:3072 sc1
  ds_read_b128 v[96:99], v1 offset:20480
  ds_read_b128 v[100:103], v1 offset:50176
  s_waitcnt vmcnt(13) lgkmcnt(4)
  v_mfma_f32_32x32x16_bf16 v[64:79], v[112:115], v[200:203], v[64:79]
  s_add_u32 s91, s91, 4096
  buffer_load_dwordx4 v[40:43], v5, s[20:23], s91 offen offset:0 sc1
  v_mfma_f32_32x32x16_bf16 v[80:95], v[200:203], v[116:119], v[80:95]
  ds_read_b128 v[104:107], v1 offset:21504
  ds_read_b128 v[108:111], v1 offset:51200
  s_waitcnt vmcnt(13) lgkmcnt(4)
  v_mfma_f32_32x32x16_bf16 v[64:79], v[120:123], v[204:207], v[64:79]
  buffer_load_dwordx4 v[44:47], v5, s[20:23], s91 offen offset:1024 sc1
  v_mfma_f32_32x32x16_bf16 v[80:95], v[204:207], v[124:127], v[80:95]
  ds_read_b128 v[112:115], v1 offset:22528
  ds_read_b128 v[116:119], v1 offset:52224
  s_waitcnt vmcnt(13) lgkmcnt(4)
  v_mfma_f32_32x32x16_bf16 v[64:79], v[96:99], v[208:211], v[64:79]
  buffer_load_dwordx4 v[48:51], v5, s[20:23], s91 offen offset:2048 sc1
  v_mfma_f32_32x32x16_bf16 v[80:95], v[208:211], v[100:103], v[80:95]
  ds_read_b128 v[120:123], v1 offset:23552
  ds_read_b128 v[124:127], v1 offset:53248
  s_waitcnt vmcnt(13) lgkmcnt(4)
  v_mfma_f32_32x32x16_bf16 v[64:79], v[104:107], v[212:215], v[64:79]
  buffer_load_dwordx4 a[0:3], v1, s[20:23], s36 offen offset:0
  v_mfma_f32_32x32x16_bf16 v[80:95], v[212:215], v[108:111], v[80:95]
  ds_read_b128 v[96:99], v1 offset:24576
  ds_read_b128 v[100:103], v1 offset:54272
  s_waitcnt vmcnt(13) lgkmcnt(4)
  v_mfma_f32_32x32x16_bf16 v[64:79], v[112:115], v[216:219], v[64:79]
  buffer_load_dwordx4 a[4:7], v1, s[20:23], s36 offen offset:1024
  v_mfma_f32_32x32x16_bf16 v[80:95], v[216:219], v[116:119], v[80:95]
  ds_read_b128 v[104:107], v1 offset:25600
  ds_read_b128 v[108:111], v1 offset:55296
  s_waitcnt vmcnt(13) lgkmcnt(4)
  v_mfma_f32_32x32x16_bf16 v[64:79], v[120:123], v[220:223], v[64:79]
  buffer_load_dwordx4 a[8:11], v1, s[20:23], s36 offen offset:2048
  v_mfma_f32_32x32x16_bf16 v[80:95], v[220:223], v[124:127], v[80:95]
  ds_read_b128 v[112:115], v1 offset:26624
  ds_read_b128 v[116:119], v1 offset:56320
  s_waitcnt vmcnt(13) lgkmcnt(4)
  v_mfma_f32_32x32x16_bf16 v[64:79], v[96:99], v[224:227], v[64:79]
  buffer_load_dwordx4 a[12:15], v1, s[20:23], s36 offen offset:3072
  v_mfma_f32_32x32x16_bf16 v[80:95], v[224:227], v[100:103], v[80:95]
  ds_read_b128 v[120:123], v1 offset:27648
  ds_read_b128 v[124:127], v1 offset:57344
  s_waitcnt vmcnt(13) lgkmcnt(4)
  v_mfma_f32_32x32x16_bf16 v[64:79], v[104:107], v[228:231], v[64:79]
  s_add_u32 s70, s36, 0x1000
  buffer_load_dwordx4 a[16:19], v1, s[20:23], s70 offen offset:0
  v_mfma_f32_32x32x16_bf16 v[80:95], v[228:231], v[108:111], v[80:95]
  ds_read_b128 v[96:99], v1 offset:28672
  ds_read_b128 v[100:103], v1 offset:58368
  s_waitcnt vmcnt(13) lgkmcnt(4)
  v_mfma_f32_32x32x16_bf16 v[64:79], v[112:115], v[232:235], v[64:79]
  s_add_u32 s71, s36, 0x1000
  buffer_load_dwordx4 a[20:23], v1, s[20:23], s71 offen offset:1024
  v_mfma_f32_32x32x16_bf16 v[80:95], v[232:235], v[116:119], v[80:95]
  s_waitcnt vmcnt(13) lgkmcnt(2)
  v_mfma_f32_32x32x16_bf16 v[64:79], v[120:123], v[236:239], v[64:79]
  s_add_u32 s72, s36, 0x1000
  buffer_load_dwordx4 a[24:27], v1, s[20:23], s72 offen offset:2048
  v_mfma_f32_32x32x16_bf16 v[80:95], v[236:239], v[124:127], v[80:95]
  s_waitcnt vmcnt(7)
  v_pk_add_f32 v[24:25], v[24:25], v[50:51]
  v_pk_add_f32 v[26:27], v[26:27], v[48:49]
  v_pk_add_f32 v[28:29], v[28:29], v[46:47]
  v_pk_add_f32 v[30:31], v[30:31], v[44:45]
  v_pk_add_f32 v[32:33], v[32:33], v[42:43]
  v_pk_add_f32 v[34:35], v[34:35], v[40:41]
  v_pk_add_f32 v[36:37], v[36:37], v[38:39]
  v_pk_add_f32 v[24:25], v[24:25], v[36:37]
  v_pk_add_f32 v[26:27], v[26:27], v[34:35]
  v_pk_add_f32 v[28:29], v[28:29], v[32:33]
  v_pk_add_f32 v[24:25], v[24:25], v[30:31]
  v_pk_add_f32 v[26:27], v[26:27], v[28:29]
  v_pk_add_f32 v[24:25], v[24:25], v[26:27]
  s_nop 1
  v_permlane32_swap_b32 v24, v25
  v_add_f32 v24, v24, v25
  v_mov_b32 v25, v24
  s_nop 1
  v_permlane32_swap_b32 v24, v25
  v_mul_f32 v24, 0x3b124925, v24
  v_mul_f32 v25, 0x3b124925, v25
  v_fma_f32 v25, -v24, v24, v25
  v_max_f32 v25, 0, v25
  v_cvt_pk_bf16_f32 v240, -v24, -v24
  v_cvt_pk_bf16_f32 v244, v25, v25
  v_and_b32 v244, 0xffff0000, v244
  v_add_f32 v244, 0x3727c5ac, v244
  v_cvt_pk_bf16_f32 v244, v244, v244
  v_and_b32 v244, 0xffff0000, v244
  v_sqrt_f32 v244, v244
  s_nop 0
  v_cvt_pk_bf16_f32 v244, v244, v244
  v_and_b32 v243, 0xffff0000, v244
  v_lshrrev_b32 v241, 16, v244
  v_rcp_f32 v242, v243
  s_nop 0
  v_mov_b32 v246, v242
  v_mul_f32 v248, 0x3fb8aa3b, v242
  v_mov_b32 v242, 0
  v_mov_b32 v243, 0
  s_waitcnt lgkmcnt(0)
  s_nop 0
  v_mfma_f32_32x32x16_bf16 v[64:79], v[96:99], v[240:243], v[64:79]
  v_mfma_f32_32x32x16_bf16 v[80:95], v[240:243], v[100:103], v[80:95]
  ds_read_b128 v[104:107], v2 offset:23552
  ds_read_b128 v[108:111], v2 offset:24576
  s_nop 8
  v_max3_f32 v8, v64, v65, v66
  v_max3_f32 v9, -v64, -v65, -v66
  v_max3_f32 v8, v8, v67, v68
  v_max3_f32 v9, v9, -v67, -v68
  v_max3_f32 v8, v8, v69, v70
  v_max3_f32 v9, v9, -v69, -v70
  v_max3_f32 v8, v8, v71, v72
  v_max3_f32 v9, v9, -v71, -v72
  s_add_u32 s73, s36, 0x1000
  buffer_load_dwordx4 a[28:31], v1, s[20:23], s73 offen offset:3072
  v_max3_f32 v8, v8, v73, v74
  v_max3_f32 v9, v9, -v73, -v74
  v_max3_f32 v8, v8, v75, v76
  v_max3_f32 v9, v9, -v75, -v76
  v_max_f32 v8, v8, v77
  v_max_f32 v9, v9, -v77
  s_nop 1
  v_permlane32_swap_b32 v8, v9
  v_max_f32 v8, v8, v9
  v_mul_f32 v8, v8, v248
  v_mov_b32 v9, v8
  s_nop 1
  v_permlane32_swap_b32 v8, v9
  v_pk_fma_f32 v[40:41], v[64:65], v[248:249], v[8:9] op_sel:[0,0,0] op_sel_hi:[1,0,0] neg_lo:[0,0,1] neg_hi:[0,0,1]
  v_pk_fma_f32 v[42:43], v[66:67], v[248:249], v[8:9] op_sel:[0,0,0] op_sel_hi:[1,0,0] neg_lo:[0,0,1] neg_hi:[0,0,1]
  v_pk_fma_f32 v[44:45], v[68:69], v[248:249], v[8:9] op_sel:[0,0,0] op_sel_hi:[1,0,0] neg_lo:[0,0,1] neg_hi:[0,0,1]
  v_pk_fma_f32 v[46:47], v[70:71], v[248:249], v[8:9] op_sel:[0,0,0] op_sel_hi:[1,0,0] neg_lo:[0,0,1] neg_hi:[0,0,1]
  v_pk_fma_f32 v[48:49], v[72:73], v[248:249], v[8:9] op_sel:[0,0,0] op_sel_hi:[1,0,0] neg_lo:[0,0,1] neg_hi:[0,0,1]
  v_pk_fma_f32 v[50:51], v[74:75], v[248:249], v[8:9] op_sel:[0,0,0] op_sel_hi:[1,0,0] neg_lo:[0,0,1] neg_hi:[0,0,1]
  v_pk_fma_f32 v[52:53], v[76:77], v[248:249], v[8:9] op_sel:[0,0,0] op_sel_hi:[1,0,0] neg_lo:[0,0,1] neg_hi:[0,0,1]
  v_pk_fma_f32 v[64:65], v[64:65], v[248:249], v[8:9] op_sel:[0,0,1] op_sel_hi:[1,0,1] neg_lo:[1,0,1] neg_hi:[1,0,1]
  v_pk_fma_f32 v[66:67], v[66:67], v[248:249], v[8:9] op_sel:[0,0,1] op_sel_hi:[1,0,1] neg_lo:[1,0,1] neg_hi:[1,0,1]
  v_pk_fma_f32 v[68:69], v[68:69], v[248:249], v[8:9] op_sel:[0,0,1] op_sel_hi:[1,0,1] neg_lo:[1,0,1] neg_hi:[1,0,1]
  v_pk_fma_f32 v[70:71], v[70:71], v[248:249], v[8:9] op_sel:[0,0,1] op_sel_hi:[1,0,1] neg_lo:[1,0,1] neg_hi:[1,0,1]
  v_pk_fma_f32 v[72:73], v[72:73], v[248:249], v[8:9] op_sel:[0,0,1] op_sel_hi:[1,0,1] neg_lo:[1,0,1] neg_hi:[1,0,1]
  s_add_u32 s70, s36, 0x8000
  buffer_load_dwordx4 a[136:139], v1, s[20:23], s70 offen offset:2048
  v_pk_fma_f32 v[74:75], v[74:75], v[248:249], v[8:9] op_sel:[0,0,1] op_sel_hi:[1,0,1] neg_lo:[1,0,1] neg_hi:[1,0,1]
  v_pk_fma_f32 v[76:77], v[76:77], v[248:249], v[8:9] op_sel:[0,0,1] op_sel_hi:[1,0,1] neg_lo:[1,0,1] neg_hi:[1,0,1]
  v_exp_f32 v40, v40
  v_exp_f32 v41, v41
  v_exp_f32 v42, v42
  v_exp_f32 v43, v43
  v_exp_f32 v44, v44
  v_exp_f32 v45, v45
  v_exp_f32 v46, v46
  v_exp_f32 v47, v47
  v_exp_f32 v48, v48
  v_exp_f32 v49, v49
  v_exp_f32 v50, v50
  buffer_load_dwordx4 a[140:143], v1, s[20:23], s70 offen offset:3072
  v_exp_f32 v51, v51
  v_exp_f32 v52, v52
  v_exp_f32 v53, v53
  v_exp_f32 v64, v64
  v_exp_f32 v65, v65
  v_exp_f32 v66, v66
  v_exp_f32 v67, v67
  v_exp_f32 v68, v68
  v_exp_f32 v69, v69
  v_exp_f32 v70, v70
  v_exp_f32 v71, v71
  v_exp_f32 v72, v72
  s_add_u32 s71, s36, 0x9000
  buffer_load_dwordx4 a[144:147], v1, s[20:23], s71 offen offset:0
  v_exp_f32 v73, v73
  v_exp_f32 v74, v74
  v_exp_f32 v75, v75
  v_exp_f32 v76, v76
  v_exp_f32 v77, v77
  v_pk_add_f32 v[54:55], v[40:41], v[42:43]
  v_pk_add_f32 v[78:79], v[64:65], v[66:67]
  v_pk_add_f32 v[54:55], v[54:55], v[44:45]
  v_pk_add_f32 v[78:79], v[78:79], v[68:69]
  v_pk_add_f32 v[54:55], v[54:55], v[46:47]
  v_pk_add_f32 v[78:79], v[78:79], v[70:71]
  v_pk_add_f32 v[54:55], v[54:55], v[48:49]
  v_pk_add_f32 v[78:79], v[78:79], v[72:73]
  v_pk_add_f32 v[54:55], v[54:55], v[50:51]
  v_pk_add_f32 v[78:79], v[78:79], v[74:75]
  v_pk_add_f32 v[54:55], v[54:55], v[52:53]
  v_pk_add_f32 v[78:79], v[78:79], v[76:77]
  v_add_f32 v8, v54, v55
  s_add_u32 s72, s36, 0x2000
  buffer_load_dwordx4 a[32:35], v1, s[20:23], s72 offen offset:0
  v_add_f32 v9, v78, v79
  s_nop 1
  v_permlane32_swap_b32 v8, v9
  v_add_f32 v8, v8, v9
  v_rcp_f32 v8, v8
  s_nop 0
  v_mul_f32 v8, v8, v246
  v_mov_b32 v9, v8
  s_nop 1
  v_permlane32_swap_b32 v8, v9
  v_pk_mul_f32 v[40:41], v[40:41], v[8:9] op_sel:[0,0] op_sel_hi:[1,0]
  v_pk_mul_f32 v[42:43], v[42:43], v[8:9] op_sel:[0,0] op_sel_hi:[1,0]
  v_pk_mul_f32 v[44:45], v[44:45], v[8:9] op_sel:[0,0] op_sel_hi:[1,0]
  v_pk_mul_f32 v[46:47], v[46:47], v[8:9] op_sel:[0,0] op_sel_hi:[1,0]
  v_pk_mul_f32 v[48:49], v[48:49], v[8:9] op_sel:[0,0] op_sel_hi:[1,0]
  v_pk_mul_f32 v[50:51], v[50:51], v[8:9] op_sel:[0,0] op_sel_hi:[1,0]
  v_pk_mul_f32 v[52:53], v[52:53], v[8:9] op_sel:[0,0] op_sel_hi:[1,0]
  v_pk_mul_f32 v[64:65], v[64:65], v[8:9] op_sel:[0,1] op_sel_hi:[1,1]
  v_pk_mul_f32 v[66:67], v[66:67], v[8:9] op_sel:[0,1] op_sel_hi:[1,1]
  v_pk_mul_f32 v[68:69], v[68:69], v[8:9] op_sel:[0,1] op_sel_hi:[1,1]
  v_pk_mul_f32 v[70:71], v[70:71], v[8:9] op_sel:[0,1] op_sel_hi:[1,1]
  v_pk_mul_f32 v[72:73], v[72:73], v[8:9] op_sel:[0,1] op_sel_hi:[1,1]
  v_pk_mul_f32 v[74:75], v[74:75], v[8:9] op_sel:[0,1] op_sel_hi:[1,1]
  v_pk_mul_f32 v[76:77], v[76:77], v[8:9] op_sel:[0,1] op_sel_hi:[1,1]
  v_cvt_pk_bf16_f32 v112, v40, v41
  buffer_load_dwordx4 a[36:39], v1, s[20:23], s72 offen offset:1024
  v_cvt_pk_bf16_f32 v113, v42, v43
  v_cvt_pk_bf16_f32 v114, v44, v45
  v_cvt_pk_bf16_f32 v115, v46, v47
  v_cvt_pk_bf16_f32 v116, v48, v49
  v_cvt_pk_bf16_f32 v117, v50, v51
  v_cvt_pk_bf16_f32 v118, v52, v53
  v_mov_b32 v119, 0
  v_cvt_pk_bf16_f32 v120, v64, v65
  v_cvt_pk_bf16_f32 v121, v66, v67
  v_cvt_pk_bf16_f32 v122, v68, v69
  v_cvt_pk_bf16_f32 v123, v70, v71
  v_cvt_pk_bf16_f32 v124, v72, v73
  v_cvt_pk_bf16_f32 v125, v74, v75
  v_cvt_pk_bf16_f32 v126, v76, v77
  v_mov_b32 v127, 0
  s_waitcnt lgkmcnt(0)
  v_mfma_f32_32x32x16_bf16 v[64:79], v[112:115], v[104:107], 0
  buffer_load_dwordx4 a[40:43], v1, s[20:23], s72 offen offset:2048
  v_mfma_f32_32x32x16_bf16 v[40:55], v[120:123], v[104:107], 0
  v_mfma_f32_32x32x16_bf16 v[64:79], v[116:119], v[108:111], v[64:79]
  v_mfma_f32_32x32x16_bf16 v[40:55], v[124:127], v[108:111], v[40:55]
  buffer_load_dwordx4 a[44:47], v1, s[20:23], s72 offen offset:3072
  v_cvt_pk_bf16_f32 v56, v80, v81
  v_cvt_pk_bf16_f32 v57, v82, v83
  v_cvt_pk_bf16_f32 v58, v84, v85
  v_cvt_pk_bf16_f32 v59, v86, v87
  v_cvt_pk_bf16_f32 v60, v88, v89
  v_cvt_pk_bf16_f32 v61, v90, v91
  v_cvt_pk_bf16_f32 v62, v92, v93
  v_cvt_pk_bf16_f32 v63, v94, v95
  s_nop 1
  v_cvt_pk_bf16_f32 v96, v64, v65
  v_cvt_pk_bf16_f32 v97, v66, v67
  v_cvt_pk_bf16_f32 v98, v68, v69
  v_cvt_pk_bf16_f32 v99, v70, v71
  v_cvt_pk_bf16_f32 v100, v72, v73
  v_cvt_pk_bf16_f32 v101, v74, v75
  v_cvt_pk_bf16_f32 v102, v76, v77
  v_cvt_pk_bf16_f32 v103, v78, v79
  v_cvt_pk_bf16_f32 v104, v40, v41
  v_cvt_pk_bf16_f32 v105, v42, v43
  v_cvt_pk_bf16_f32 v106, v44, v45
  v_cvt_pk_bf16_f32 v107, v46, v47
  v_cvt_pk_bf16_f32 v108, v48, v49
  v_cvt_pk_bf16_f32 v109, v50, v51
  v_cvt_pk_bf16_f32 v110, v52, v53
  v_cvt_pk_bf16_f32 v111, v54, v55
  v_mfma_f32_32x32x16_bf16 v[64:79], v[96:99], v[56:59], 0
  s_add_u32 s73, s36, 0x9000
  buffer_load_dwordx4 a[148:151], v1, s[20:23], s73 offen offset:1024
  v_mfma_f32_32x32x16_bf16 v[80:95], v[104:107], v[56:59], 0
  v_mfma_f32_32x32x16_bf16 v[64:79], v[100:103], v[60:63], v[64:79]
  v_mfma_f32_32x32x16_bf16 v[80:95], v[108:111], v[60:63], v[80:95]
  buffer_load_dwordx4 a[152:155], v1, s[20:23], s73 offen offset:2048
  s_lshl_b32 s56, s42, 13
  s_add_u32 s56, s56, 0x18400
  v_add_u32 v12, s56, v1
  s_lshl_b32 s56, s42, 11
  s_add_u32 s56, s56, 0x18400
  v_add_u32 v13, s56, v1
  s_nop 3
  ds_write_b128 v12, v[64:67] offset:0
  ds_write_b128 v12, v[68:71] offset:1024
  ds_write_b128 v12, v[72:75] offset:2048
  ds_write_b128 v12, v[76:79] offset:3072
  ds_write_b128 v12, v[80:83] offset:4096
  ds_write_b128 v12, v[84:87] offset:5120
  ds_write_b128 v12, v[88:91] offset:6144
  ds_write_b128 v12, v[92:95] offset:7168
  buffer_load_dwordx4 a[156:159], v1, s[20:23], s73 offen offset:3072
  s_add_u32 s70, s36, 0xa000
  buffer_load_dwordx4 a[160:163], v1, s[20:23], s70 offen offset:0
  s_add_u32 s71, s36, 0x3000
  buffer_load_dwordx4 a[48:51], v1, s[20:23], s71 offen offset:0
  buffer_load_dwordx4 a[52:55], v1, s[20:23], s71 offen offset:1024
  s_waitcnt lgkmcnt(0)
  s_barrier
  ds_read_b128 v[96:99], v13 offset:0
  ds_read_b128 v[100:103], v13 offset:1024
  ds_read_b128 v[104:107], v13 offset:8192
  ds_read_b128 v[108:111], v13 offset:9216
  ds_read_b128 v[112:115], v13 offset:16384
  ds_read_b128 v[116:119], v13 offset:17408
  ds_read_b128 v[120:123], v13 offset:24576
  ds_read_b128 v[124:127], v13 offset:25600
  s_lshl_b32 s56, s41, 16
  s_lshl_b32 s57, s40, 12
  s_add_u32 s56, s56, s57
  s_lshl_b32 s57, s42, 10
  s_add_u32 s56, s56, s57
  s_add_u32 s56, s56, 0x11a0000
  s_waitcnt lgkmcnt(4)
  v_pk_add_f32 v[96:97], v[96:97], v[104:105]
  v_pk_add_f32 v[98:99], v[98:99], v[106:107]
  v_pk_add_f32 v[100:101], v[100:101], v[108:109]
  v_pk_add_f32 v[102:103], v[102:103], v[110:111]
  s_waitcnt lgkmcnt(0)
  v_pk_add_f32 v[112:113], v[112:113], v[120:121]
  v_pk_add_f32 v[114:115], v[114:115], v[122:123]
  v_pk_add_f32 v[116:117], v[116:117], v[124:125]
  v_pk_add_f32 v[118:119], v[118:119], v[126:127]
  v_pk_add_f32 v[96:97], v[96:97], v[112:113]
  v_pk_add_f32 v[98:99], v[98:99], v[114:115]
  v_pk_add_f32 v[100:101], v[100:101], v[116:117]
  v_pk_add_f32 v[102:103], v[102:103], v[118:119]
  v_cvt_pk_bf16_f32 v104, v96, v97
  v_cvt_pk_bf16_f32 v105, v98, v99
  v_cvt_pk_bf16_f32 v106, v100, v101
  v_cvt_pk_bf16_f32 v107, v102, v103
  v_mul_u32_u24 v10, 12, v0
  s_bitcmp1_b32 s42, 0
  s_cbranch_scc1 L_kv3s_89
  buffer_store_dwordx4 v[104:107], v1, s[20:23], s56 offen sc1
L_kv3j_90:
  ds_read_b128 v[112:115], v1 offset:59392
  v_min_u32 v10, 5, v0
  v_lshlrev_b32 v10, 11, v10
  s_lshl_b32 s56, s40, 7
  s_add_u32 s56, s56, 0x4000
  buffer_load_dword v13, v10, s[20:23], s56 offen
  ds_read_b128 v[116:119], v1 offset:60416
  ds_read_b128 v[120:123], v1 offset:61440
  s_waitcnt lgkmcnt(2)
  v_mfma_f32_32x32x16_bf16 v[64:79], v[112:115], v[128:131], 0
  v_and_b32 v10, 15, v0
  v_lshlrev_b32 v10, 7, v10
  s_lshl_b32 s56, s42, 15
  s_add_u32 s56, s56, s39
  s_lshl_b32 s57, s41, 11
  s_add_u32 s56, s56, s57
  s_add_u32 s56, s56, 0x7dc000
  buffer_load_dword v84, v10, s[20:23], s56 offen
  ds_read_b128 v[124:127], v1 offset:62464
  s_waitcnt lgkmcnt(2)
  v_mfma_f32_32x32x16_bf16 v[64:79], v[116:119], v[132:135], v[64:79]
  v_bfe_u32 v11, v0, 3, 1
  v_and_b32 v10, 896, v10
  v_mul_u32_u24 v12, 57344, v11
  v_add_u32 v12, v12, v10
  v_and_b32 v10, 384, v10
  ds_read_b128 v[112:115], v1 offset:63488
  s_waitcnt lgkmcnt(2)
  v_mfma_f32_32x32x16_bf16 v[64:79], v[120:123], v[136:139], v[64:79]
  v_mul_u32_u24 v11, 14336, v11
  v_add_u32 v11, v11, v10
  s_add_u32 s56, s32, 0x818000
  s_add_u32 s57, s33, 0x10c0000
  s_cmp_ge_u32 s41, 14
  s_cselect_b32 s56, 0x7f000000, s56
  s_cselect_b32 s57, 0x7f000000, s57
  buffer_load_dword v85, v12, s[20:23], s56 offen
  ds_read_b128 v[116:119], v1 offset:64512
  s_waitcnt lgkmcnt(2)
  v_mfma_f32_32x32x16_bf16 v[64:79], v[124:127], v[140:143], v[64:79]
  buffer_load_dword v86, v11, s[20:23], s57 offen
  ds_read_b128 v[120:123], v2 offset:0
  s_waitcnt lgkmcnt(2)
  v_mfma_f32_32x32x16_bf16 v[64:79], v[112:115], v[144:147], v[64:79]
  ds_read_b128 v[124:127], v2 offset:1024
  s_waitcnt lgkmcnt(2)
  v_mfma_f32_32x32x16_bf16 v[64:79], v[116:119], v[148:151], v[64:79]
  ds_read_b128 v[112:115], v2 offset:2048
  s_waitcnt lgkmcnt(2)
  v_mfma_f32_32x32x16_bf16 v[64:79], v[120:123], v[152:155], v[64:79]
  s_add_u32 s72, s37, 0x3000
  buffer_load_dwordx4 a[56:59], v1, s[20:23], s72 offen offset:2048
  ds_read_b128 v[116:119], v2 offset:3072
  s_waitcnt lgkmcnt(2)
  v_mfma_f32_32x32x16_bf16 v[64:79], v[124:127], v[156:159], v[64:79]
  ds_read_b128 v[120:123], v2 offset:4096
  s_waitcnt lgkmcnt(2)
  v_mfma_f32_32x32x16_bf16 v[64:79], v[112:115], v[160:163], v[64:79]
  ds_read_b128 v[124:127], v2 offset:5120
  s_waitcnt lgkmcnt(2)
  v_mfma_f32_32x32x16_bf16 v[64:79], v[116:119], v[164:167], v[64:79]
  buffer_load_dwordx4 a[60:63], v1, s[20:23], s72 offen offset:3072
  ds_read_b128 v[112:115], v2 offset:6144
  s_waitcnt lgkmcnt(2)
  v_mfma_f32_32x32x16_bf16 v[64:79], v[120:123], v[168:171], v[64:79]
  ds_read_b128 v[116:119], v2 offset:7168
  s_waitcnt lgkmcnt(2)
  v_mfma_f32_32x32x16_bf16 v[64:79], v[124:127], v[172:175], v[64:79]
  ds_read_b128 v[120:123], v2 offset:8192
  s_waitcnt lgkmcnt(2)
  v_mfma_f32_32x32x16_bf16 v[64:79], v[112:115], v[176:179], v[64:79]
  s_add_u32 s73, s36, 0xa000
  buffer_load_dwordx4 a[164:167], v1, s[20:23], s73 offen offset:1024
  ds_read_b128 v[124:127], v2 offset:9216
  s_waitcnt lgkmcnt(2)
  v_mfma_f32_32x32x16_bf16 v[64:79], v[116:119], v[180:183], v[64:79]
  ds_read_b128 v[112:115], v2 offset:10240
  s_waitcnt lgkmcnt(2)
  v_mfma_f32_32x32x16_bf16 v[64:79], v[120:123], v[184:187], v[64:79]
  ds_read_b128 v[116:119], v2 offset:11264
  s_waitcnt lgkmcnt(2)
  v_mfma_f32_32x32x16_bf16 v[64:79], v[124:127], v[188:191], v[64:79]
  buffer_load_dwordx4 a[168:171], v1, s[20:23], s73 offen offset:2048
  ds_read_b128 v[120:123], v2 offset:12288
  s_waitcnt lgkmcnt(2)
  v_mfma_f32_32x32x16_bf16 v[64:79], v[112:115], v[192:195], v[64:79]
  ds_read_b128 v[124:127], v2 offset:13312
  s_waitcnt lgkmcnt(2)
  v_mfma_f32_32x32x16_bf16 v[64:79], v[116:119], v[196:199], v[64:79]
  ds_read_b128 v[112:115], v2 offset:14336
  s_waitcnt lgkmcnt(2)
  v_mfma_f32_32x32x16_bf16 v[64:79], v[120:123], v[200:203], v[64:79]
  s_add_u32 s70, s37, 0xa000
  buffer_load_dwordx4 a[172:175], v1, s[20:23], s70 offen offset:3072
  ds_read_b128 v[116:119], v2 offset:15360
  s_waitcnt lgkmcnt(2)
  v_mfma_f32_32x32x16_bf16 v[64:79], v[124:127], v[204:207], v[64:79]
  ds_read_b128 v[120:123], v2 offset:16384
  s_waitcnt lgkmcnt(2)
  v_mfma_f32_32x32x16_bf16 v[64:79], v[112:115], v[208:211], v[64:79]
  ds_read_b128 v[124:127], v2 offset:17408
  s_waitcnt lgkmcnt(2)
  v_mfma_f32_32x32x16_bf16 v[64:79], v[116:119], v[212:215], v[64:79]
  s_add_u32 s71, s37, 0xb000
  buffer_load_dwordx4 a[176:179], v1, s[20:23], s71 offen offset:0
  ds_read_b128 v[112:115], v2 offset:18432
  s_waitcnt lgkmcnt(2)
  v_mfma_f32_32x32x16_bf16 v[64:79], v[120:123], v[216:219], v[64:79]
  ds_read_b128 v[116:119], v2 offset:19456
  s_waitcnt vmcnt(10)
  s_barrier
  s_cmp_lg_u32 s42, 0
  s_cbranch_scc1 L_pubskip_91
  s_lshl_b32 s56, s41, 10
  s_lshl_b32 s57, s40, 6
  s_add_u32 s56, s56, s57
  s_add_u32 s56, s56, 0xb000
  v_mov_b32 v8, s43
  s_mov_b64 exec, 1
  buffer_store_dword v8, v7, s[20:23], s56 offen sc1
  s_mov_b64 exec, -1
  s_nop 0
L_pubskip_91:
  s_waitcnt lgkmcnt(2)
  v_mfma_f32_32x32x16_bf16 v[64:79], v[124:127], v[220:223], v[64:79]
  ds_read_b128 v[120:123], v2 offset:20480
  s_waitcnt lgkmcnt(2)
  v_mfma_f32_32x32x16_bf16 v[64:79], v[112:115], v[224:227], v[64:79]
  ds_read_b128 v[124:127], v2 offset:21504
  s_waitcnt lgkmcnt(2)
  v_mfma_f32_32x32x16_bf16 v[64:79], v[116:119], v[228:231], v[64:79]
  ds_read_b128 v[112:115], v2 offset:22528
  s_waitcnt lgkmcnt(2)
  v_mfma_f32_32x32x16_bf16 v[64:79], v[120:123], v[232:235], v[64:79]
  s_waitcnt lgkmcnt(1)
  v_mfma_f32_32x32x16_bf16 v[64:79], v[124:127], v[236:239], v[64:79]
  s_waitcnt lgkmcnt(0)
  v_mfma_f32_32x32x16_bf16 v[64:79], v[112:115], v[240:243], v[64:79]
  s_nop 11
  v_max3_f32 v8, v64, v65, v66
  v_max3_f32 v9, -v64, -v65, -v66
  v_max3_f32 v8, v8, v67, v68
  v_max3_f32 v9, v9, -v67, -v68
  v_max3_f32 v8, v8, v69, v70
  v_max3_f32 v9, v9, -v69, -v70
  v_max3_f32 v8, v8, v71, v72
  v_max3_f32 v9, v9, -v71, -v72
  buffer_load_dwordx4 v[192:195], v14, s[20:23], s66 offen offset:0
  v_max3_f32 v8, v8, v73, v74
  v_max3_f32 v9, v9, -v73, -v74
  v_max3_f32 v8, v8, v75, v76
  v_max3_f32 v9, v9, -v75, -v76
  v_max_f32 v8, v8, v77
  v_max_f32 v9, v9, -v77
  s_nop 1
  v_permlane32_swap_b32 v8, v9
  v_max_f32 v8, v8, v9
  v_mul_f32 v8, v8, v248
  v_mov_b32 v9, v8
  s_nop 1
  v_permlane32_swap_b32 v8, v9
  v_pk_fma_f32 v[40:41], v[64:65], v[248:249], v[8:9] op_sel:[0,0,0] op_sel_hi:[1,0,0] neg_lo:[0,0,1] neg_hi:[0,0,1]
  v_pk_fma_f32 v[42:43], v[66:67], v[248:249], v[8:9] op_sel:[0,0,0] op_sel_hi:[1,0,0] neg_lo:[0,0,1] neg_hi:[0,0,1]
  v_pk_fma_f32 v[44:45], v[68:69], v[248:249], v[8:9] op_sel:[0,0,0] op_sel_hi:[1,0,0] neg_lo:[0,0,1] neg_hi:[0,0,1]
  v_pk_fma_f32 v[46:47], v[70:71], v[248:249], v[8:9] op_sel:[0,0,0] op_sel_hi:[1,0,0] neg_lo:[0,0,1] neg_hi:[0,0,1]
  v_pk_fma_f32 v[48:49], v[72:73], v[248:249], v[8:9] op_sel:[0,0,0] op_sel_hi:[1,0,0] neg_lo:[0,0,1] neg_hi:[0,0,1]
  buffer_load_dwordx4 v[196:199], v14, s[20:23], s66 offen offset:1024
  v_pk_fma_f32 v[50:51], v[74:75], v[248:249], v[8:9] op_sel:[0,0,0] op_sel_hi:[1,0,0] neg_lo:[0,0,1] neg_hi:[0,0,1]
  v_pk_fma_f32 v[52:53], v[76:77], v[248:249], v[8:9] op_sel:[0,0,0] op_sel_hi:[1,0,0] neg_lo:[0,0,1] neg_hi:[0,0,1]
  v_pk_fma_f32 v[64:65], v[64:65], v[248:249], v[8:9] op_sel:[0,0,1] op_sel_hi:[1,0,1] neg_lo:[1,0,1] neg_hi:[1,0,1]
  v_pk_fma_f32 v[66:67], v[66:67], v[248:249], v[8:9] op_sel:[0,0,1] op_sel_hi:[1,0,1] neg_lo:[1,0,1] neg_hi:[1,0,1]
  v_pk_fma_f32 v[68:69], v[68:69], v[248:249], v[8:9] op_sel:[0,0,1] op_sel_hi:[1,0,1] neg_lo:[1,0,1] neg_hi:[1,0,1]
  v_pk_fma_f32 v[70:71], v[70:71], v[248:249], v[8:9] op_sel:[0,0,1] op_sel_hi:[1,0,1] neg_lo:[1,0,1] neg_hi:[1,0,1]
  v_pk_fma_f32 v[72:73], v[72:73], v[248:249], v[8:9] op_sel:[0,0,1] op_sel_hi:[1,0,1] neg_lo:[1,0,1] neg_hi:[1,0,1]
  v_pk_fma_f32 v[74:75], v[74:75], v[248:249], v[8:9] op_sel:[0,0,1] op_sel_hi:[1,0,1] neg_lo:[1,0,1] neg_hi:[1,0,1]
  v_pk_fma_f32 v[76:77], v[76:77], v[248:249], v[8:9] op_sel:[0,0,1] op_sel_hi:[1,0,1] neg_lo:[1,0,1] neg_hi:[1,0,1]
  v_exp_f32 v40, v40
  v_exp_f32 v41, v41
  v_exp_f32 v42, v42
  v_exp_f32 v43, v43
  buffer_load_dwordx4 v[200:203], v14, s[20:23], s66 offen offset:2048
  v_exp_f32 v44, v44
  v_exp_f32 v45, v45
  v_exp_f32 v46, v46
  v_exp_f32 v47, v47
  v_exp_f32 v48, v48
  v_exp_f32 v49, v49
  v_exp_f32 v50, v50
  v_exp_f32 v51, v51
  buffer_load_dwordx4 v[204:207], v14, s[20:23], s66 offen offset:3072
  v_exp_f32 v52, v52
  v_exp_f32 v53, v53
  v_exp_f32 v64, v64
  v_exp_f32 v65, v65
  v_exp_f32 v66, v66
  v_exp_f32 v67, v67
  v_exp_f32 v68, v68
  v_exp_f32 v69, v69
  buffer_load_dwordx4 v[224:227], v14, s[20:23], s82 offen offset:0
  v_exp_f32 v70, v70
  v_exp_f32 v71, v71
  v_exp_f32 v72, v72
  v_exp_f32 v73, v73
  v_exp_f32 v74, v74
  v_exp_f32 v75, v75
  v_exp_f32 v76, v76
  v_exp_f32 v77, v77
  buffer_load_dwordx4 v[228:231], v14, s[20:23], s82 offen offset:1024
  v_pk_add_f32 v[54:55], v[40:41], v[42:43]
  v_pk_add_f32 v[78:79], v[64:65], v[66:67]
  v_pk_add_f32 v[54:55], v[54:55], v[44:45]
  v_pk_add_f32 v[78:79], v[78:79], v[68:69]
  v_pk_add_f32 v[54:55], v[54:55], v[46:47]
  v_pk_add_f32 v[78:79], v[78:79], v[70:71]
  v_pk_add_f32 v[54:55], v[54:55], v[48:49]
  v_pk_add_f32 v[78:79], v[78:79], v[72:73]
  v_pk_add_f32 v[54:55], v[54:55], v[50:51]
  v_pk_add_f32 v[78:79], v[78:79], v[74:75]
  v_pk_add_f32 v[54:55], v[54:55], v[52:53]
  v_pk_add_f32 v[78:79], v[78:79], v[76:77]
  v_add_f32 v8, v54, v55
  v_add_f32 v9, v78, v79
  s_nop 1
  v_permlane32_swap_b32 v8, v9
  v_add_f32 v8, v8, v9
  buffer_load_dwordx4 v[232:235], v14, s[20:23], s82 offen offset:2048
  v_rcp_f32 v8, v8
  s_nop 0
  v_mov_b32 v9, v8
  s_nop 1
  v_permlane32_swap_b32 v8, v9
  v_pk_mul_f32 v[40:41], v[40:41], v[8:9] op_sel:[0,0] op_sel_hi:[1,0]
  v_pk_mul_f32 v[42:43], v[42:43], v[8:9] op_sel:[0,0] op_sel_hi:[1,0]
  v_pk_mul_f32 v[44:45], v[44:45], v[8:9] op_sel:[0,0] op_sel_hi:[1,0]
  v_pk_mul_f32 v[46:47], v[46:47], v[8:9] op_sel:[0,0] op_sel_hi:[1,0]
  v_pk_mul_f32 v[48:49], v[48:49], v[8:9] op_sel:[0,0] op_sel_hi:[1,0]
  v_pk_mul_f32 v[50:51], v[50:51], v[8:9] op_sel:[0,0] op_sel_hi:[1,0]
  v_pk_mul_f32 v[52:53], v[52:53], v[8:9] op_sel:[0,0] op_sel_hi:[1,0]
  v_pk_mul_f32 v[64:65], v[64:65], v[8:9] op_sel:[0,1] op_sel_hi:[1,1]
  v_pk_mul_f32 v[66:67], v[66:67], v[8:9] op_sel:[0,1] op_sel_hi:[1,1]
  v_pk_mul_f32 v[68:69], v[68:69], v[8:9] op_sel:[0,1] op_sel_hi:[1,1]
  v_pk_mul_f32 v[70:71], v[70:71], v[8:9] op_sel:[0,1] op_sel_hi:[1,1]
  v_pk_mul_f32 v[72:73], v[72:73], v[8:9] op_sel:[0,1] op_sel_hi:[1,1]
  buffer_load_dwordx4 v[236:239], v14, s[20:23], s82 offen offset:3072
  v_pk_mul_f32 v[74:75], v[74:75], v[8:9] op_sel:[0,1] op_sel_hi:[1,1]
  v_pk_mul_f32 v[76:77], v[76:77], v[8:9] op_sel:[0,1] op_sel_hi:[1,1]
  v_cvt_pk_bf16_f32 v24, v40, v41
  v_cvt_pk_bf16_f32 v25, v42, v43
  v_cvt_pk_bf16_f32 v26, v44, v45
  v_cvt_pk_bf16_f32 v27, v46, v47
  v_cvt_pk_bf16_f32 v28, v48, v49
  v_cvt_pk_bf16_f32 v29, v50, v51
  v_cvt_pk_bf16_f32 v30, v52, v53
  v_mov_b32 v31, 0
  v_cvt_pk_bf16_f32 v32, v64, v65
  v_cvt_pk_bf16_f32 v33, v66, v67
  v_cvt_pk_bf16_f32 v34, v68, v69
  v_cvt_pk_bf16_f32 v35, v70, v71
  v_cvt_pk_bf16_f32 v36, v72, v73
  v_cvt_pk_bf16_f32 v37, v74, v75
  s_add_u32 s72, s66, 0x1000
  buffer_load_dwordx4 v[208:211], v14, s[20:23], s72 offen offset:0
  v_cvt_pk_bf16_f32 v38, v76, v77
  v_mov_b32 v39, 0
  buffer_load_dwordx4 v[212:215], v14, s[20:23], s72 offen offset:1024
  s_add_u32 s73, s66, 0x1000
  buffer_load_dwordx4 v[216:219], v14, s[20:23], s73 offen offset:2048
  buffer_load_dwordx4 v[220:223], v14, s[20:23], s73 offen offset:3072
  s_add_u32 s70, s82, 0x1000
  buffer_load_dwordx4 v[240:243], v14, s[20:23], s70 offen offset:0
  buffer_load_dwordx4 v[244:247], v14, s[20:23], s70 offen offset:1024
  buffer_load_dwordx4 v[248:251], v14, s[20:23], s70 offen offset:2048
  buffer_load_dwordx4 v[252:255], v14, s[20:23], s70 offen offset:3072
  s_add_u32 s71, s37, 0x4000
  buffer_load_dwordx4 a[64:67], v1, s[20:23], s71 offen offset:0
  buffer_load_dwordx4 a[68:71], v1, s[20:23], s71 offen offset:1024
  s_add_u32 s72, s37, 0xb000
  buffer_load_dwordx4 a[180:183], v1, s[20:23], s72 offen offset:1024
  buffer_load_dwordx4 a[184:187], v1, s[20:23], s72 offen offset:2048
  buffer_load_dwordx4 a[188:191], v1, s[20:23], s72 offen offset:3072
  s_add_u32 s73, s37, 0xc000
  buffer_load_dwordx4 a[192:195], v1, s[20:23], s73 offen offset:0
  s_cmp_lg_u32 s42, 0
  s_cbranch_scc1 L_pollskip_92
  s_lshl_b32 s56, s41, 10
  s_add_u32 s56, s56, 0xb000
  s_mov_b32 s63, 0
  v_lshlrev_b32 v9, 6, v0
  s_mov_b64 exec, 0xffff
L_poll_93:
  buffer_load_dword v8, v9, s[20:23], s56 offen sc1
  s_waitcnt vmcnt(0)
  v_cmp_ne_u32 vcc, s43, v8
  s_add_u32 s63, s63, 1
  s_nop 1
  s_cbranch_vccz L_polldone_94
  s_cmp_lt_u32 s63, 262144
  s_cbranch_scc1 L_poll_93
L_polldone_94:
  s_mov_b64 exec, -1
L_pollskip_92:
  s_barrier
  s_lshl_b32 s69, s41, 16
  s_lshl_b32 s56, s42, 10
  s_add_u32 s69, s69, s56
  s_add_u32 s69, s69, 0x11a0000
  s_and_b32 s56, s40, 0
  s_lshl_b32 s56, s56, 15
  s_sub_u32 s93, s69, s56
  s_add_u32 s69, s69, s56
  v_mul_u32_u24 v12, 12, v0
  s_bitcmp1_b32 s42, 0
  s_cselect_b32 s57, 0, -1
  s_cbranch_scc1 L_kv3l_95
  buffer_load_dwordx4 v[128:131], v1, s[20:23], s69 offen offset:0 sc1
  s_add_u32 s52, s69, 0x1000
  buffer_load_dwordx4 v[132:135], v1, s[20:23], s52 offen offset:0 sc1
  s_add_u32 s53, s69, 0x2000
  buffer_load_dwordx4 v[136:139], v1, s[20:23], s53 offen offset:0 sc1
  s_add_u32 s54, s69, 0x3000
  buffer_load_dwordx4 v[140:143], v1, s[20:23], s54 offen offset:0 sc1
  s_add_u32 s55, s69, 0x4000
  buffer_load_dwordx4 v[144:147], v1, s[20:23], s55 offen offset:0 sc1
  s_add_u32 s48, s69, 0x5000
  buffer_load_dwordx4 v[148:151], v1, s[20:23], s48 offen offset:0 sc1
  s_add_u32 s49, s69, 0x6000
  buffer_load_dwordx4 v[152:155], v1, s[20:23], s49 offen offset:0 sc1
  s_add_u32 s50, s69, 0x7000
  buffer_load_dwordx4 v[156:159], v1, s[20:23], s50 offen offset:0 sc1
  s_add_u32 s51, s93, 0x8000
  buffer_load_dwordx4 v[160:163], v1, s[20:23], s51 offen offset:0 sc1
  s_add_u32 s52, s93, 0x9000
  buffer_load_dwordx4 v[164:167], v1, s[20:23], s52 offen offset:0 sc1
  s_add_u32 s53, s93, 0xa000
  buffer_load_dwordx4 v[168:171], v1, s[20:23], s53 offen offset:0 sc1
  s_add_u32 s54, s93, 0xb000
  buffer_load_dwordx4 v[172:175], v1, s[20:23], s54 offen offset:0 sc1
  s_add_u32 s55, s93, 0xc000
  buffer_load_dwordx4 v[176:179], v1, s[20:23], s55 offen offset:0 sc1
  s_add_u32 s48, s93, 0xd000
  buffer_load_dwordx4 v[180:183], v1, s[20:23], s48 offen offset:0 sc1
  s_add_u32 s49, s93, 0xe000
  buffer_load_dwordx4 v[184:187], v1, s[20:23], s49 offen offset:0 sc1
  s_add_u32 s50, s93, 0xf000
  buffer_load_dwordx4 v[188:191], v1, s[20:23], s50 offen offset:0 sc1
L_kv3k_96:
  s_waitcnt vmcnt(15)
  v_dot2_f32_bf16 v40, v128, s60, 0
  v_dot2_f32_bf16 v41, v128, s61, 0
  v_dot2_f32_bf16 v42, v129, s60, 0
  v_dot2_f32_bf16 v43, v129, s61, 0
  v_dot2_f32_bf16 v44, v130, s60, 0
  v_dot2_f32_bf16 v45, v130, s61, 0
  v_dot2_f32_bf16 v46, v131, s60, 0
  v_dot2_f32_bf16 v47, v131, s61, 0
  s_waitcnt vmcnt(14)
  v_dot2_f32_bf16 v40, v132, s60, v40
  v_dot2_f32_bf16 v41, v132, s61, v41
  v_dot2_f32_bf16 v42, v133, s60, v42
  v_dot2_f32_bf16 v43, v133, s61, v43
  v_dot2_f32_bf16 v44, v134, s60, v44
  v_dot2_f32_bf16 v45, v134, s61, v45
  v_dot2_f32_bf16 v46, v135, s60, v46
  v_dot2_f32_bf16 v47, v135, s61, v47
  s_waitcnt vmcnt(13)
  v_dot2_f32_bf16 v40, v136, s60, v40
  v_dot2_f32_bf16 v41, v136, s61, v41
  v_dot2_f32_bf16 v42, v137, s60, v42
  v_dot2_f32_bf16 v43, v137, s61, v43
  v_dot2_f32_bf16 v44, v138, s60, v44
  v_dot2_f32_bf16 v45, v138, s61, v45
  v_dot2_f32_bf16 v46, v139, s60, v46
  v_dot2_f32_bf16 v47, v139, s61, v47
  s_waitcnt vmcnt(12)
  v_dot2_f32_bf16 v40, v140, s60, v40
  v_dot2_f32_bf16 v41, v140, s61, v41
  v_dot2_f32_bf16 v42, v141, s60, v42
  v_dot2_f32_bf16 v43, v141, s61, v43
  v_dot2_f32_bf16 v44, v142, s60, v44
  v_dot2_f32_bf16 v45, v142, s61, v45
  v_dot2_f32_bf16 v46, v143, s60, v46
  v_dot2_f32_bf16 v47, v143, s61, v47
  s_waitcnt vmcnt(11)
  v_dot2_f32_bf16 v40, v144, s60, v40
  v_dot2_f32_bf16 v41, v144, s61, v41
  v_dot2_f32_bf16 v42, v145, s60, v42
  v_dot2_f32_bf16 v43, v145, s61, v43
  v_dot2_f32_bf16 v44, v146, s60, v44
  v_dot2_f32_bf16 v45, v146, s61, v45
  v_dot2_f32_bf16 v46, v147, s60, v46
  v_dot2_f32_bf16 v47, v147, s61, v47
  s_waitcnt vmcnt(10)
  v_dot2_f32_bf16 v40, v148, s60, v40
  v_dot2_f32_bf16 v41, v148, s61, v41
  v_dot2_f32_bf16 v42, v149, s60, v42
  v_dot2_f32_bf16 v43, v149, s61, v43
  v_dot2_f32_bf16 v44, v150, s60, v44
  v_dot2_f32_bf16 v45, v150, s61, v45
  v_dot2_f32_bf16 v46, v151, s60, v46
  v_dot2_f32_bf16 v47, v151, s61, v47
  s_waitcnt vmcnt(9)
  v_dot2_f32_bf16 v40, v152, s60, v40
  v_dot2_f32_bf16 v41, v152, s61, v41
  v_dot2_f32_bf16 v42, v153, s60, v42
  v_dot2_f32_bf16 v43, v153, s61, v43
  v_dot2_f32_bf16 v44, v154, s60, v44
  v_dot2_f32_bf16 v45, v154, s61, v45
  v_dot2_f32_bf16 v46, v155, s60, v46
  v_dot2_f32_bf16 v47, v155, s61, v47
  s_waitcnt vmcnt(8)
  v_dot2_f32_bf16 v40, v156, s60, v40
  v_dot2_f32_bf16 v41, v156, s61, v41
  v_dot2_f32_bf16 v42, v157, s60, v42
  v_dot2_f32_bf16 v43, v157, s61, v43
  v_dot2_f32_bf16 v44, v158, s60, v44
  v_dot2_f32_bf16 v45, v158, s61, v45
  v_dot2_f32_bf16 v46, v159, s60, v46
  v_dot2_f32_bf16 v47, v159, s61, v47
  s_waitcnt vmcnt(7)
  v_dot2_f32_bf16 v40, v160, s60, v40
  v_dot2_f32_bf16 v41, v160, s61, v41
  v_dot2_f32_bf16 v42, v161, s60, v42
  v_dot2_f32_bf16 v43, v161, s61, v43
  v_dot2_f32_bf16 v44, v162, s60, v44
  v_dot2_f32_bf16 v45, v162, s61, v45
  v_dot2_f32_bf16 v46, v163, s60, v46
  v_dot2_f32_bf16 v47, v163, s61, v47
  s_waitcnt vmcnt(6)
  v_dot2_f32_bf16 v40, v164, s60, v40
  v_dot2_f32_bf16 v41, v164, s61, v41
  v_dot2_f32_bf16 v42, v165, s60, v42
  v_dot2_f32_bf16 v43, v165, s61, v43
  v_dot2_f32_bf16 v44, v166, s60, v44
  v_dot2_f32_bf16 v45, v166, s61, v45
  v_dot2_f32_bf16 v46, v167, s60, v46
  v_dot2_f32_bf16 v47, v167, s61, v47
  s_waitcnt vmcnt(5)
  v_dot2_f32_bf16 v40, v168, s60, v40
  v_dot2_f32_bf16 v41, v168, s61, v41
  v_dot2_f32_bf16 v42, v169, s60, v42
  v_dot2_f32_bf16 v43, v169, s61, v43
  v_dot2_f32_bf16 v44, v170, s60, v44
  v_dot2_f32_bf16 v45, v170, s61, v45
  v_dot2_f32_bf16 v46, v171, s60, v46
  v_dot2_f32_bf16 v47, v171, s61, v47
  s_waitcnt vmcnt(4)
  v_dot2_f32_bf16 v40, v172, s60, v40
  v_dot2_f32_bf16 v41, v172, s61, v41
  v_dot2_f32_bf16 v42, v173, s60, v42
  v_dot2_f32_bf16 v43, v173, s61, v43
  v_dot2_f32_bf16 v44, v174, s60, v44
  v_dot2_f32_bf16 v45, v174, s61, v45
  v_dot2_f32_bf16 v46, v175, s60, v46
  v_dot2_f32_bf16 v47, v175, s61, v47
  s_waitcnt vmcnt(3)
  v_dot2_f32_bf16 v40, v176, s60, v40
  v_dot2_f32_bf16 v41, v176, s61, v41
  v_dot2_f32_bf16 v42, v177, s60, v42
  v_dot2_f32_bf16 v43, v177, s61, v43
  v_dot2_f32_bf16 v44, v178, s60, v44
  v_dot2_f32_bf16 v45, v178, s61, v45
  v_dot2_f32_bf16 v46, v179, s60, v46
  v_dot2_f32_bf16 v47, v179, s61, v47
  s_waitcnt vmcnt(2)
  v_dot2_f32_bf16 v40, v180, s60, v40
  v_dot2_f32_bf16 v41, v180, s61, v41
  v_dot2_f32_bf16 v42, v181, s60, v42
  v_dot2_f32_bf16 v43, v181, s61, v43
  v_dot2_f32_bf16 v44, v182, s60, v44
  v_dot2_f32_bf16 v45, v182, s61, v45
  v_dot2_f32_bf16 v46, v183, s60, v46
  v_dot2_f32_bf16 v47, v183, s61, v47
  s_waitcnt vmcnt(1)
  v_dot2_f32_bf16 v40, v184, s60, v40
  v_dot2_f32_bf16 v41, v184, s61, v41
  v_dot2_f32_bf16 v42, v185, s60, v42
  v_dot2_f32_bf16 v43, v185, s61, v43
  v_dot2_f32_bf16 v44, v186, s60, v44
  v_dot2_f32_bf16 v45, v186, s61, v45
  v_dot2_f32_bf16 v46, v187, s60, v46
  v_dot2_f32_bf16 v47, v187, s61, v47
  s_waitcnt vmcnt(0)
  v_dot2_f32_bf16 v40, v188, s60, v40
  v_dot2_f32_bf16 v41, v188, s61, v41
  v_dot2_f32_bf16 v42, v189, s60, v42
  v_dot2_f32_bf16 v43, v189, s61, v43
  v_dot2_f32_bf16 v44, v190, s60, v44
  v_dot2_f32_bf16 v45, v190, s61, v45
  v_dot2_f32_bf16 v46, v191, s60, v46
  v_dot2_f32_bf16 v47, v191, s61, v47
  v_cvt_pk_bf16_f32 v48, v40, v41
  v_cvt_pk_bf16_f32 v49, v42, v43
  v_cvt_pk_bf16_f32 v50, v44, v45
  v_cvt_pk_bf16_f32 v51, v46, v47
  v_and_b32 v51, s57, v51
  s_lshl_b32 s56, s42, 10
  s_add_u32 s56, s56, 0x20400
  v_add_u32 v8, s56, v1
  ds_write_b128 v8, v[48:51]
  s_waitcnt lgkmcnt(0)
  s_barrier
  ds_read_b128 v[96:99], v3 offset:1024
  ds_read_b128 v[100:103], v3 offset:2048
  ds_read_b128 v[104:107], v3 offset:3072
  ds_read_b128 v[108:111], v3 offset:4096
  s_lshl_b32 s56, s42, 15
  s_add_u32 s56, s56, s39
  s_lshl_b32 s57, s41, 11
  s_add_u32 s56, s56, s57
  s_add_u32 s56, s56, 0x7dc000
  s_waitcnt lgkmcnt(3)
  v_mfma_f32_32x32x16_bf16 v[64:79], v[96:99], v[24:27], 0
  s_waitcnt lgkmcnt(2)
  v_mfma_f32_32x32x16_bf16 v[64:79], v[100:103], v[28:31], v[64:79]
  s_waitcnt lgkmcnt(1)
  v_mfma_f32_32x32x16_bf16 v[64:79], v[104:107], v[32:35], v[64:79]
  s_waitcnt lgkmcnt(0)
  v_mfma_f32_32x32x16_bf16 v[64:79], v[108:111], v[36:39], v[64:79]
  s_nop 11
  v_add_f32 v8, 0x358637bd, v78
  v_rcp_f32 v8, v8
  v_mov_b32 v47, 0
  v_pk_mul_f32 v[64:65], v[64:65], v[8:9] op_sel:[0,0] op_sel_hi:[1,0]
  v_pk_mul_f32 v[66:67], v[66:67], v[8:9] op_sel:[0,0] op_sel_hi:[1,0]
  v_pk_mul_f32 v[68:69], v[68:69], v[8:9] op_sel:[0,0] op_sel_hi:[1,0]
  v_pk_mul_f32 v[70:71], v[70:71], v[8:9] op_sel:[0,0] op_sel_hi:[1,0]
  v_pk_mul_f32 v[72:73], v[72:73], v[8:9] op_sel:[0,0] op_sel_hi:[1,0]
  v_pk_mul_f32 v[74:75], v[74:75], v[8:9] op_sel:[0,0] op_sel_hi:[1,0]
  v_pk_mul_f32 v[76:77], v[76:77], v[8:9] op_sel:[0,0] op_sel_hi:[1,0]
  v_cvt_pk_bf16_f32 v40, v64, v65
  v_cvt_pk_bf16_f32 v41, v66, v67
  v_cvt_pk_bf16_f32 v42, v68, v69
  v_cvt_pk_bf16_f32 v43, v70, v71
  v_cvt_pk_bf16_f32 v44, v72, v73
  v_cvt_pk_bf16_f32 v45, v74, v75
  v_cvt_pk_bf16_f32 v46, v76, v77
  s_cmp_eq_u32 s44, 0
  s_cbranch_scc1 L_slow_97
  buffer_store_dwordx4 v[40:43], v1, s[20:23], s56 offen offset:0
  buffer_store_dwordx4 v[44:47], v1, s[20:23], s56 offen offset:1024
L_join_98:
  s_add_u32 s70, s37, 0xc000
  buffer_load_dwordx4 a[196:199], v1, s[20:23], s70 offen offset:1024
  s_waitcnt vmcnt(1) lgkmcnt(0)
  s_barrier
  s_cmp_lg_u32 s42, 0
  s_cbranch_scc1 L_pubskip_99
  s_lshl_b32 s56, s40, 7
  s_lshl_b32 s57, s41, 2
  s_add_u32 s56, s56, s57
  s_add_u32 s56, s56, 0x4000
  v_mov_b32 v8, s43
  s_mov_b64 exec, 1
  s_cmp_eq_u32 s44, 0
  s_cbranch_scc1 L_slow_100
  buffer_store_dword v8, v7, s[20:23], s56 offen
L_join_101:
  s_mov_b64 exec, -1
  s_nop 0
L_pubskip_99:
  s_cmp_ge_u32 s41, 14
  s_cbranch_scc1 L_help1
L_wo1:
  s_or_b32 s56, s2, s42
  s_cmp_lg_u32 s56, 0
  s_cbranch_scc1 L_noep_102
  v_mov_b32 v10, s43
  s_mov_b64 exec, 1
  buffer_store_dword v10, v7, s[20:23], 0 offen offset:0 sc1
  s_mov_b64 exec, -1
  s_nop 0
L_noep_102:
  s_lshl_b32 s69, s46, 15
  s_add_u32 s69, s69, s39
  s_lshl_b32 s56, s42, 13
  s_add_u32 s69, s69, s56
  s_add_u32 s69, s69, 0x7dc000
  s_xor_b32 s56, s42, 1
  s_mul_i32 s56, s56, 6144
  s_add_u32 s56, s56, 0x18400
  v_add_u32 v10, s56, v1
  s_xor_b32 s56, s42, 2
  s_mul_i32 s56, s56, 6144
  s_add_u32 s56, s56, 0x18c00
  v_add_u32 v11, s56, v1
  s_xor_b32 s56, s42, 3
  s_mul_i32 s56, s56, 6144
  s_add_u32 s56, s56, 0x19400
  v_add_u32 v12, s56, v1
  s_mul_i32 s56, s42, 6144
  s_add_u32 s56, s56, 0x18400
  v_add_u32 v13, s56, v1
  s_nop 2
  s_cmp_lg_u32 s42, 0
  s_cbranch_scc1 L_pollskip_103
  s_lshl_b32 s56, s40, 7
  s_add_u32 s56, s56, 0x4000
  s_mov_b32 s63, 0
  s_mov_b64 exec, 0xffff
L_poll_104:
  buffer_load_dword v8, v7, s[20:23], s56 offen sc1
  s_waitcnt vmcnt(0)
  v_cmp_ne_u32 vcc, s43, v8
  s_add_u32 s63, s63, 1
  s_nop 1
  s_cbranch_vccz L_polldone_105
  s_cmp_lt_u32 s63, 262144
  s_cbranch_scc1 L_poll_104
L_polldone_105:
  s_mov_b64 exec, -1
L_pollskip_103:
  s_barrier
  buffer_load_dwordx4 v[128:131], v1, s[20:23], s69 offen offset:0 sc1
  buffer_load_dwordx4 v[132:135], v1, s[20:23], s69 offen offset:1024 sc1
  buffer_load_dwordx4 v[136:139], v1, s[20:23], s69 offen offset:2048 sc1
  buffer_load_dwordx4 v[140:143], v1, s[20:23], s69 offen offset:3072 sc1
  s_add_u32 s77, s69, 0x1000
  buffer_load_dwordx4 v[144:147], v1, s[20:23], s77 offen offset:0 sc1
  buffer_load_dwordx4 v[148:151], v1, s[20:23], s77 offen offset:1024 sc1
  buffer_load_dwordx4 v[152:155], v1, s[20:23], s77 offen offset:2048 sc1
  buffer_load_dwordx4 v[156:159], v1, s[20:23], s77 offen offset:3072 sc1
  s_add_u32 s74, s69, 0x10000
  buffer_load_dwordx4 v[160:163], v1, s[20:23], s74 offen offset:0 sc1
  buffer_load_dwordx4 v[164:167], v1, s[20:23], s74 offen offset:1024 sc1
  s_waitcnt vmcnt(9)
  v_mfma_f32_32x32x16_bf16 v[64:79], v[192:195], v[128:131], 0
  buffer_load_dwordx4 v[168:171], v1, s[20:23], s74 offen offset:2048 sc1
  v_mfma_f32_32x32x16_bf16 v[80:95], v[224:227], v[128:131], 0
  s_waitcnt vmcnt(9)
  v_mfma_f32_32x32x16_bf16 v[64:79], v[196:199], v[132:135], v[64:79]
  buffer_load_dwordx4 v[172:175], v1, s[20:23], s74 offen offset:3072 sc1
  v_mfma_f32_32x32x16_bf16 v[80:95], v[228:231], v[132:135], v[80:95]
  s_waitcnt vmcnt(9)
  v_mfma_f32_32x32x16_bf16 v[64:79], v[200:203], v[136:139], v[64:79]
  s_add_u32 s75, s69, 0x11000
  buffer_load_dwordx4 v[176:179], v1, s[20:23], s75 offen offset:0 sc1
  v_mfma_f32_32x32x16_bf16 v[80:95], v[232:235], v[136:139], v[80:95]
  s_waitcnt vmcnt(9)
  v_mfma_f32_32x32x16_bf16 v[64:79], v[204:207], v[140:143], v[64:79]
  buffer_load_dwordx4 v[180:183], v1, s[20:23], s75 offen offset:1024 sc1
  v_mfma_f32_32x32x16_bf16 v[80:95], v[236:239], v[140:143], v[80:95]
  s_waitcnt vmcnt(9)
  v_mfma_f32_32x32x16_bf16 v[64:79], v[208:211], v[144:147], v[64:79]
  buffer_load_dwordx4 v[184:187], v1, s[20:23], s75 offen offset:2048 sc1
  v_mfma_f32_32x32x16_bf16 v[80:95], v[240:243], v[144:147], v[80:95]
  s_waitcnt vmcnt(9)
  v_mfma_f32_32x32x16_bf16 v[64:79], v[212:215], v[148:151], v[64:79]
  buffer_load_dwordx4 v[188:191], v1, s[20:23], s75 offen offset:3072 sc1
  v_mfma_f32_32x32x16_bf16 v[80:95], v[244:247], v[148:151], v[80:95]
  s_waitcnt vmcnt(9)
  v_mfma_f32_32x32x16_bf16 v[64:79], v[216:219], v[152:155], v[64:79]
  v_mfma_f32_32x32x16_bf16 v[80:95], v[248:251], v[152:155], v[80:95]
  s_waitcnt vmcnt(8)
  v_mfma_f32_32x32x16_bf16 v[64:79], v[220:223], v[156:159], v[64:79]
  v_mfma_f32_32x32x16_bf16 v[80:95], v[252:255], v[156:159], v[80:95]
  s_waitcnt vmcnt(7)
  v_mfma_f32_32x32x16_bf16 v[96:111], v[192:195], v[160:163], 0
  v_mfma_f32_32x32x16_bf16 v[112:127], v[224:227], v[160:163], 0
  s_waitcnt vmcnt(6)
  v_mfma_f32_32x32x16_bf16 v[96:111], v[196:199], v[164:167], v[96:111]
  s_nop 5
  ds_write_b128 v10, v[72:75] offset:0
  v_mfma_f32_32x32x16_bf16 v[112:127], v[228:231], v[164:167], v[112:127]
  ds_write_b128 v10, v[76:79] offset:1024
  s_waitcnt vmcnt(5)
  v_mfma_f32_32x32x16_bf16 v[96:111], v[200:203], v[168:171], v[96:111]
  ds_write_b128 v11, v[80:83] offset:0
  v_mfma_f32_32x32x16_bf16 v[112:127], v[232:235], v[168:171], v[112:127]
  ds_write_b128 v11, v[84:87] offset:1024
  s_waitcnt vmcnt(4)
  v_mfma_f32_32x32x16_bf16 v[96:111], v[204:207], v[172:175], v[96:111]
  ds_write_b128 v12, v[88:91] offset:0
  v_mfma_f32_32x32x16_bf16 v[112:127], v[236:239], v[172:175], v[112:127]
  ds_write_b128 v12, v[92:95] offset:1024
  s_waitcnt vmcnt(3)
  v_mfma_f32_32x32x16_bf16 v[96:111], v[208:211], v[176:179], v[96:111]
  s_waitcnt lgkmcnt(0)
  s_barrier
  ds_read_b128 v[72:75], v13 offset:0
  ds_read_b128 v[76:79], v13 offset:1024
  ds_read_b128 v[80:83], v13 offset:2048
  ds_read_b128 v[84:87], v13 offset:3072
  v_mfma_f32_32x32x16_bf16 v[112:127], v[240:243], v[176:179], v[112:127]
  ds_read_b128 v[88:91], v13 offset:4096
  ds_read_b128 v[92:95], v13 offset:5120
  s_add_u32 s57, s32, 0x818000
  s_add_u32 s58, s33, 0x10c0000
  v_lshlrev_b32 v40, 16, v16
  s_waitcnt vmcnt(2)
  v_mfma_f32_32x32x16_bf16 v[96:111], v[212:215], v[180:183], v[96:111]
  v_and_b32 v16, 0xffff0000, v16
  v_lshlrev_b32 v41, 16, v17
  v_and_b32 v17, 0xffff0000, v17
  v_lshlrev_b32 v42, 16, v18
  v_and_b32 v18, 0xffff0000, v18
  v_mfma_f32_32x32x16_bf16 v[112:127], v[244:247], v[180:183], v[112:127]
  v_lshlrev_b32 v43, 16, v19
  v_and_b32 v19, 0xffff0000, v19
  v_add_f32 v64, v64, v40
  v_add_f32 v65, v65, v16
  v_add_f32 v66, v66, v41
  s_waitcnt vmcnt(1)
  v_mfma_f32_32x32x16_bf16 v[96:111], v[216:219], v[184:187], v[96:111]
  v_add_f32 v67, v67, v17
  v_add_f32 v68, v68, v42
  v_add_f32 v69, v69, v18
  v_add_f32 v70, v70, v43
  v_add_f32 v71, v71, v19
  v_mfma_f32_32x32x16_bf16 v[112:127], v[248:251], v[184:187], v[112:127]
  s_waitcnt lgkmcnt(4)
  v_add_f32 v64, v64, v72
  v_add_f32 v65, v65, v73
  v_add_f32 v66, v66, v74
  v_add_f32 v67, v67, v75
  v_add_f32 v68, v68, v76
  s_waitcnt vmcnt(0)
  v_mfma_f32_32x32x16_bf16 v[96:111], v[220:223], v[188:191], v[96:111]
  v_add_f32 v69, v69, v77
  v_add_f32 v70, v70, v78
  v_add_f32 v71, v71, v79
  s_waitcnt lgkmcnt(2)
  v_add_f32 v64, v64, v80
  v_add_f32 v65, v65, v81
  v_mfma_f32_32x32x16_bf16 v[112:127], v[252:255], v[188:191], v[112:127]
  v_add_f32 v66, v66, v82
  v_add_f32 v67, v67, v83
  v_add_f32 v68, v68, v84
  v_add_f32 v69, v69, v85
  v_add_f32 v70, v70, v86
  v_add_f32 v71, v71, v87
  s_waitcnt lgkmcnt(0)
  v_add_f32 v64, v64, v88
  v_add_f32 v65, v65, v89
  v_add_f32 v66, v66, v90
  v_add_f32 v67, v67, v91
  v_add_f32 v68, v68, v92
  v_add_f32 v69, v69, v93
  v_add_f32 v70, v70, v94
  v_add_f32 v71, v71, v95
  v_cvt_pk_bf16_f32 v40, v64, v65
  v_cvt_pk_bf16_f32 v41, v66, v67
  v_cvt_pk_bf16_f32 v42, v68, v69
  v_cvt_pk_bf16_f32 v43, v70, v71
  v_cvt_pk_bf16_f32 v16, v64, v65
  v_cvt_pk_bf16_f32 v17, v66, v67
  v_cvt_pk_bf16_f32 v18, v68, v69
  v_cvt_pk_bf16_f32 v19, v70, v71
  v_permlane32_swap_b32 v40, v42
  v_permlane32_swap_b32 v41, v43
  s_cmp_eq_u32 s44, 0
  s_cbranch_scc1 L_slow_106
  buffer_store_dwordx4 v[40:43], v1, s[20:23], s57 offen
L_join_107:
  v_add_f32 v44, v64, v65
  v_mul_f32 v45, v64, v64
  v_fmac_f32 v45, v65, v65
  v_add_f32 v44, v44, v66
  v_fmac_f32 v45, v66, v66
  v_add_f32 v44, v44, v67
  v_fmac_f32 v45, v67, v67
  v_add_f32 v44, v44, v68
  v_fmac_f32 v45, v68, v68
  v_add_f32 v44, v44, v69
  v_fmac_f32 v45, v69, v69
  v_add_f32 v44, v44, v70
  v_fmac_f32 v45, v70, v70
  v_add_f32 v44, v44, v71
  v_fmac_f32 v45, v71, v71
  s_nop 1
  v_permlane32_swap_b32 v44, v45
  v_add_f32 v44, v44, v45
  s_cmp_eq_u32 s44, 0
  s_cbranch_scc1 L_slow_108
  buffer_store_dword v44, v4, s[20:23], s58 offen
L_join_109:
  ds_write_b128 v10, v[104:107] offset:24576
  ds_write_b128 v10, v[108:111] offset:25600
  ds_write_b128 v11, v[112:115] offset:24576
  ds_write_b128 v11, v[116:119] offset:25600
  ds_write_b128 v12, v[120:123] offset:24576
  ds_write_b128 v12, v[124:127] offset:25600
  v_dot2_f32_bf16 v96, v20, s60, v96
  v_dot2_f32_bf16 v97, v20, s61, v97
  v_dot2_f32_bf16 v98, v21, s60, v98
  v_dot2_f32_bf16 v99, v21, s61, v99
  v_dot2_f32_bf16 v100, v22, s60, v100
  v_dot2_f32_bf16 v101, v22, s61, v101
  v_dot2_f32_bf16 v102, v23, s60, v102
  v_dot2_f32_bf16 v103, v23, s61, v103
  s_waitcnt vmcnt(0) lgkmcnt(0)
  s_barrier
  ds_read_b128 v[104:107], v13 offset:24576
  ds_read_b128 v[108:111], v13 offset:25600
  ds_read_b128 v[112:115], v13 offset:26624
  ds_read_b128 v[116:119], v13 offset:27648
  ds_read_b128 v[120:123], v13 offset:28672
  ds_read_b128 v[124:127], v13 offset:29696
  s_cmp_lg_u32 s42, 0
  s_cbranch_scc1 L_pubskip_110
  s_lshl_b32 s56, s40, 7
  s_lshl_b32 s57, s41, 2
  s_add_u32 s56, s56, s57
  s_add_u32 s56, s56, 0x4800
  v_mov_b32 v8, s43
  s_mov_b64 exec, 1
  s_cmp_eq_u32 s44, 0
  s_cbranch_scc1 L_slow_111
  buffer_store_dword v8, v7, s[20:23], s56 offen
L_join_112:
  s_mov_b64 exec, -1
  s_nop 0
L_pubskip_110:
  s_add_u32 s57, s32, 0x826000
  s_add_u32 s58, s33, 0x10c3800
  s_waitcnt lgkmcnt(4)
  v_pk_add_f32 v[96:97], v[96:97], v[104:105]
  v_pk_add_f32 v[98:99], v[98:99], v[106:107]
  v_pk_add_f32 v[100:101], v[100:101], v[108:109]
  v_pk_add_f32 v[102:103], v[102:103], v[110:111]
  s_waitcnt lgkmcnt(2)
  v_pk_add_f32 v[96:97], v[96:97], v[112:113]
  v_pk_add_f32 v[98:99], v[98:99], v[114:115]
  v_pk_add_f32 v[100:101], v[100:101], v[116:117]
  v_pk_add_f32 v[102:103], v[102:103], v[118:119]
  s_waitcnt lgkmcnt(0)
  v_pk_add_f32 v[96:97], v[96:97], v[120:121]
  v_pk_add_f32 v[98:99], v[98:99], v[122:123]
  v_pk_add_f32 v[100:101], v[100:101], v[124:125]
  v_pk_add_f32 v[102:103], v[102:103], v[126:127]
  v_cvt_pk_bf16_f32 v48, v96, v97
  v_cvt_pk_bf16_f32 v49, v98, v99
  v_cvt_pk_bf16_f32 v50, v100, v101
  v_cvt_pk_bf16_f32 v51, v102, v103
  v_cvt_pk_bf16_f32 v20, v96, v97
  v_cvt_pk_bf16_f32 v21, v98, v99
  v_cvt_pk_bf16_f32 v22, v100, v101
  v_cvt_pk_bf16_f32 v23, v102, v103
  v_permlane32_swap_b32 v48, v50
  v_permlane32_swap_b32 v49, v51
  s_cmp_eq_u32 s44, 0
  s_cbranch_scc1 L_slow_113
  buffer_store_dwordx4 v[48:51], v1, s[20:23], s57 offen
L_join_114:
  v_dot2_f32_bf16 v52, v20, s62, 0
  v_dot2_f32_bf16 v53, v20, v20, 0
  v_dot2_f32_bf16 v52, v21, s62, v52
  v_dot2_f32_bf16 v53, v21, v21, v53
  v_dot2_f32_bf16 v52, v22, s62, v52
  v_dot2_f32_bf16 v53, v22, v22, v53
  v_dot2_f32_bf16 v52, v23, s62, v52
  v_dot2_f32_bf16 v53, v23, v23, v53
  s_nop 2
  v_permlane32_swap_b32 v52, v53
  v_add_f32 v52, v52, v53
  s_cmp_eq_u32 s44, 0
  s_cbranch_scc1 L_slow_115
  buffer_store_dword v52, v4, s[20:23], s58 offen
L_join_116:
  s_lshl_b32 s51, s40, 7
  s_add_u32 s51, s51, 0x4800
  s_mov_b64 exec, 0x3fff
  buffer_load_dword v10, v7, s[20:23], s51 offen sc1
  s_mov_b64 exec, -1
  s_lshl_b32 s93, s42, 2
  s_min_u32 s93, s93, 10
  s_lshl_b32 s93, s93, 10
  s_add_u32 s69, s39, s93
  s_add_u32 s69, s69, 0x818000
  s_add_u32 s80, s69, s38
  s_sub_u32 s81, s69, s38
  s_add_u32 s93, s93, 0x18400
  s_lshl_b32 s56, s41, 2
  s_add_u32 s56, s56, s42
  s_lshl_b32 s56, s56, 11
  s_add_u32 s78, s39, s56
  s_mul_i32 s56, s42, 28672
  s_add_u32 s56, s56, s39
  s_mul_i32 s79, s46, 0xfffa8000
  s_add_u32 s79, s79, 0x834000
  s_add_u32 s79, s79, s56
  s_mul_i32 s88, s46, 0x1c000
  s_add_u32 s88, s88, 0x7fc000
  s_add_u32 s88, s88, s56
L_gu1:
  s_waitcnt vmcnt(0)
  v_cmp_ne_u32 vcc, s43, v10
  s_nop 1
  s_and_b32 s56, vcc_lo, 0x3fff
  s_cbranch_scc1 L_fsp_119
L_fok_118:
  s_add_u32 s76, s80, 0x0
  s_add_u32 m0, s93, 0x0
  s_nop 0
  buffer_load_dwordx4 v1, s[20:23], s76 offen offset:0 sc1 lds
  buffer_load_dwordx4 v1, s[20:23], s76 offen offset:1024 sc1 lds
  buffer_load_dwordx4 v1, s[20:23], s76 offen offset:2048 sc1 lds
  buffer_load_dwordx4 v1, s[20:23], s76 offen offset:3072 sc1 lds
  s_waitcnt lgkmcnt(0)
  s_barrier
  s_cmp_lg_u32 s42, 0
  s_cbranch_scc1 L_pubskip_121
  s_lshl_b32 s56, s40, 7
  s_lshl_b32 s57, s41, 2
  s_add_u32 s56, s56, s57
  s_add_u32 s56, s56, 0x5000
  v_mov_b32 v8, s43
  s_mov_b64 exec, 1
  s_cmp_eq_u32 s44, 0
  s_cbranch_scc1 L_slow_122
  buffer_store_dword v8, v7, s[20:23], s56 offen
L_join_123:
  s_mov_b64 exec, -1
  s_nop 0
L_pubskip_121:
  s_add_u32 s77, s81, 0x3800
  s_add_u32 m0, s93, 0x3800
  s_nop 0
  buffer_load_dwordx4 v1, s[20:23], s77 offen offset:0 sc1 lds
  buffer_load_dwordx4 v1, s[20:23], s77 offen offset:1024 sc1 lds
  buffer_load_dwordx4 v1, s[20:23], s77 offen offset:2048 sc1 lds
  buffer_load_dwordx4 v1, s[20:23], s77 offen offset:3072 sc1 lds
  s_waitcnt vmcnt(4)
  s_barrier
  ds_read_b128 v[48:51], v2 offset:33792
  ds_read_b128 v[52:55], v2 offset:34816
  ds_read_b128 v[56:59], v2 offset:35840
  s_waitcnt lgkmcnt(2)
  v_mfma_f32_32x32x16_bf16 v[64:79], a[0:3], v[48:51], 0
  s_lshl_b32 s52, s40, 7
  s_add_u32 s52, s52, 0x5000
  s_mov_b64 exec, 0x3fff
  buffer_load_dword v12, v7, s[20:23], s52 offen sc1
  s_mov_b64 exec, -1
  s_nop 0
  v_mfma_f32_32x32x16_bf16 v[80:95], a[116:119], v[48:51], 0
  s_add_u32 s74, s80, 0x7000
  s_add_u32 m0, s93, 0x7000
  s_nop 0
  buffer_load_dwordx4 v1, s[20:23], s74 offen offset:0 sc1 lds
  ds_read_b128 v[60:63], v2 offset:36864
  s_waitcnt lgkmcnt(2)
  v_mfma_f32_32x32x16_bf16 v[64:79], a[4:7], v[52:55], v[64:79]
  v_mfma_f32_32x32x16_bf16 v[80:95], a[120:123], v[52:55], v[80:95]
  buffer_load_dwordx4 v1, s[20:23], s74 offen offset:1024 sc1 lds
  ds_read_b128 v[48:51], v2 offset:37888
  s_waitcnt lgkmcnt(2)
  v_mfma_f32_32x32x16_bf16 v[64:79], a[8:11], v[56:59], v[64:79]
  v_mfma_f32_32x32x16_bf16 v[80:95], a[124:127], v[56:59], v[80:95]
  buffer_load_dwordx4 v1, s[20:23], s74 offen offset:2048 sc1 lds
  ds_read_b128 v[52:55], v2 offset:38912
  s_waitcnt lgkmcnt(2)
  v_mfma_f32_32x32x16_bf16 v[64:79], a[12:15], v[60:63], v[64:79]
  v_mfma_f32_32x32x16_bf16 v[80:95], a[128:131], v[60:63], v[80:95]
  buffer_load_dwordx4 v1, s[20:23], s74 offen offset:3072 sc1 lds
  ds_read_b128 v[56:59], v2 offset:39936
  s_waitcnt lgkmcnt(2)
  v_mfma_f32_32x32x16_bf16 v[64:79], a[16:19], v[48:51], v[64:79]
  v_mfma_f32_32x32x16_bf16 v[80:95], a[132:135], v[48:51], v[80:95]
  s_add_u32 s75, s81, 0xa800
  s_add_u32 m0, s93, 0xa800
  s_nop 0
  buffer_load_dwordx4 v1, s[20:23], s75 offen offset:0 sc1 lds
  ds_read_b128 v[60:63], v2 offset:40960
  s_waitcnt lgkmcnt(2)
  v_mfma_f32_32x32x16_bf16 v[64:79], a[20:23], v[52:55], v[64:79]
  v_mfma_f32_32x32x16_bf16 v[80:95], a[136:139], v[52:55], v[80:95]
  buffer_load_dwordx4 v1, s[20:23], s75 offen offset:1024 sc1 lds
  ds_read_b128 v[48:51], v2 offset:41984
  s_waitcnt lgkmcnt(2)
  v_mfma_f32_32x32x16_bf16 v[64:79], a[24:27], v[56:59], v[64:79]
  v_mfma_f32_32x32x16_bf16 v[80:95], a[140:143], v[56:59], v[80:95]
  buffer_load_dwordx4 v1, s[20:23], s75 offen offset:2048 sc1 lds
  ds_read_b128 v[52:55], v2 offset:43008
  s_waitcnt lgkmcnt(2)
  v_mfma_f32_32x32x16_bf16 v[64:79], a[28:31], v[60:63], v[64:79]
  v_mfma_f32_32x32x16_bf16 v[80:95], a[144:147], v[60:63], v[80:95]
  buffer_load_dwordx4 v1, s[20:23], s75 offen offset:3072 sc1 lds
  ds_read_b128 v[56:59], v2 offset:44032
  s_waitcnt vmcnt(8)
  v_cmp_ne_u32 vcc, s43, v12
  s_nop 1
  s_and_b32 s56, vcc_lo, 0x3fff
  s_cbranch_scc1 L_fsp_126
L_fok_125:
  s_waitcnt lgkmcnt(2)
  v_mfma_f32_32x32x16_bf16 v[64:79], a[32:35], v[48:51], v[64:79]
  s_lshl_b32 s91, s40, 2
  s_add_u32 s91, s91, s42
  s_mul_i32 s91, s91, 7168
  s_add_u32 s91, s91, 0x10c0000
  buffer_load_dwordx4 v[96:99], v5, s[20:23], s91 offen offset:0 sc1
  v_mfma_f32_32x32x16_bf16 v[80:95], a[148:151], v[48:51], v[80:95]
  buffer_load_dwordx4 v[100:103], v5, s[20:23], s91 offen offset:1024 sc1
  ds_read_b128 v[60:63], v2 offset:45056
  s_waitcnt lgkmcnt(2)
  v_mfma_f32_32x32x16_bf16 v[64:79], a[36:39], v[52:55], v[64:79]
  buffer_load_dwordx4 v[104:107], v5, s[20:23], s91 offen offset:2048 sc1
  v_mfma_f32_32x32x16_bf16 v[80:95], a[152:155], v[52:55], v[80:95]
  buffer_load_dwordx4 v[108:111], v5, s[20:23], s91 offen offset:3072 sc1
  ds_read_b128 v[48:51], v2 offset:46080
  s_waitcnt lgkmcnt(2)
  v_mfma_f32_32x32x16_bf16 v[64:79], a[40:43], v[56:59], v[64:79]
  s_add_u32 s91, s91, 4096
  buffer_load_dwordx4 v[112:115], v5, s[20:23], s91 offen offset:0 sc1
  v_mfma_f32_32x32x16_bf16 v[80:95], a[156:159], v[56:59], v[80:95]
  buffer_load_dwordx4 v[116:119], v5, s[20:23], s91 offen offset:1024 sc1
  s_barrier
  ds_read_b128 v[52:55], v2 offset:47104
  s_waitcnt lgkmcnt(2)
  v_mfma_f32_32x32x16_bf16 v[64:79], a[44:47], v[60:63], v[64:79]
  buffer_load_dwordx4 v[120:123], v5, s[20:23], s91 offen offset:2048 sc1
  v_mfma_f32_32x32x16_bf16 v[80:95], a[160:163], v[60:63], v[80:95]
  ds_read_b128 v[56:59], v2 offset:48128
  s_waitcnt lgkmcnt(2)
  v_mfma_f32_32x32x16_bf16 v[64:79], a[48:51], v[48:51], v[64:79]
  v_mfma_f32_32x32x16_bf16 v[80:95], a[164:167], v[48:51], v[80:95]
  ds_read_b128 v[60:63], v2 offset:49152
  s_waitcnt lgkmcnt(2)
  v_mfma_f32_32x32x16_bf16 v[64:79], a[52:55], v[52:55], v[64:79]
  v_mfma_f32_32x32x16_bf16 v[80:95], a[168:171], v[52:55], v[80:95]
  ds_read_b128 v[48:51], v2 offset:50176
  s_waitcnt lgkmcnt(2)
  v_mfma_f32_32x32x16_bf16 v[64:79], a[56:59], v[56:59], v[64:79]
  v_mfma_f32_32x32x16_bf16 v[80:95], a[172:175], v[56:59], v[80:95]
  ds_read_b128 v[52:55], v2 offset:51200
  s_waitcnt lgkmcnt(2)
  v_mfma_f32_32x32x16_bf16 v[64:79], a[60:63], v[60:63], v[64:79]
  v_mfma_f32_32x32x16_bf16 v[80:95], a[176:179], v[60:63], v[80:95]
  ds_read_b128 v[56:59], v2 offset:52224
  s_waitcnt lgkmcnt(2)
  v_mfma_f32_32x32x16_bf16 v[64:79], a[64:67], v[48:51], v[64:79]
  v_mfma_f32_32x32x16_bf16 v[80:95], a[180:183], v[48:51], v[80:95]
  ds_read_b128 v[60:63], v2 offset:53248
  s_waitcnt lgkmcnt(2)
  v_mfma_f32_32x32x16_bf16 v[64:79], a[68:71], v[52:55], v[64:79]
  v_mfma_f32_32x32x16_bf16 v[80:95], a[184:187], v[52:55], v[80:95]
  ds_read_b128 v[48:51], v2 offset:54272
  s_waitcnt lgkmcnt(2)
  v_mfma_f32_32x32x16_bf16 v[64:79], a[72:75], v[56:59], v[64:79]
  v_mfma_f32_32x32x16_bf16 v[80:95], a[188:191], v[56:59], v[80:95]
  ds_read_b128 v[52:55], v2 offset:55296
  s_waitcnt lgkmcnt(2)
  v_mfma_f32_32x32x16_bf16 v[64:79], a[76:79], v[60:63], v[64:79]
  v_mfma_f32_32x32x16_bf16 v[80:95], a[192:195], v[60:63], v[80:95]
  ds_read_b128 v[56:59], v2 offset:56320
  s_waitcnt lgkmcnt(2)
  v_mfma_f32_32x32x16_bf16 v[64:79], a[80:83], v[48:51], v[64:79]
  s_waitcnt vmcnt(0)
  v_add_f32 v96, v96, v98
  v_add_f32 v97, v97, v99
  v_add_f32 v96, v96, v100
  v_add_f32 v97, v97, v101
  v_mfma_f32_32x32x16_bf16 v[80:95], a[196:199], v[48:51], v[80:95]
  ds_read_b128 v[60:63], v2 offset:57344
  v_add_f32 v96, v96, v102
  v_add_f32 v97, v97, v103
  v_add_f32 v96, v96, v104
  v_add_f32 v97, v97, v105
  s_waitcnt lgkmcnt(2)
  v_mfma_f32_32x32x16_bf16 v[64:79], a[84:87], v[52:55], v[64:79]
  buffer_load_dwordx4 v[128:131], v14, s[20:23], s68 offen offset:0
  v_add_f32 v96, v96, v106
  v_add_f32 v97, v97, v107
  v_add_f32 v96, v96, v108
  v_add_f32 v97, v97, v109
  v_mfma_f32_32x32x16_bf16 v[80:95], a[200:203], v[52:55], v[80:95]
  ds_read_b128 v[48:51], v2 offset:58368
  v_add_f32 v96, v96, v110
  v_add_f32 v97, v97, v111
  v_add_f32 v96, v96, v112
  v_add_f32 v97, v97, v113
  s_waitcnt lgkmcnt(2)
  v_mfma_f32_32x32x16_bf16 v[64:79], a[88:91], v[56:59], v[64:79]
  v_add_f32 v96, v96, v114
  v_add_f32 v97, v97, v115
  v_add_f32 v96, v96, v116
  v_add_f32 v97, v97, v117
  v_mfma_f32_32x32x16_bf16 v[80:95], a[204:207], v[56:59], v[80:95]
  ds_read_b128 v[52:55], v2 offset:59392
  v_add_f32 v96, v96, v118
  v_add_f32 v97, v97, v119
  v_add_f32 v96, v96, v120
  v_add_f32 v97, v97, v121
  s_waitcnt lgkmcnt(2)
  v_mfma_f32_32x32x16_bf16 v[64:79], a[92:95], v[60:63], v[64:79]
  buffer_load_dwordx4 v[136:139], v14, s[20:23], s68 offen offset:1024
  v_add_f32 v96, v96, v122
  v_add_f32 v97, v97, v123
  s_nop 1
  v_permlane32_swap_b32 v96, v97
  v_add_f32 v96, v96, v97
  v_mfma_f32_32x32x16_bf16 v[80:95], a[208:211], v[60:63], v[80:95]
  ds_read_b128 v[56:59], v2 offset:60416
  v_mov_b32 v97, v96
  s_nop 1
  v_permlane32_swap_b32 v96, v97
  v_mul_f32 v96, 0x3b124925, v96
  v_mul_f32 v97, 0x3b124925, v97
  s_waitcnt lgkmcnt(2)
  v_mfma_f32_32x32x16_bf16 v[64:79], a[96:99], v[48:51], v[64:79]
  v_fma_f32 v97, -v96, v96, v97
  v_max_f32 v97, 0, v97
  v_cvt_pk_bf16_f32 v24, -v96, -v96
  v_cvt_pk_bf16_f32 v28, v97, v97
  v_mfma_f32_32x32x16_bf16 v[80:95], a[212:215], v[48:51], v[80:95]
  s_barrier
  ds_read_b128 v[60:63], v2 offset:61440
  v_and_b32 v28, 0xffff0000, v28
  v_add_f32 v28, 0x3727c5ac, v28
  v_cvt_pk_bf16_f32 v28, v28, v28
  v_and_b32 v28, 0xffff0000, v28
  s_waitcnt lgkmcnt(2)
  v_mfma_f32_32x32x16_bf16 v[64:79], a[100:103], v[52:55], v[64:79]
  buffer_load_dwordx4 v[144:147], v14, s[20:23], s68 offen offset:2048
  v_sqrt_f32 v28, v28
  s_nop 0
  v_cvt_pk_bf16_f32 v28, v28, v28
  v_and_b32 v27, 0xffff0000, v28
  v_mfma_f32_32x32x16_bf16 v[80:95], a[216:219], v[52:55], v[80:95]
  s_add_u32 s76, s80, 0xe000
  s_add_u32 m0, s93, 0x0
  s_nop 0
  buffer_load_dwordx4 v1, s[20:23], s76 offen offset:0 sc1 lds
  ds_read_b128 v[48:51], v2 offset:62464
  v_lshrrev_b32 v25, 16, v28
  v_rcp_f32 v26, v27
  s_waitcnt lgkmcnt(2)
  v_mfma_f32_32x32x16_bf16 v[64:79], a[104:107], v[56:59], v[64:79]
  v_mul_f32 v32, 0xc0135761, v26
  v_mul_f32 v33, v26, v26
  v_mul_f32 v33, v33, v32
  v_mul_f32 v33, 0x3d372713, v33
  v_mfma_f32_32x32x16_bf16 v[80:95], a[220:223], v[56:59], v[80:95]
  buffer_load_dwordx4 v1, s[20:23], s76 offen offset:1024 sc1 lds
  ds_read_b128 v[52:55], v2 offset:63488
  v_mul_f32 v34, v27, v27
  v_mov_b32 v35, 0
  v_mov_b32 v26, 0
  s_waitcnt lgkmcnt(2)
  v_mfma_f32_32x32x16_bf16 v[64:79], a[108:111], v[60:63], v[64:79]
  buffer_load_dwordx4 v[152:155], v14, s[20:23], s68 offen offset:3072
  v_mov_b32 v27, 0
  s_lshl_b32 s56, s42, 11
  s_add_u32 s56, s56, 0x16400
  v_add_u32 v8, s56, v1
  v_mfma_f32_32x32x16_bf16 v[80:95], a[224:227], v[60:63], v[80:95]
  buffer_load_dwordx4 v1, s[20:23], s76 offen offset:2048 sc1 lds
  ds_read_b128 v[56:59], v2 offset:64512
  ds_write_b128 v8, v[24:27]
  ds_write_b128 v8, v[32:35] offset:1024
  s_waitcnt lgkmcnt(0)
  s_barrier
  v_mfma_f32_32x32x16_bf16 v[96:111], a[0:3], v[48:51], 0
  v_mfma_f32_32x32x16_bf16 v[112:127], a[116:119], v[48:51], 0
  buffer_load_dwordx4 v1, s[20:23], s76 offen offset:3072 sc1 lds
  ds_read_b128 v[60:63], v2 offset:25600
  v_mfma_f32_32x32x16_bf16 v[96:111], a[4:7], v[52:55], v[96:111]
  buffer_load_dwordx4 v[132:135], v14, s[20:23], s83 offen offset:0
  v_mfma_f32_32x32x16_bf16 v[112:127], a[120:123], v[52:55], v[112:127]
  ds_read_b128 v[48:51], v3 offset:0
  v_mfma_f32_32x32x16_bf16 v[96:111], a[8:11], v[56:59], v[96:111]
  v_mfma_f32_32x32x16_bf16 v[112:127], a[124:127], v[56:59], v[112:127]
  ds_read_b128 v[52:55], v3 offset:1024
  s_waitcnt lgkmcnt(2)
  v_mfma_f32_32x32x16_bf16 v[64:79], a[112:115], v[60:63], v[64:79]
  buffer_load_dwordx4 v[140:143], v14, s[20:23], s83 offen offset:1024
  v_mfma_f32_32x32x16_bf16 v[80:95], a[228:231], v[60:63], v[80:95]
  ds_read_b128 v[56:59], v3 offset:2048
  s_waitcnt lgkmcnt(2)
  v_mfma_f32_32x32x16_bf16 v[96:111], a[12:15], v[48:51], v[96:111]
  v_mfma_f32_32x32x16_bf16 v[112:127], a[128:131], v[48:51], v[112:127]
  ds_read_b128 v[60:63], v3 offset:3072
  s_waitcnt lgkmcnt(2)
  v_mfma_f32_32x32x16_bf16 v[96:111], a[16:19], v[52:55], v[96:111]
  buffer_load_dwordx4 v[148:151], v14, s[20:23], s83 offen offset:2048
  ds_read_b128 v[40:43], v2 offset:26624
  s_waitcnt lgkmcnt(0)
  v_mul_f32 v8, v64, v64
  v_mul_f32 v9, v65, v65
  v_mul_f32 v10, v66, v66
  v_mfma_f32_32x32x16_bf16 v[112:127], a[132:135], v[52:55], v[112:127]
  ds_read_b128 v[48:51], v3 offset:4096
  v_mul_f32 v11, v67, v67
  v_fma_f32 v8, v8, v41, v40
  v_fma_f32 v9, v9, v41, v40
  v_fma_f32 v10, v10, v41, v40
  v_mfma_f32_32x32x16_bf16 v[96:111], a[20:23], v[56:59], v[96:111]
  v_fma_f32 v11, v11, v41, v40
  v_mul_f32 v8, v8, v64
  v_mul_f32 v9, v9, v65
  v_mul_f32 v10, v10, v66
  v_mfma_f32_32x32x16_bf16 v[112:127], a[136:139], v[56:59], v[112:127]
  ds_read_b128 v[52:55], v3 offset:5120
  v_mul_f32 v11, v11, v67
  v_exp_f32 v8, v8
  v_exp_f32 v9, v9
  v_mfma_f32_32x32x16_bf16 v[96:111], a[24:27], v[60:63], v[96:111]
  buffer_load_dwordx4 v[156:159], v14, s[20:23], s83 offen offset:3072
  v_exp_f32 v10, v10
  v_exp_f32 v11, v11
  v_mfma_f32_32x32x16_bf16 v[112:127], a[140:143], v[60:63], v[112:127]
  ds_read_b128 v[56:59], v3 offset:6144
  v_mul_f32 v80, v80, v64
  v_mul_f32 v81, v81, v65
  v_mul_f32 v82, v82, v66
  v_mul_f32 v83, v83, v67
  s_waitcnt lgkmcnt(2)
  v_mfma_f32_32x32x16_bf16 v[96:111], a[28:31], v[48:51], v[96:111]
  v_fma_f32 v8, v8, v42, v42
  v_fma_f32 v9, v9, v42, v42
  v_fma_f32 v10, v10, v42, v42
  v_fma_f32 v11, v11, v42, v42
  v_mfma_f32_32x32x16_bf16 v[112:127], a[144:147], v[48:51], v[112:127]
  ds_read_b128 v[60:63], v3 offset:7168
  v_rcp_f32 v8, v8
  v_rcp_f32 v9, v9
  s_waitcnt lgkmcnt(2)
  v_mfma_f32_32x32x16_bf16 v[96:111], a[32:35], v[52:55], v[96:111]
  s_add_u32 s71, s68, 0x1000
  buffer_load_dwordx4 v[160:163], v14, s[20:23], s71 offen offset:0
  v_rcp_f32 v10, v10
  v_rcp_f32 v11, v11
  v_mfma_f32_32x32x16_bf16 v[112:127], a[148:151], v[52:55], v[112:127]
  ds_read_b128 v[48:51], v3 offset:8192
  v_mul_f32 v80, v80, v8
  v_mul_f32 v81, v81, v9
  v_mul_f32 v82, v82, v10
  v_mul_f32 v83, v83, v11
  s_waitcnt lgkmcnt(2)
  v_mfma_f32_32x32x16_bf16 v[96:111], a[36:39], v[56:59], v[96:111]
  v_cvt_pk_bf16_f32 v24, v80, v81
  v_cvt_pk_bf16_f32 v25, v82, v83
  v_mul_f32 v8, v68, v68
  v_mul_f32 v9, v69, v69
  v_mfma_f32_32x32x16_bf16 v[112:127], a[152:155], v[56:59], v[112:127]
  ds_read_b128 v[52:55], v3 offset:9216
  v_mul_f32 v10, v70, v70
  v_mul_f32 v11, v71, v71
  v_fma_f32 v8, v8, v41, v40
  v_fma_f32 v9, v9, v41, v40
  s_waitcnt lgkmcnt(2)
  v_mfma_f32_32x32x16_bf16 v[96:111], a[40:43], v[60:63], v[96:111]
  buffer_load_dwordx4 v[168:171], v14, s[20:23], s71 offen offset:1024
  v_fma_f32 v10, v10, v41, v40
  v_fma_f32 v11, v11, v41, v40
  v_mul_f32 v8, v8, v68
  v_mul_f32 v9, v9, v69
  v_mfma_f32_32x32x16_bf16 v[112:127], a[156:159], v[60:63], v[112:127]
  s_barrier
  ds_read_b128 v[56:59], v3 offset:10240
  v_mul_f32 v10, v10, v70
  v_mul_f32 v11, v11, v71
  v_exp_f32 v8, v8
  s_waitcnt lgkmcnt(2)
  v_mfma_f32_32x32x16_bf16 v[96:111], a[44:47], v[48:51], v[96:111]
  v_exp_f32 v9, v9
  v_exp_f32 v10, v10
  v_mfma_f32_32x32x16_bf16 v[112:127], a[160:163], v[48:51], v[112:127]
  s_add_u32 s77, s81, 0x11800
  s_add_u32 m0, s93, 0x3800
  s_nop 0
  buffer_load_dwordx4 v1, s[20:23], s77 offen offset:0 sc1 lds
  ds_read_b128 v[60:63], v3 offset:11264
  v_exp_f32 v11, v11
  v_mul_f32 v84, v84, v68
  s_waitcnt lgkmcnt(2)
  v_mfma_f32_32x32x16_bf16 v[96:111], a[48:51], v[52:55], v[96:111]
  buffer_load_dwordx4 v[176:179], v14, s[20:23], s71 offen offset:2048
  v_mul_f32 v85, v85, v69
  v_mul_f32 v86, v86, v70
  v_mul_f32 v87, v87, v71
  v_fma_f32 v8, v8, v42, v42
  v_mfma_f32_32x32x16_bf16 v[112:127], a[164:167], v[52:55], v[112:127]
  buffer_load_dwordx4 v1, s[20:23], s77 offen offset:1024 sc1 lds
  ds_read_b128 v[48:51], v3 offset:12288
  v_fma_f32 v9, v9, v42, v42
  v_fma_f32 v10, v10, v42, v42
  v_fma_f32 v11, v11, v42, v42
  s_waitcnt lgkmcnt(2)
  v_mfma_f32_32x32x16_bf16 v[96:111], a[52:55], v[56:59], v[96:111]
  v_rcp_f32 v8, v8
  v_rcp_f32 v9, v9
  v_mfma_f32_32x32x16_bf16 v[112:127], a[168:171], v[56:59], v[112:127]
  buffer_load_dwordx4 v1, s[20:23], s77 offen offset:2048 sc1 lds
  ds_read_b128 v[52:55], v3 offset:13312
  v_rcp_f32 v10, v10
  v_rcp_f32 v11, v11
  s_waitcnt lgkmcnt(2)
  v_mfma_f32_32x32x16_bf16 v[96:111], a[56:59], v[60:63], v[96:111]
  buffer_load_dwordx4 v[184:187], v14, s[20:23], s71 offen offset:3072
  v_mul_f32 v84, v84, v8
  v_mul_f32 v85, v85, v9
  v_mul_f32 v86, v86, v10
  v_mul_f32 v87, v87, v11
  v_mfma_f32_32x32x16_bf16 v[112:127], a[172:175], v[60:63], v[112:127]
  buffer_load_dwordx4 v1, s[20:23], s77 offen offset:3072 sc1 lds
  ds_read_b128 v[56:59], v3 offset:14336
  v_cvt_pk_bf16_f32 v26, v84, v85
  v_cvt_pk_bf16_f32 v27, v86, v87
  v_mul_f32 v8, v72, v72
  s_waitcnt lgkmcnt(2)
  v_mfma_f32_32x32x16_bf16 v[96:111], a[60:63], v[48:51], v[96:111]
  v_mul_f32 v9, v73, v73
  v_mul_f32 v10, v74, v74
  v_mul_f32 v11, v75, v75
  v_fma_f32 v8, v8, v41, v40
  v_mfma_f32_32x32x16_bf16 v[112:127], a[176:179], v[48:51], v[112:127]
  ds_read_b128 v[60:63], v3 offset:15360
  v_fma_f32 v9, v9, v41, v40
  v_fma_f32 v10, v10, v41, v40
  v_fma_f32 v11, v11, v41, v40
  v_mul_f32 v8, v8, v72
  s_waitcnt lgkmcnt(2)
  v_mfma_f32_32x32x16_bf16 v[96:111], a[64:67], v[52:55], v[96:111]
  s_add_u32 s72, s83, 0x1000
  buffer_load_dwordx4 v[164:167], v14, s[20:23], s72 offen offset:0
  v_mul_f32 v9, v9, v73
  v_mul_f32 v10, v10, v74
  v_mul_f32 v11, v11, v75
  v_exp_f32 v8, v8
  v_mfma_f32_32x32x16_bf16 v[112:127], a[180:183], v[52:55], v[112:127]
  ds_read_b128 v[48:51], v3 offset:16384
  v_exp_f32 v9, v9
  v_exp_f32 v10, v10
  s_waitcnt lgkmcnt(2)
  v_mfma_f32_32x32x16_bf16 v[96:111], a[68:71], v[56:59], v[96:111]
  s_add_u32 s53, s78, 0x834000
  s_cmp_eq_u32 s44, 0
  s_cbranch_scc1 L_slow_128
  buffer_store_dwordx4 v[24:27], v1, s[20:23], s53 offen offset:0 nt
L_join_129:
  v_exp_f32 v11, v11
  v_mfma_f32_32x32x16_bf16 v[112:127], a[184:187], v[56:59], v[112:127]
  ds_read_b128 v[52:55], v3 offset:17408
  v_mul_f32 v88, v88, v72
  v_mul_f32 v89, v89, v73
  v_mul_f32 v90, v90, v74
  v_mul_f32 v91, v91, v75
  s_waitcnt lgkmcnt(2)
  v_mfma_f32_32x32x16_bf16 v[96:111], a[72:75], v[60:63], v[96:111]
  buffer_load_dwordx4 v[172:175], v14, s[20:23], s72 offen offset:1024
  v_fma_f32 v8, v8, v42, v42
  v_fma_f32 v9, v9, v42, v42
  v_fma_f32 v10, v10, v42, v42
  v_fma_f32 v11, v11, v42, v42
  v_mfma_f32_32x32x16_bf16 v[112:127], a[188:191], v[60:63], v[112:127]
  ds_read_b128 v[56:59], v3 offset:18432
  v_rcp_f32 v8, v8
  v_rcp_f32 v9, v9
  s_waitcnt lgkmcnt(2)
  v_mfma_f32_32x32x16_bf16 v[96:111], a[76:79], v[48:51], v[96:111]
  v_rcp_f32 v10, v10
  v_rcp_f32 v11, v11
  v_mfma_f32_32x32x16_bf16 v[112:127], a[192:195], v[48:51], v[112:127]
  ds_read_b128 v[60:63], v3 offset:19456
  v_mul_f32 v88, v88, v8
  v_mul_f32 v89, v89, v9
  v_mul_f32 v90, v90, v10
  v_mul_f32 v91, v91, v11
  s_waitcnt lgkmcnt(2)
  v_mfma_f32_32x32x16_bf16 v[96:111], a[80:83], v[52:55], v[96:111]
  buffer_load_dwordx4 v[180:183], v14, s[20:23], s72 offen offset:2048
  v_cvt_pk_bf16_f32 v28, v88, v89
  v_cvt_pk_bf16_f32 v29, v90, v91
  v_mul_f32 v8, v76, v76
  v_mul_f32 v9, v77, v77
  v_mfma_f32_32x32x16_bf16 v[112:127], a[196:199], v[52:55], v[112:127]
  ds_read_b128 v[48:51], v3 offset:20480
  v_mul_f32 v10, v78, v78
  v_mul_f32 v11, v79, v79
  v_fma_f32 v8, v8, v41, v40
  v_fma_f32 v9, v9, v41, v40
  s_waitcnt lgkmcnt(2)
  v_mfma_f32_32x32x16_bf16 v[96:111], a[84:87], v[56:59], v[96:111]
  v_fma_f32 v10, v10, v41, v40
  v_fma_f32 v11, v11, v41, v40
  v_mul_f32 v8, v8, v76
  v_mul_f32 v9, v9, v77
  v_mfma_f32_32x32x16_bf16 v[112:127], a[200:203], v[56:59], v[112:127]
  ds_read_b128 v[52:55], v3 offset:21504
  v_mul_f32 v10, v10, v78
  v_mul_f32 v11, v11, v79
  v_exp_f32 v8, v8
  s_waitcnt lgkmcnt(2)
  v_mfma_f32_32x32x16_bf16 v[96:111], a[88:91], v[60:63], v[96:111]
  buffer_load_dwordx4 v[188:191], v14, s[20:23], s72 offen offset:3072
  v_exp_f32 v9, v9
  v_exp_f32 v10, v10
  v_mfma_f32_32x32x16_bf16 v[112:127], a[204:207], v[60:63], v[112:127]
  ds_read_b128 v[56:59], v3 offset:22528
  v_exp_f32 v11, v11
  v_mul_f32 v92, v92, v76
  v_mul_f32 v93, v93, v77
  s_waitcnt lgkmcnt(2)
  v_mfma_f32_32x32x16_bf16 v[96:111], a[92:95], v[48:51], v[96:111]
  v_mul_f32 v94, v94, v78
  v_mul_f32 v95, v95, v79
  v_fma_f32 v8, v8, v42, v42
  v_fma_f32 v9, v9, v42, v42
  v_mfma_f32_32x32x16_bf16 v[112:127], a[208:211], v[48:51], v[112:127]
  ds_read_b128 v[60:63], v3 offset:23552
  v_fma_f32 v10, v10, v42, v42
  v_fma_f32 v11, v11, v42, v42
  v_rcp_f32 v8, v8
  s_waitcnt lgkmcnt(2)
  v_mfma_f32_32x32x16_bf16 v[96:111], a[96:99], v[52:55], v[96:111]
  s_add_u32 s73, s68, 0x2000
  buffer_load_dwordx4 v[192:195], v14, s[20:23], s73 offen offset:0
  v_rcp_f32 v9, v9
  v_rcp_f32 v10, v10
  v_mfma_f32_32x32x16_bf16 v[112:127], a[212:215], v[52:55], v[112:127]
  s_waitcnt vmcnt(18)
  s_barrier
  ds_read_b128 v[48:51], v3 offset:24576
  v_rcp_f32 v11, v11
  v_mul_f32 v92, v92, v8
  v_mul_f32 v93, v93, v9
  s_waitcnt lgkmcnt(2)
  v_mfma_f32_32x32x16_bf16 v[96:111], a[100:103], v[56:59], v[96:111]
  v_mul_f32 v94, v94, v10
  v_mul_f32 v95, v95, v11
  v_cvt_pk_bf16_f32 v30, v92, v93
  v_cvt_pk_bf16_f32 v31, v94, v95
  v_mfma_f32_32x32x16_bf16 v[112:127], a[216:219], v[56:59], v[112:127]
  s_add_u32 s74, s80, 0x15000
  s_add_u32 m0, s93, 0x7000
  s_nop 0
  buffer_load_dwordx4 v1, s[20:23], s74 offen offset:0 sc1 lds
  ds_read_b128 v[52:55], v2 offset:27648
  s_waitcnt lgkmcnt(2)
  v_mfma_f32_32x32x16_bf16 v[96:111], a[104:107], v[60:63], v[96:111]
  buffer_load_dwordx4 v[200:203], v14, s[20:23], s73 offen offset:1024
  v_mfma_f32_32x32x16_bf16 v[112:127], a[220:223], v[60:63], v[112:127]
  buffer_load_dwordx4 v1, s[20:23], s74 offen offset:1024 sc1 lds
  ds_read_b128 v[56:59], v2 offset:33792
  s_waitcnt lgkmcnt(2)
  v_mfma_f32_32x32x16_bf16 v[96:111], a[108:111], v[48:51], v[96:111]
  v_mfma_f32_32x32x16_bf16 v[112:127], a[224:227], v[48:51], v[112:127]
  buffer_load_dwordx4 v1, s[20:23], s74 offen offset:2048 sc1 lds
  ds_read_b128 v[60:63], v2 offset:34816
  s_waitcnt lgkmcnt(2)
  v_mfma_f32_32x32x16_bf16 v[96:111], a[112:115], v[52:55], v[96:111]
  s_add_u32 s54, s78, 0x834000
  s_cmp_eq_u32 s44, 0
  s_cbranch_scc1 L_slow_130
  buffer_store_dwordx4 v[28:31], v1, s[20:23], s54 offen offset:1024 nt
L_join_131:
  v_mfma_f32_32x32x16_bf16 v[112:127], a[228:231], v[52:55], v[112:127]
  buffer_load_dwordx4 v1, s[20:23], s74 offen offset:3072 sc1 lds
  ds_read_b128 v[48:51], v2 offset:35840
  s_waitcnt lgkmcnt(2)
  v_mfma_f32_32x32x16_bf16 v[64:79], a[0:3], v[56:59], 0
  v_mfma_f32_32x32x16_bf16 v[80:95], a[116:119], v[56:59], 0
  ds_read_b128 v[52:55], v2 offset:36864
  s_waitcnt lgkmcnt(2)
  v_mfma_f32_32x32x16_bf16 v[64:79], a[4:7], v[60:63], v[64:79]
  buffer_load_dwordx4 v[208:211], v14, s[20:23], s73 offen offset:2048
  v_mfma_f32_32x32x16_bf16 v[80:95], a[120:123], v[60:63], v[80:95]
  ds_read_b128 v[56:59], v2 offset:37888
  s_waitcnt lgkmcnt(2)
  v_mfma_f32_32x32x16_bf16 v[64:79], a[8:11], v[48:51], v[64:79]
  ds_read_b128 v[44:47], v2 offset:28672
  s_waitcnt lgkmcnt(0)
  v_mul_f32 v8, v96, v96
  v_mul_f32 v9, v97, v97
  v_mul_f32 v10, v98, v98
  v_mfma_f32_32x32x16_bf16 v[80:95], a[124:127], v[48:51], v[80:95]
  ds_read_b128 v[60:63], v2 offset:38912
  v_mul_f32 v11, v99, v99
  v_fma_f32 v8, v8, v45, v44
  v_fma_f32 v9, v9, v45, v44
  v_mfma_f32_32x32x16_bf16 v[64:79], a[12:15], v[52:55], v[64:79]
  buffer_load_dwordx4 v[216:219], v14, s[20:23], s73 offen offset:3072
  v_fma_f32 v10, v10, v45, v44
  v_fma_f32 v11, v11, v45, v44
  v_mul_f32 v8, v8, v96
  v_mul_f32 v9, v9, v97
  v_mfma_f32_32x32x16_bf16 v[80:95], a[128:131], v[52:55], v[80:95]
  ds_read_b128 v[48:51], v2 offset:39936
  v_mul_f32 v10, v10, v98
  v_mul_f32 v11, v11, v99
  v_exp_f32 v8, v8
  v_mfma_f32_32x32x16_bf16 v[64:79], a[16:19], v[56:59], v[64:79]
  v_exp_f32 v9, v9
  v_exp_f32 v10, v10
  v_mfma_f32_32x32x16_bf16 v[80:95], a[132:135], v[56:59], v[80:95]
  ds_read_b128 v[52:55], v2 offset:40960
  v_exp_f32 v11, v11
  v_mul_f32 v112, v112, v96
  s_waitcnt lgkmcnt(2)
  v_mfma_f32_32x32x16_bf16 v[64:79], a[20:23], v[60:63], v[64:79]
  s_add_u32 s70, s83, 0x2000
  buffer_load_dwordx4 v[196:199], v14, s[20:23], s70 offen offset:0
  v_mul_f32 v113, v113, v97
  v_mul_f32 v114, v114, v98
  v_mul_f32 v115, v115, v99
  v_fma_f32 v8, v8, v46, v46
  v_mfma_f32_32x32x16_bf16 v[80:95], a[136:139], v[60:63], v[80:95]
  ds_read_b128 v[56:59], v2 offset:41984
  v_fma_f32 v9, v9, v46, v46
  v_fma_f32 v10, v10, v46, v46
  v_fma_f32 v11, v11, v46, v46
  s_waitcnt lgkmcnt(2)
  v_mfma_f32_32x32x16_bf16 v[64:79], a[24:27], v[48:51], v[64:79]
  v_rcp_f32 v8, v8
  v_rcp_f32 v9, v9
  v_mfma_f32_32x32x16_bf16 v[80:95], a[140:143], v[48:51], v[80:95]
  ds_read_b128 v[60:63], v2 offset:43008
  v_rcp_f32 v10, v10
  v_rcp_f32 v11, v11
  s_waitcnt lgkmcnt(2)
  v_mfma_f32_32x32x16_bf16 v[64:79], a[28:31], v[52:55], v[64:79]
  buffer_load_dwordx4 v[204:207], v14, s[20:23], s70 offen offset:1024
  v_mul_f32 v112, v112, v8
  v_mul_f32 v113, v113, v9
  v_mul_f32 v114, v114, v10
  v_mul_f32 v115, v115, v11
  v_mfma_f32_32x32x16_bf16 v[80:95], a[144:147], v[52:55], v[80:95]
  ds_read_b128 v[48:51], v2 offset:44032
  v_cvt_pk_bf16_f32 v32, v112, v113
  v_cvt_pk_bf16_f32 v33, v114, v115
  v_mul_f32 v8, v100, v100
  s_waitcnt lgkmcnt(2)
  v_mfma_f32_32x32x16_bf16 v[64:79], a[32:35], v[56:59], v[64:79]
  v_mul_f32 v9, v101, v101
  v_mul_f32 v10, v102, v102
  v_mul_f32 v11, v103, v103
  v_fma_f32 v8, v8, v45, v44
  v_mfma_f32_32x32x16_bf16 v[80:95], a[148:151], v[56:59], v[80:95]
  ds_read_b128 v[52:55], v2 offset:45056
  v_fma_f32 v9, v9, v45, v44
  v_fma_f32 v10, v10, v45, v44
  v_fma_f32 v11, v11, v45, v44
  s_waitcnt lgkmcnt(2)
  v_mfma_f32_32x32x16_bf16 v[64:79], a[36:39], v[60:63], v[64:79]
  buffer_load_dwordx4 v[212:215], v14, s[20:23], s70 offen offset:2048
  v_mul_f32 v8, v8, v100
  v_mul_f32 v9, v9, v101
  v_mul_f32 v10, v10, v102
  v_mul_f32 v11, v11, v103
  v_mfma_f32_32x32x16_bf16 v[80:95], a[152:155], v[60:63], v[80:95]
  ds_read_b128 v[56:59], v2 offset:46080
  v_exp_f32 v8, v8
  v_exp_f32 v9, v9
  s_waitcnt lgkmcnt(2)
  v_mfma_f32_32x32x16_bf16 v[64:79], a[40:43], v[48:51], v[64:79]
  v_exp_f32 v10, v10
  v_exp_f32 v11, v11
  v_mfma_f32_32x32x16_bf16 v[80:95], a[156:159], v[48:51], v[80:95]
  s_waitcnt vmcnt(17)
  s_barrier
  ds_read_b128 v[60:63], v2 offset:47104
  v_mul_f32 v116, v116, v100
  v_mul_f32 v117, v117, v101
  v_mul_f32 v118, v118, v102
  s_waitcnt lgkmcnt(2)
  v_mfma_f32_32x32x16_bf16 v[64:79], a[44:47], v[52:55], v[64:79]
  buffer_load_dwordx4 v[220:223], v14, s[20:23], s70 offen offset:3072
  v_mul_f32 v119, v119, v103
  v_fma_f32 v8, v8, v46, v46
  v_fma_f32 v9, v9, v46, v46
  v_fma_f32 v10, v10, v46, v46
  v_mfma_f32_32x32x16_bf16 v[80:95], a[160:163], v[52:55], v[80:95]
  s_add_u32 s75, s81, 0x18800
  s_add_u32 m0, s93, 0xa800
  s_nop 0
  buffer_load_dwordx4 v1, s[20:23], s75 offen offset:0 sc1 lds
  ds_read_b128 v[48:51], v2 offset:48128
  v_fma_f32 v11, v11, v46, v46
  v_rcp_f32 v8, v8
  s_waitcnt lgkmcnt(2)
  v_mfma_f32_32x32x16_bf16 v[64:79], a[48:51], v[56:59], v[64:79]
  v_rcp_f32 v9, v9
  v_rcp_f32 v10, v10
  v_mfma_f32_32x32x16_bf16 v[80:95], a[164:167], v[56:59], v[80:95]
  buffer_load_dwordx4 v1, s[20:23], s75 offen offset:1024 sc1 lds
  ds_read_b128 v[52:55], v2 offset:49152
  v_rcp_f32 v11, v11
  s_waitcnt lgkmcnt(2)
  v_mfma_f32_32x32x16_bf16 v[64:79], a[52:55], v[60:63], v[64:79]
  s_add_u32 s71, s68, 0x3000
  buffer_load_dwordx4 v[224:227], v14, s[20:23], s71 offen offset:0
  v_mul_f32 v116, v116, v8
  v_mul_f32 v117, v117, v9
  v_mul_f32 v118, v118, v10
  v_mul_f32 v119, v119, v11
  v_mfma_f32_32x32x16_bf16 v[80:95], a[168:171], v[60:63], v[80:95]
  buffer_load_dwordx4 v1, s[20:23], s75 offen offset:2048 sc1 lds
  ds_read_b128 v[56:59], v2 offset:50176
  v_cvt_pk_bf16_f32 v34, v116, v117
  v_cvt_pk_bf16_f32 v35, v118, v119
  s_waitcnt lgkmcnt(2)
  v_mfma_f32_32x32x16_bf16 v[64:79], a[56:59], v[48:51], v[64:79]
  v_mul_f32 v8, v104, v104
  v_mul_f32 v9, v105, v105
  v_mul_f32 v10, v106, v106
  v_mul_f32 v11, v107, v107
  v_mfma_f32_32x32x16_bf16 v[80:95], a[172:175], v[48:51], v[80:95]
  buffer_load_dwordx4 v1, s[20:23], s75 offen offset:3072 sc1 lds
  ds_read_b128 v[60:63], v2 offset:51200
  v_fma_f32 v8, v8, v45, v44
  v_fma_f32 v9, v9, v45, v44
  s_waitcnt lgkmcnt(2)
  v_mfma_f32_32x32x16_bf16 v[64:79], a[60:63], v[52:55], v[64:79]
  buffer_load_dwordx4 v[232:235], v14, s[20:23], s71 offen offset:1024
  v_fma_f32 v10, v10, v45, v44
  v_fma_f32 v11, v11, v45, v44
  v_mul_f32 v8, v8, v104
  v_mul_f32 v9, v9, v105
  v_mfma_f32_32x32x16_bf16 v[80:95], a[176:179], v[52:55], v[80:95]
  ds_read_b128 v[48:51], v2 offset:52224
  v_mul_f32 v10, v10, v106
  v_mul_f32 v11, v11, v107
  v_exp_f32 v8, v8
  s_waitcnt lgkmcnt(2)
  v_mfma_f32_32x32x16_bf16 v[64:79], a[64:67], v[56:59], v[64:79]
  v_exp_f32 v9, v9
  v_exp_f32 v10, v10
  v_mfma_f32_32x32x16_bf16 v[80:95], a[180:183], v[56:59], v[80:95]
  ds_read_b128 v[52:55], v2 offset:53248
  v_exp_f32 v11, v11
  v_mul_f32 v120, v120, v104
  s_waitcnt lgkmcnt(2)
  v_mfma_f32_32x32x16_bf16 v[64:79], a[68:71], v[60:63], v[64:79]
  s_add_u32 s55, s78, 0x7dc000
  s_cmp_eq_u32 s44, 0
  s_cbranch_scc1 L_slow_132
  buffer_store_dwordx4 v[32:35], v1, s[20:23], s55 offen offset:0 nt
L_join_133:
  v_mul_f32 v121, v121, v105
  v_mfma_f32_32x32x16_bf16 v[80:95], a[184:187], v[60:63], v[80:95]
  ds_read_b128 v[56:59], v2 offset:54272
  v_mul_f32 v122, v122, v106
  v_mul_f32 v123, v123, v107
  v_fma_f32 v8, v8, v46, v46
  s_waitcnt lgkmcnt(2)
  v_mfma_f32_32x32x16_bf16 v[64:79], a[72:75], v[48:51], v[64:79]
  buffer_load_dwordx4 v[240:243], v14, s[20:23], s71 offen offset:2048
  v_fma_f32 v9, v9, v46, v46
  v_fma_f32 v10, v10, v46, v46
  v_fma_f32 v11, v11, v46, v46
  v_rcp_f32 v8, v8
  v_mfma_f32_32x32x16_bf16 v[80:95], a[188:191], v[48:51], v[80:95]
  ds_read_b128 v[60:63], v2 offset:55296
  v_rcp_f32 v9, v9
  v_rcp_f32 v10, v10
  s_waitcnt lgkmcnt(2)
  v_mfma_f32_32x32x16_bf16 v[64:79], a[76:79], v[52:55], v[64:79]
  buffer_load_dwordx4 v[248:251], v14, s[20:23], s71 offen offset:3072
  v_rcp_f32 v11, v11
  v_mul_f32 v120, v120, v8
  v_mul_f32 v121, v121, v9
  v_mfma_f32_32x32x16_bf16 v[80:95], a[192:195], v[52:55], v[80:95]
  ds_read_b128 v[48:51], v2 offset:56320
  v_mul_f32 v122, v122, v10
  v_mul_f32 v123, v123, v11
  v_cvt_pk_bf16_f32 v36, v120, v121
  s_waitcnt lgkmcnt(2)
  v_mfma_f32_32x32x16_bf16 v[64:79], a[80:83], v[56:59], v[64:79]
  v_cvt_pk_bf16_f32 v37, v122, v123
  v_mul_f32 v8, v108, v108
  v_mul_f32 v9, v109, v109
  v_mul_f32 v10, v110, v110
  v_mfma_f32_32x32x16_bf16 v[80:95], a[196:199], v[56:59], v[80:95]
  ds_read_b128 v[52:55], v2 offset:57344
  v_mul_f32 v11, v111, v111
  v_fma_f32 v8, v8, v45, v44
  v_fma_f32 v9, v9, v45, v44
  s_waitcnt lgkmcnt(2)
  v_mfma_f32_32x32x16_bf16 v[64:79], a[84:87], v[60:63], v[64:79]
  s_add_u32 s72, s83, 0x3000
  buffer_load_dwordx4 v[228:231], v14, s[20:23], s72 offen offset:0
  v_fma_f32 v10, v10, v45, v44
  v_fma_f32 v11, v11, v45, v44
  v_mul_f32 v8, v8, v108
  v_mul_f32 v9, v9, v109
  v_mfma_f32_32x32x16_bf16 v[80:95], a[200:203], v[60:63], v[80:95]
  ds_read_b128 v[56:59], v2 offset:58368
  v_mul_f32 v10, v10, v110
  v_mul_f32 v11, v11, v111
  v_exp_f32 v8, v8
  s_waitcnt lgkmcnt(2)
  v_mfma_f32_32x32x16_bf16 v[64:79], a[88:91], v[48:51], v[64:79]
  v_exp_f32 v9, v9
  v_exp_f32 v10, v10
  v_mfma_f32_32x32x16_bf16 v[80:95], a[204:207], v[48:51], v[80:95]
  ds_read_b128 v[60:63], v2 offset:59392
  v_exp_f32 v11, v11
  v_mul_f32 v124, v124, v108
  s_waitcnt lgkmcnt(2)
  v_mfma_f32_32x32x16_bf16 v[64:79], a[92:95], v[52:55], v[64:79]
  buffer_load_dwordx4 v[236:239], v14, s[20:23], s72 offen offset:1024
  v_mul_f32 v125, v125, v109
  v_mul_f32 v126, v126, v110
  v_mul_f32 v127, v127, v111
  v_fma_f32 v8, v8, v46, v46
  v_mfma_f32_32x32x16_bf16 v[80:95], a[208:211], v[52:55], v[80:95]
  ds_read_b128 v[48:51], v2 offset:60416
  v_fma_f32 v9, v9, v46, v46
  v_fma_f32 v10, v10, v46, v46
  v_fma_f32 v11, v11, v46, v46
  s_waitcnt lgkmcnt(2)
  v_mfma_f32_32x32x16_bf16 v[64:79], a[96:99], v[56:59], v[64:79]
  v_rcp_f32 v8, v8
  v_rcp_f32 v9, v9
  v_mfma_f32_32x32x16_bf16 v[80:95], a[212:215], v[56:59], v[80:95]
  s_waitcnt vmcnt(17)
  s_barrier
  ds_read_b128 v[52:55], v2 offset:61440
  v_rcp_f32 v10, v10
  v_rcp_f32 v11, v11
  s_waitcnt lgkmcnt(2)
  v_mfma_f32_32x32x16_bf16 v[64:79], a[100:103], v[60:63], v[64:79]
  buffer_load_dwordx4 v[244:247], v14, s[20:23], s72 offen offset:2048
  v_mul_f32 v124, v124, v8
  v_mul_f32 v125, v125, v9
  v_mul_f32 v126, v126, v10
  v_mul_f32 v127, v127, v11
  v_mfma_f32_32x32x16_bf16 v[80:95], a[216:219], v[60:63], v[80:95]
  ds_read_b128 v[56:59], v2 offset:29696
  v_cvt_pk_bf16_f32 v38, v124, v125
  v_cvt_pk_bf16_f32 v39, v126, v127
  s_waitcnt lgkmcnt(2)
  v_mfma_f32_32x32x16_bf16 v[64:79], a[104:107], v[48:51], v[64:79]
  v_mfma_f32_32x32x16_bf16 v[80:95], a[220:223], v[48:51], v[80:95]
  ds_read_b128 v[60:63], v2 offset:62464
  s_waitcnt lgkmcnt(2)
  v_mfma_f32_32x32x16_bf16 v[64:79], a[108:111], v[52:55], v[64:79]
  buffer_load_dwordx4 v[252:255], v14, s[20:23], s72 offen offset:3072
  v_mfma_f32_32x32x16_bf16 v[80:95], a[224:227], v[52:55], v[80:95]
  ds_read_b128 v[48:51], v2 offset:63488
  s_waitcnt lgkmcnt(2)
  v_mfma_f32_32x32x16_bf16 v[64:79], a[112:115], v[56:59], v[64:79]
  s_add_u32 s48, s78, 0x7dc000
  s_cmp_eq_u32 s44, 0
  s_cbranch_scc1 L_slow_134
  buffer_store_dwordx4 v[36:39], v1, s[20:23], s48 offen offset:1024 nt
L_join_135:
  v_mfma_f32_32x32x16_bf16 v[80:95], a[228:231], v[56:59], v[80:95]
  ds_read_b128 v[52:55], v2 offset:64512
  s_waitcnt lgkmcnt(2)
  v_mfma_f32_32x32x16_bf16 v[96:111], a[0:3], v[60:63], 0
  v_mfma_f32_32x32x16_bf16 v[112:127], a[116:119], v[60:63], 0
  ds_read_b128 v[56:59], v3 offset:0
  s_waitcnt lgkmcnt(2)
  v_mfma_f32_32x32x16_bf16 v[96:111], a[4:7], v[48:51], v[96:111]
  s_add_u32 s86, s68, 0x4000
  buffer_load_dwordx4 a[0:3], v14, s[20:23], s86 offen offset:3072
  v_mfma_f32_32x32x16_bf16 v[112:127], a[120:123], v[48:51], v[112:127]
  ds_read_b128 v[60:63], v3 offset:1024
  s_waitcnt lgkmcnt(2)
  v_mfma_f32_32x32x16_bf16 v[96:111], a[8:11], v[52:55], v[96:111]
  s_add_u32 s87, s83, 0x4000
  buffer_load_dwordx4 a[4:7], v14, s[20:23], s87 offen offset:3072
  ds_read_b128 v[40:43], v2 offset:30720
  s_waitcnt lgkmcnt(0)
  v_mul_f32 v8, v64, v64
  v_mul_f32 v9, v65, v65
  v_mul_f32 v10, v66, v66
  v_mfma_f32_32x32x16_bf16 v[112:127], a[124:127], v[52:55], v[112:127]
  ds_read_b128 v[48:51], v3 offset:2048
  v_mul_f32 v11, v67, v67
  v_fma_f32 v8, v8, v41, v40
  v_fma_f32 v9, v9, v41, v40
  v_mfma_f32_32x32x16_bf16 v[96:111], a[12:15], v[56:59], v[96:111]
  s_add_u32 s84, s68, 0x5000
  buffer_load_dwordx4 a[8:11], v14, s[20:23], s84 offen offset:0
  v_fma_f32 v10, v10, v41, v40
  v_fma_f32 v11, v11, v41, v40
  v_mul_f32 v8, v8, v64
  v_mul_f32 v9, v9, v65
  v_mfma_f32_32x32x16_bf16 v[112:127], a[128:131], v[56:59], v[112:127]
  ds_read_b128 v[52:55], v3 offset:3072
  v_mul_f32 v10, v10, v66
  v_mul_f32 v11, v11, v67
  v_exp_f32 v8, v8
  v_mfma_f32_32x32x16_bf16 v[96:111], a[16:19], v[60:63], v[96:111]
  s_add_u32 s85, s83, 0x5000
  buffer_load_dwordx4 a[12:15], v14, s[20:23], s85 offen offset:0
  v_exp_f32 v9, v9
  v_exp_f32 v10, v10
  v_mfma_f32_32x32x16_bf16 v[112:127], a[132:135], v[60:63], v[112:127]
  ds_read_b128 v[56:59], v3 offset:4096
  v_exp_f32 v11, v11
  v_mul_f32 v80, v80, v64
  s_waitcnt lgkmcnt(2)
  v_mfma_f32_32x32x16_bf16 v[96:111], a[20:23], v[48:51], v[96:111]
  s_add_u32 s86, s68, 0x5000
  buffer_load_dwordx4 a[16:19], v14, s[20:23], s86 offen offset:1024
  v_mul_f32 v81, v81, v65
  v_mul_f32 v82, v82, v66
  v_mul_f32 v83, v83, v67
  v_fma_f32 v8, v8, v42, v42
  v_mfma_f32_32x32x16_bf16 v[112:127], a[136:139], v[48:51], v[112:127]
  ds_read_b128 v[60:63], v3 offset:5120
  v_fma_f32 v9, v9, v42, v42
  v_fma_f32 v10, v10, v42, v42
  v_fma_f32 v11, v11, v42, v42
  s_waitcnt lgkmcnt(2)
  v_mfma_f32_32x32x16_bf16 v[96:111], a[24:27], v[52:55], v[96:111]
  s_add_u32 s87, s83, 0x5000
  buffer_load_dwordx4 a[20:23], v14, s[20:23], s87 offen offset:1024
  v_rcp_f32 v8, v8
  v_rcp_f32 v9, v9
  v_mfma_f32_32x32x16_bf16 v[112:127], a[140:143], v[52:55], v[112:127]
  ds_read_b128 v[48:51], v3 offset:6144
  v_rcp_f32 v10, v10
  v_rcp_f32 v11, v11
  s_waitcnt lgkmcnt(2)
  v_mfma_f32_32x32x16_bf16 v[96:111], a[28:31], v[56:59], v[96:111]
  s_add_u32 s84, s68, 0x5000
  buffer_load_dwordx4 a[24:27], v14, s[20:23], s84 offen offset:2048
  v_mul_f32 v80, v80, v8
  v_mul_f32 v81, v81, v9
  v_mul_f32 v82, v82, v10
  v_mul_f32 v83, v83, v11
  v_mfma_f32_32x32x16_bf16 v[112:127], a[144:147], v[56:59], v[112:127]
  ds_read_b128 v[52:55], v3 offset:7168
  v_cvt_pk_bf16_f32 v24, v80, v81
  v_cvt_pk_bf16_f32 v25, v82, v83
  v_mul_f32 v8, v68, v68
  s_waitcnt lgkmcnt(2)
  v_mfma_f32_32x32x16_bf16 v[96:111], a[32:35], v[60:63], v[96:111]
  s_add_u32 s85, s83, 0x5000
  buffer_load_dwordx4 a[28:31], v14, s[20:23], s85 offen offset:2048
  v_mul_f32 v9, v69, v69
  v_mul_f32 v10, v70, v70
  v_mul_f32 v11, v71, v71
  v_fma_f32 v8, v8, v41, v40
  v_mfma_f32_32x32x16_bf16 v[112:127], a[148:151], v[60:63], v[112:127]
  ds_read_b128 v[56:59], v3 offset:8192
  v_fma_f32 v9, v9, v41, v40
  v_fma_f32 v10, v10, v41, v40
  v_fma_f32 v11, v11, v41, v40
  s_waitcnt lgkmcnt(2)
  v_mfma_f32_32x32x16_bf16 v[96:111], a[36:39], v[48:51], v[96:111]
  s_add_u32 s86, s68, 0x5000
  buffer_load_dwordx4 a[32:35], v14, s[20:23], s86 offen offset:3072
  v_mul_f32 v8, v8, v68
  v_mul_f32 v9, v9, v69
  v_mul_f32 v10, v10, v70
  v_mul_f32 v11, v11, v71
  v_mfma_f32_32x32x16_bf16 v[112:127], a[152:155], v[48:51], v[112:127]
  ds_read_b128 v[60:63], v3 offset:9216
  v_exp_f32 v8, v8
  v_exp_f32 v9, v9
  s_waitcnt lgkmcnt(2)
  v_mfma_f32_32x32x16_bf16 v[96:111], a[40:43], v[52:55], v[96:111]
  s_add_u32 s87, s83, 0x5000
  buffer_load_dwordx4 a[36:39], v14, s[20:23], s87 offen offset:3072
  v_exp_f32 v10, v10
  v_exp_f32 v11, v11
  v_mfma_f32_32x32x16_bf16 v[112:127], a[156:159], v[52:55], v[112:127]
  s_waitcnt vmcnt(10)
  s_barrier
  s_cmp_lg_u32 s42, 0
  s_cbranch_scc1 L_pubskip_136
  s_lshl_b32 s56, s40, 7
  s_lshl_b32 s57, s41, 2
  s_add_u32 s56, s56, s57
  s_add_u32 s56, s56, 0x5800
  s_mov_b64 exec, 1
  v_mov_b32 v13, s43
  s_cmp_eq_u32 s44, 0
  s_cbranch_scc1 L_slow_137
  buffer_store_dword v13, v7, s[20:23], s56 offen
L_join_138:
  s_mov_b64 exec, -1
  s_nop 0
L_pubskip_136:
  ds_read_b128 v[48:51], v3 offset:10240
  v_mul_f32 v84, v84, v68
  v_mul_f32 v85, v85, v69
  v_mul_f32 v86, v86, v70
  s_waitcnt lgkmcnt(2)
  v_mfma_f32_32x32x16_bf16 v[96:111], a[44:47], v[56:59], v[96:111]
  s_add_u32 s84, s68, 0x6000
  buffer_load_dwordx4 a[40:43], v14, s[20:23], s84 offen offset:0
  v_mul_f32 v87, v87, v71
  v_fma_f32 v8, v8, v42, v42
  v_fma_f32 v9, v9, v42, v42
  v_fma_f32 v10, v10, v42, v42
  v_mfma_f32_32x32x16_bf16 v[112:127], a[160:163], v[56:59], v[112:127]
  ds_read_b128 v[52:55], v3 offset:11264
  v_fma_f32 v11, v11, v42, v42
  v_rcp_f32 v8, v8
  s_waitcnt lgkmcnt(2)
  v_mfma_f32_32x32x16_bf16 v[96:111], a[48:51], v[60:63], v[96:111]
  s_add_u32 s85, s83, 0x6000
  buffer_load_dwordx4 a[44:47], v14, s[20:23], s85 offen offset:0
  v_rcp_f32 v9, v9
  v_rcp_f32 v10, v10
  v_mfma_f32_32x32x16_bf16 v[112:127], a[164:167], v[60:63], v[112:127]
  ds_read_b128 v[56:59], v3 offset:12288
  v_rcp_f32 v11, v11
  v_mul_f32 v84, v84, v8
  s_waitcnt lgkmcnt(2)
  v_mfma_f32_32x32x16_bf16 v[96:111], a[52:55], v[48:51], v[96:111]
  s_add_u32 s86, s68, 0x6000
  buffer_load_dwordx4 a[48:51], v14, s[20:23], s86 offen offset:1024
  v_mul_f32 v85, v85, v9
  v_mul_f32 v86, v86, v10
  v_mul_f32 v87, v87, v11
  v_cvt_pk_bf16_f32 v26, v84, v85
  v_mfma_f32_32x32x16_bf16 v[112:127], a[168:171], v[48:51], v[112:127]
  ds_read_b128 v[60:63], v3 offset:13312
  v_cvt_pk_bf16_f32 v27, v86, v87
  v_mul_f32 v8, v72, v72
  v_mul_f32 v9, v73, v73
  s_waitcnt lgkmcnt(2)
  v_mfma_f32_32x32x16_bf16 v[96:111], a[56:59], v[52:55], v[96:111]
  s_add_u32 s87, s83, 0x6000
  buffer_load_dwordx4 a[52:55], v14, s[20:23], s87 offen offset:1024
  v_mul_f32 v10, v74, v74
  v_mul_f32 v11, v75, v75
  v_fma_f32 v8, v8, v41, v40
  v_fma_f32 v9, v9, v41, v40
  v_mfma_f32_32x32x16_bf16 v[112:127], a[172:175], v[52:55], v[112:127]
  ds_read_b128 v[48:51], v3 offset:14336
  v_fma_f32 v10, v10, v41, v40
  v_fma_f32 v11, v11, v41, v40
  v_mul_f32 v8, v8, v72
  s_waitcnt lgkmcnt(2)
  v_mfma_f32_32x32x16_bf16 v[96:111], a[60:63], v[56:59], v[96:111]
  s_add_u32 s84, s68, 0x6000
  buffer_load_dwordx4 a[56:59], v14, s[20:23], s84 offen offset:2048
  v_mul_f32 v9, v9, v73
  v_mul_f32 v10, v10, v74
  v_mul_f32 v11, v11, v75
  v_exp_f32 v8, v8
  v_mfma_f32_32x32x16_bf16 v[112:127], a[176:179], v[56:59], v[112:127]
  ds_read_b128 v[52:55], v3 offset:15360
  v_exp_f32 v9, v9
  v_exp_f32 v10, v10
  s_waitcnt lgkmcnt(2)
  v_mfma_f32_32x32x16_bf16 v[96:111], a[64:67], v[60:63], v[96:111]
  s_add_u32 s85, s83, 0x6000
  buffer_load_dwordx4 a[60:63], v14, s[20:23], s85 offen offset:2048
  v_exp_f32 v11, v11
  v_mul_f32 v88, v88, v72
  v_mul_f32 v89, v89, v73
  v_mfma_f32_32x32x16_bf16 v[112:127], a[180:183], v[60:63], v[112:127]
  ds_read_b128 v[56:59], v3 offset:16384
  v_mul_f32 v90, v90, v74
  v_mul_f32 v91, v91, v75
  v_fma_f32 v8, v8, v42, v42
  s_waitcnt lgkmcnt(2)
  v_mfma_f32_32x32x16_bf16 v[96:111], a[68:71], v[48:51], v[96:111]
  s_add_u32 s49, s78, 0x7fc000
  s_cmp_eq_u32 s44, 0
  s_cbranch_scc1 L_slow_139
  buffer_store_dwordx4 v[24:27], v1, s[20:23], s49 offen offset:0 nt
L_join_140:
  v_fma_f32 v9, v9, v42, v42
  v_mfma_f32_32x32x16_bf16 v[112:127], a[184:187], v[48:51], v[112:127]
  ds_read_b128 v[60:63], v3 offset:17408
  v_fma_f32 v10, v10, v42, v42
  v_fma_f32 v11, v11, v42, v42
  v_rcp_f32 v8, v8
  s_waitcnt lgkmcnt(2)
  v_mfma_f32_32x32x16_bf16 v[96:111], a[72:75], v[52:55], v[96:111]
  s_lshl_b32 s50, s40, 7
  s_add_u32 s50, s50, 0x5800
  s_mov_b64 exec, 0x3fff
  buffer_load_dword v12, v7, s[20:23], s50 offen sc1
  s_mov_b64 exec, -1
  v_rcp_f32 v9, v9
  v_mfma_f32_32x32x16_bf16 v[112:127], a[188:191], v[52:55], v[112:127]
  ds_read_b128 v[48:51], v3 offset:18432
  v_rcp_f32 v10, v10
  v_rcp_f32 v11, v11
  s_waitcnt lgkmcnt(2)
  v_mfma_f32_32x32x16_bf16 v[96:111], a[76:79], v[56:59], v[96:111]
  s_add_u32 s86, s68, 0x6000
  buffer_load_dwordx4 a[64:67], v14, s[20:23], s86 offen offset:3072
  v_mul_f32 v88, v88, v8
  v_mul_f32 v89, v89, v9
  v_mul_f32 v90, v90, v10
  v_mul_f32 v91, v91, v11
  v_mfma_f32_32x32x16_bf16 v[112:127], a[192:195], v[56:59], v[112:127]
  ds_read_b128 v[52:55], v3 offset:19456
  v_cvt_pk_bf16_f32 v28, v88, v89
  v_cvt_pk_bf16_f32 v29, v90, v91
  v_mul_f32 v8, v76, v76
  s_waitcnt lgkmcnt(2)
  v_mfma_f32_32x32x16_bf16 v[96:111], a[80:83], v[60:63], v[96:111]
  s_add_u32 s87, s83, 0x6000
  buffer_load_dwordx4 a[68:71], v14, s[20:23], s87 offen offset:3072
  v_mul_f32 v9, v77, v77
  v_mul_f32 v10, v78, v78
  v_mul_f32 v11, v79, v79
  v_fma_f32 v8, v8, v41, v40
  v_mfma_f32_32x32x16_bf16 v[112:127], a[196:199], v[60:63], v[112:127]
  ds_read_b128 v[56:59], v3 offset:20480
  v_fma_f32 v9, v9, v41, v40
  v_fma_f32 v10, v10, v41, v40
  v_fma_f32 v11, v11, v41, v40
  s_waitcnt lgkmcnt(2)
  v_mfma_f32_32x32x16_bf16 v[96:111], a[84:87], v[48:51], v[96:111]
  v_mul_f32 v8, v8, v76
  v_mul_f32 v9, v9, v77
  v_mul_f32 v10, v10, v78
  v_mul_f32 v11, v11, v79
  v_mfma_f32_32x32x16_bf16 v[112:127], a[200:203], v[48:51], v[112:127]
  ds_read_b128 v[60:63], v3 offset:21504
  v_exp_f32 v8, v8
  v_exp_f32 v9, v9
  s_waitcnt lgkmcnt(2)
  v_mfma_f32_32x32x16_bf16 v[96:111], a[88:91], v[52:55], v[96:111]
  v_exp_f32 v10, v10
  v_exp_f32 v11, v11
  v_mfma_f32_32x32x16_bf16 v[112:127], a[204:207], v[52:55], v[112:127]
  ds_read_b128 v[48:51], v3 offset:22528
  v_mul_f32 v92, v92, v76
  v_mul_f32 v93, v93, v77
  v_mul_f32 v94, v94, v78
  s_waitcnt lgkmcnt(2)
  v_mfma_f32_32x32x16_bf16 v[96:111], a[92:95], v[56:59], v[96:111]
  v_mul_f32 v95, v95, v79
  v_fma_f32 v8, v8, v42, v42
  v_fma_f32 v9, v9, v42, v42
  v_fma_f32 v10, v10, v42, v42
  v_mfma_f32_32x32x16_bf16 v[112:127], a[208:211], v[56:59], v[112:127]
  ds_read_b128 v[52:55], v3 offset:23552
  v_fma_f32 v11, v11, v42, v42
  v_rcp_f32 v8, v8
  s_waitcnt lgkmcnt(2)
  v_mfma_f32_32x32x16_bf16 v[96:111], a[96:99], v[60:63], v[96:111]
  v_rcp_f32 v9, v9
  v_rcp_f32 v10, v10
  v_mfma_f32_32x32x16_bf16 v[112:127], a[212:215], v[60:63], v[112:127]
  ds_read_b128 v[56:59], v3 offset:24576
  v_rcp_f32 v11, v11
  v_mul_f32 v92, v92, v8
  s_waitcnt lgkmcnt(2)
  v_mfma_f32_32x32x16_bf16 v[96:111], a[100:103], v[48:51], v[96:111]
  v_mul_f32 v93, v93, v9
  v_mul_f32 v94, v94, v10
  v_mul_f32 v95, v95, v11
  v_cvt_pk_bf16_f32 v30, v92, v93
  v_mfma_f32_32x32x16_bf16 v[112:127], a[216:219], v[48:51], v[112:127]
  ds_read_b128 v[60:63], v2 offset:31744
  v_cvt_pk_bf16_f32 v31, v94, v95
  s_waitcnt vmcnt(2)
  v_cmp_ne_u32 vcc, s43, v12
  s_nop 1
  s_and_b32 s56, vcc_lo, 0x3fff
  s_cbranch_scc1 L_fsp_143
L_fok_142:
  s_waitcnt lgkmcnt(2)
  v_mfma_f32_32x32x16_bf16 v[96:111], a[104:107], v[52:55], v[96:111]
  buffer_load_dwordx4 a[136:139], v1, s[20:23], s79 offen offset:0 sc1
  v_mfma_f32_32x32x16_bf16 v[112:127], a[220:223], v[52:55], v[112:127]
  buffer_load_dwordx4 a[140:143], v1, s[20:23], s79 offen offset:1024 sc1
  s_waitcnt lgkmcnt(1)
  v_mfma_f32_32x32x16_bf16 v[96:111], a[108:111], v[56:59], v[96:111]
  buffer_load_dwordx4 a[144:147], v1, s[20:23], s79 offen offset:2048 sc1
  v_mfma_f32_32x32x16_bf16 v[112:127], a[224:227], v[56:59], v[112:127]
  buffer_load_dwordx4 a[148:151], v1, s[20:23], s79 offen offset:3072 sc1
  s_waitcnt lgkmcnt(0)
  v_mfma_f32_32x32x16_bf16 v[96:111], a[112:115], v[60:63], v[96:111]
  s_add_u32 s51, s78, 0x7fc000
  s_cmp_eq_u32 s44, 0
  s_cbranch_scc1 L_slow_145
  buffer_store_dwordx4 v[28:31], v1, s[20:23], s51 offen offset:1024 nt
L_join_146:
  v_mfma_f32_32x32x16_bf16 v[112:127], a[228:231], v[60:63], v[112:127]
  s_add_u32 s76, s79, 0x1000
  buffer_load_dwordx4 a[152:155], v1, s[20:23], s76 offen offset:0 sc1
  ds_read_b128 v[44:47], v2 offset:32768
  buffer_load_dwordx4 a[156:159], v1, s[20:23], s76 offen offset:1024 sc1
  s_waitcnt lgkmcnt(0)
  s_nop 1
  v_pk_mul_f32 v[48:49], v[96:97], v[96:97]
  v_pk_mul_f32 v[50:51], v[98:99], v[98:99]
  v_pk_mul_f32 v[52:53], v[100:101], v[100:101]
  v_pk_mul_f32 v[54:55], v[102:103], v[102:103]
  v_pk_fma_f32 v[48:49], v[48:49], v[44:45], v[44:45] op_sel:[0,1,0] op_sel_hi:[1,1,0]
  v_pk_fma_f32 v[50:51], v[50:51], v[44:45], v[44:45] op_sel:[0,1,0] op_sel_hi:[1,1,0]
  v_pk_fma_f32 v[52:53], v[52:53], v[44:45], v[44:45] op_sel:[0,1,0] op_sel_hi:[1,1,0]
  v_pk_fma_f32 v[54:55], v[54:55], v[44:45], v[44:45] op_sel:[0,1,0] op_sel_hi:[1,1,0]
  buffer_load_dwordx4 a[160:163], v1, s[20:23], s76 offen offset:2048 sc1
  v_pk_mul_f32 v[48:49], v[48:49], v[96:97]
  v_pk_mul_f32 v[50:51], v[50:51], v[98:99]
  v_pk_mul_f32 v[52:53], v[52:53], v[100:101]
  v_pk_mul_f32 v[54:55], v[54:55], v[102:103]
  v_exp_f32 v48, v48
  v_exp_f32 v49, v49
  buffer_load_dwordx4 a[164:167], v1, s[20:23], s76 offen offset:3072 sc1
  v_exp_f32 v50, v50
  v_exp_f32 v51, v51
  v_exp_f32 v52, v52
  v_exp_f32 v53, v53
  s_add_u32 s77, s79, 0x2000
  buffer_load_dwordx4 a[168:171], v1, s[20:23], s77 offen offset:0 sc1
  v_exp_f32 v54, v54
  v_exp_f32 v55, v55
  v_pk_mul_f32 v[112:113], v[112:113], v[96:97]
  v_pk_mul_f32 v[114:115], v[114:115], v[98:99]
  v_pk_mul_f32 v[116:117], v[116:117], v[100:101]
  v_pk_mul_f32 v[118:119], v[118:119], v[102:103]
  buffer_load_dwordx4 a[172:175], v1, s[20:23], s77 offen offset:1024 sc1
  v_pk_fma_f32 v[48:49], v[48:49], v[46:47], v[46:47] op_sel:[0,0,0] op_sel_hi:[1,0,0]
  v_pk_fma_f32 v[50:51], v[50:51], v[46:47], v[46:47] op_sel:[0,0,0] op_sel_hi:[1,0,0]
  v_pk_fma_f32 v[52:53], v[52:53], v[46:47], v[46:47] op_sel:[0,0,0] op_sel_hi:[1,0,0]
  v_pk_fma_f32 v[54:55], v[54:55], v[46:47], v[46:47] op_sel:[0,0,0] op_sel_hi:[1,0,0]
  v_rcp_f32 v48, v48
  v_rcp_f32 v49, v49
  buffer_load_dwordx4 a[176:179], v1, s[20:23], s77 offen offset:2048 sc1
  v_rcp_f32 v50, v50
  v_rcp_f32 v51, v51
  v_rcp_f32 v52, v52
  v_rcp_f32 v53, v53
  buffer_load_dwordx4 a[180:183], v1, s[20:23], s77 offen offset:3072 sc1
  v_rcp_f32 v54, v54
  v_rcp_f32 v55, v55
  v_pk_mul_f32 v[112:113], v[112:113], v[48:49]
  v_pk_mul_f32 v[114:115], v[114:115], v[50:51]
  v_pk_mul_f32 v[116:117], v[116:117], v[52:53]
  v_pk_mul_f32 v[118:119], v[118:119], v[54:55]
  v_cvt_pk_bf16_f32 v32, v112, v113
  v_cvt_pk_bf16_f32 v33, v114, v115
  v_cvt_pk_bf16_f32 v34, v116, v117
  v_cvt_pk_bf16_f32 v35, v118, v119
  s_add_u32 s52, s78, 0x818000
  s_cmp_eq_u32 s44, 0
  s_cbranch_scc1 L_slow_147
  buffer_store_dwordx4 v[32:35], v1, s[20:23], s52 offen offset:0 nt
L_join_148:
  v_pk_mul_f32 v[48:49], v[104:105], v[104:105]
  v_pk_mul_f32 v[50:51], v[106:107], v[106:107]
  v_pk_mul_f32 v[52:53], v[108:109], v[108:109]
  v_pk_mul_f32 v[54:55], v[110:111], v[110:111]
  v_pk_fma_f32 v[48:49], v[48:49], v[44:45], v[44:45] op_sel:[0,1,0] op_sel_hi:[1,1,0]
  v_pk_fma_f32 v[50:51], v[50:51], v[44:45], v[44:45] op_sel:[0,1,0] op_sel_hi:[1,1,0]
  v_pk_fma_f32 v[52:53], v[52:53], v[44:45], v[44:45] op_sel:[0,1,0] op_sel_hi:[1,1,0]
  v_pk_fma_f32 v[54:55], v[54:55], v[44:45], v[44:45] op_sel:[0,1,0] op_sel_hi:[1,1,0]
  v_pk_mul_f32 v[48:49], v[48:49], v[104:105]
  v_pk_mul_f32 v[50:51], v[50:51], v[106:107]
  v_pk_mul_f32 v[52:53], v[52:53], v[108:109]
  v_pk_mul_f32 v[54:55], v[54:55], v[110:111]
  v_exp_f32 v48, v48
  v_exp_f32 v49, v49
  v_exp_f32 v50, v50
  v_exp_f32 v51, v51
  v_exp_f32 v52, v52
  v_exp_f32 v53, v53
  v_exp_f32 v54, v54
  v_exp_f32 v55, v55
  v_pk_mul_f32 v[120:121], v[120:121], v[104:105]
  v_pk_mul_f32 v[122:123], v[122:123], v[106:107]
  v_pk_mul_f32 v[124:125], v[124:125], v[108:109]
  v_pk_mul_f32 v[126:127], v[126:127], v[110:111]
  v_pk_fma_f32 v[48:49], v[48:49], v[46:47], v[46:47] op_sel:[0,0,0] op_sel_hi:[1,0,0]
  v_pk_fma_f32 v[50:51], v[50:51], v[46:47], v[46:47] op_sel:[0,0,0] op_sel_hi:[1,0,0]
  v_pk_fma_f32 v[52:53], v[52:53], v[46:47], v[46:47] op_sel:[0,0,0] op_sel_hi:[1,0,0]
  v_pk_fma_f32 v[54:55], v[54:55], v[46:47], v[46:47] op_sel:[0,0,0] op_sel_hi:[1,0,0]
  v_rcp_f32 v48, v48
  v_rcp_f32 v49, v49
  v_rcp_f32 v50, v50
  v_rcp_f32 v51, v51
  v_rcp_f32 v52, v52
  v_rcp_f32 v53, v53
  v_rcp_f32 v54, v54
  v_rcp_f32 v55, v55
  v_pk_mul_f32 v[120:121], v[120:121], v[48:49]
  v_pk_mul_f32 v[122:123], v[122:123], v[50:51]
  v_pk_mul_f32 v[124:125], v[124:125], v[52:53]
  v_pk_mul_f32 v[126:127], v[126:127], v[54:55]
  v_cvt_pk_bf16_f32 v36, v120, v121
  v_cvt_pk_bf16_f32 v37, v122, v123
  v_cvt_pk_bf16_f32 v38, v124, v125
  v_cvt_pk_bf16_f32 v39, v126, v127
  s_add_u32 s53, s78, 0x818000
  s_cmp_eq_u32 s44, 0
  s_cbranch_scc1 L_slow_149
  buffer_store_dwordx4 v[36:39], v1, s[20:23], s53 offen offset:1024 nt
L_join_150:
  s_waitcnt vmcnt(14)
  v_mfma_f32_32x32x16_bf16 v[64:79], v[128:131], a[136:139], 0
  s_add_u32 s74, s79, 0x3000
  buffer_load_dwordx4 a[184:187], v1, s[20:23], s74 offen offset:0 sc1
  s_xor_b32 s56, s42, 1
  s_mul_i32 s56, s56, 6144
  s_add_u32 s56, s56, 0x18400
  v_add_u32 v10, s56, v1
  v_mfma_f32_32x32x16_bf16 v[80:95], v[132:135], a[136:139], 0
  s_xor_b32 s56, s42, 2
  s_mul_i32 s56, s56, 6144
  s_add_u32 s56, s56, 0x18c00
  v_add_u32 v11, s56, v1
  s_waitcnt vmcnt(14)
  v_mfma_f32_32x32x16_bf16 v[64:79], v[136:139], a[140:143], v[64:79]
  buffer_load_dwordx4 a[188:191], v1, s[20:23], s74 offen offset:1024 sc1
  s_xor_b32 s56, s42, 3
  s_mul_i32 s56, s56, 6144
  s_add_u32 s56, s56, 0x19400
  v_add_u32 v12, s56, v1
  v_mfma_f32_32x32x16_bf16 v[80:95], v[140:143], a[140:143], v[80:95]
  s_mul_i32 s56, s42, 6144
  s_add_u32 s56, s56, 0x18400
  v_add_u32 v13, s56, v1
  s_waitcnt vmcnt(14)
  v_mfma_f32_32x32x16_bf16 v[64:79], v[144:147], a[144:147], v[64:79]
  buffer_load_dwordx4 a[192:195], v1, s[20:23], s74 offen offset:2048 sc1
  v_mfma_f32_32x32x16_bf16 v[80:95], v[148:151], a[144:147], v[80:95]
  s_waitcnt vmcnt(14)
  v_mfma_f32_32x32x16_bf16 v[64:79], v[152:155], a[148:151], v[64:79]
  buffer_load_dwordx4 a[196:199], v1, s[20:23], s74 offen offset:3072 sc1
  v_mfma_f32_32x32x16_bf16 v[80:95], v[156:159], a[148:151], v[80:95]
  s_waitcnt vmcnt(13)
  v_mfma_f32_32x32x16_bf16 v[64:79], v[160:163], a[152:155], v[64:79]
  s_add_u32 s75, s79, 0x4000
  buffer_load_dwordx4 a[136:139], v1, s[20:23], s75 offen offset:0 sc1
  v_mfma_f32_32x32x16_bf16 v[80:95], v[164:167], a[152:155], v[80:95]
  s_waitcnt vmcnt(13)
  v_mfma_f32_32x32x16_bf16 v[64:79], v[168:171], a[156:159], v[64:79]
  buffer_load_dwordx4 a[140:143], v1, s[20:23], s75 offen offset:1024 sc1
  v_mfma_f32_32x32x16_bf16 v[80:95], v[172:175], a[156:159], v[80:95]
  s_waitcnt vmcnt(6)
  s_barrier
  s_cmp_lg_u32 s42, 0
  s_cbranch_scc1 L_pubskip_151
  s_lshl_b32 s56, s40, 7
  s_lshl_b32 s57, s41, 2
  s_add_u32 s56, s56, s57
  s_add_u32 s56, s56, 0x6000
  s_mov_b64 exec, 1
  v_mov_b32 v57, s43
  s_cmp_eq_u32 s44, 0
  s_cbranch_scc1 L_slow_152
  buffer_store_dword v57, v7, s[20:23], s56 offen
L_join_153:
  s_mov_b64 exec, -1
  s_nop 0
L_pubskip_151:
  v_mfma_f32_32x32x16_bf16 v[64:79], v[176:179], a[160:163], v[64:79]
  buffer_load_dwordx4 a[144:147], v1, s[20:23], s75 offen offset:2048 sc1
  v_mfma_f32_32x32x16_bf16 v[80:95], v[180:183], a[160:163], v[80:95]
  v_mfma_f32_32x32x16_bf16 v[64:79], v[184:187], a[164:167], v[64:79]
  buffer_load_dwordx4 a[148:151], v1, s[20:23], s75 offen offset:3072 sc1
  v_mfma_f32_32x32x16_bf16 v[80:95], v[188:191], a[164:167], v[80:95]
  v_mfma_f32_32x32x16_bf16 v[64:79], v[192:195], a[168:171], v[64:79]
  s_add_u32 s76, s79, 0x5000
  buffer_load_dwordx4 a[152:155], v1, s[20:23], s76 offen offset:0 sc1
  v_mfma_f32_32x32x16_bf16 v[80:95], v[196:199], a[168:171], v[80:95]
  v_mfma_f32_32x32x16_bf16 v[64:79], v[200:203], a[172:175], v[64:79]
  buffer_load_dwordx4 a[156:159], v1, s[20:23], s76 offen offset:1024 sc1
  v_mfma_f32_32x32x16_bf16 v[80:95], v[204:207], a[172:175], v[80:95]
  v_mfma_f32_32x32x16_bf16 v[64:79], v[208:211], a[176:179], v[64:79]
  buffer_load_dwordx4 a[160:163], v1, s[20:23], s76 offen offset:2048 sc1
  v_mfma_f32_32x32x16_bf16 v[80:95], v[212:215], a[176:179], v[80:95]
  v_mfma_f32_32x32x16_bf16 v[64:79], v[216:219], a[180:183], v[64:79]
  buffer_load_dwordx4 a[164:167], v1, s[20:23], s76 offen offset:3072 sc1
  v_mfma_f32_32x32x16_bf16 v[80:95], v[220:223], a[180:183], v[80:95]
  s_lshl_b32 s54, s40, 7
  s_add_u32 s54, s54, 0x6000
  s_mov_b64 exec, 0x3fff
  buffer_load_dword v56, v7, s[20:23], s54 offen sc1
  s_mov_b64 exec, -1
  s_waitcnt vmcnt(12)
  v_mfma_f32_32x32x16_bf16 v[64:79], v[224:227], a[184:187], v[64:79]
  s_add_u32 s77, s79, 0x6000
  buffer_load_dwordx4 a[168:171], v1, s[20:23], s77 offen offset:0 sc1
  v_mfma_f32_32x32x16_bf16 v[80:95], v[228:231], a[184:187], v[80:95]
  s_waitcnt vmcnt(12)
  v_mfma_f32_32x32x16_bf16 v[64:79], v[232:235], a[188:191], v[64:79]
  buffer_load_dwordx4 a[172:175], v1, s[20:23], s77 offen offset:1024 sc1
  v_mfma_f32_32x32x16_bf16 v[80:95], v[236:239], a[188:191], v[80:95]
  s_waitcnt vmcnt(12)
  v_mfma_f32_32x32x16_bf16 v[64:79], v[240:243], a[192:195], v[64:79]
  buffer_load_dwordx4 a[176:179], v1, s[20:23], s77 offen offset:2048 sc1
  v_mfma_f32_32x32x16_bf16 v[80:95], v[244:247], a[192:195], v[80:95]
  s_waitcnt vmcnt(12)
  v_mfma_f32_32x32x16_bf16 v[64:79], v[248:251], a[196:199], v[64:79]
  buffer_load_dwordx4 a[180:183], v1, s[20:23], s77 offen offset:3072 sc1
  v_mfma_f32_32x32x16_bf16 v[80:95], v[252:255], a[196:199], v[80:95]
  s_waitcnt vmcnt(12)
  v_mfma_f32_32x32x16_bf16 v[64:79], a[232:235], a[136:139], v[64:79]
  v_mfma_f32_32x32x16_bf16 v[80:95], a[236:239], a[136:139], v[80:95]
  s_waitcnt vmcnt(4)
  v_cmp_ne_u32 vcc, s43, v56
  s_nop 1
  s_and_b32 s56, vcc_lo, 0x3fff
  s_cbranch_scc1 L_fsp_156
L_fok_155:
  v_mfma_f32_32x32x16_bf16 v[64:79], a[240:243], a[140:143], v[64:79]
  buffer_load_dwordx4 a[184:187], v1, s[20:23], s88 offen offset:0 sc1
  v_mfma_f32_32x32x16_bf16 v[80:95], a[244:247], a[140:143], v[80:95]
  v_mfma_f32_32x32x16_bf16 v[64:79], a[248:251], a[144:147], v[64:79]
  buffer_load_dwordx4 a[188:191], v1, s[20:23], s88 offen offset:1024 sc1
  v_mfma_f32_32x32x16_bf16 v[80:95], a[252:255], a[144:147], v[80:95]
  v_mfma_f32_32x32x16_bf16 v[64:79], a[0:3], a[148:151], v[64:79]
  buffer_load_dwordx4 a[192:195], v1, s[20:23], s88 offen offset:2048 sc1
  v_mfma_f32_32x32x16_bf16 v[80:95], a[4:7], a[148:151], v[80:95]
  v_mfma_f32_32x32x16_bf16 v[64:79], a[8:11], a[152:155], v[64:79]
  buffer_load_dwordx4 a[196:199], v1, s[20:23], s88 offen offset:3072 sc1
  v_mfma_f32_32x32x16_bf16 v[80:95], a[12:15], a[152:155], v[80:95]
  v_mfma_f32_32x32x16_bf16 v[64:79], a[16:19], a[156:159], v[64:79]
  s_add_u32 s74, s88, 0x1000
  buffer_load_dwordx4 a[136:139], v1, s[20:23], s74 offen offset:0 sc1
  v_mfma_f32_32x32x16_bf16 v[80:95], a[20:23], a[156:159], v[80:95]
  v_mfma_f32_32x32x16_bf16 v[64:79], a[24:27], a[160:163], v[64:79]
  buffer_load_dwordx4 a[140:143], v1, s[20:23], s74 offen offset:1024 sc1
  v_mfma_f32_32x32x16_bf16 v[80:95], a[28:31], a[160:163], v[80:95]
  v_mfma_f32_32x32x16_bf16 v[64:79], a[32:35], a[164:167], v[64:79]
  buffer_load_dwordx4 a[144:147], v1, s[20:23], s74 offen offset:2048 sc1
  v_mfma_f32_32x32x16_bf16 v[80:95], a[36:39], a[164:167], v[80:95]
  s_waitcnt vmcnt(10)
  v_mfma_f32_32x32x16_bf16 v[64:79], a[40:43], a[168:171], v[64:79]
  buffer_load_dwordx4 a[148:151], v1, s[20:23], s74 offen offset:3072 sc1
  v_mfma_f32_32x32x16_bf16 v[80:95], a[44:47], a[168:171], v[80:95]
  s_waitcnt vmcnt(10)
  v_mfma_f32_32x32x16_bf16 v[64:79], a[48:51], a[172:175], v[64:79]
  s_add_u32 s75, s88, 0x2000
  buffer_load_dwordx4 a[152:155], v1, s[20:23], s75 offen offset:0 sc1
  v_mfma_f32_32x32x16_bf16 v[80:95], a[52:55], a[172:175], v[80:95]
  s_waitcnt vmcnt(10)
  v_mfma_f32_32x32x16_bf16 v[64:79], a[56:59], a[176:179], v[64:79]
  buffer_load_dwordx4 a[156:159], v1, s[20:23], s75 offen offset:1024 sc1
  v_mfma_f32_32x32x16_bf16 v[80:95], a[60:63], a[176:179], v[80:95]
  s_waitcnt vmcnt(10)
  v_mfma_f32_32x32x16_bf16 v[64:79], a[64:67], a[180:183], v[64:79]
  buffer_load_dwordx4 a[160:163], v1, s[20:23], s75 offen offset:2048 sc1
  v_mfma_f32_32x32x16_bf16 v[80:95], a[68:71], a[180:183], v[80:95]
  s_waitcnt vmcnt(10)
  v_mfma_f32_32x32x16_bf16 v[96:111], v[128:131], a[184:187], 0
  buffer_load_dwordx4 a[164:167], v1, s[20:23], s75 offen offset:3072 sc1
  v_mfma_f32_32x32x16_bf16 v[112:127], v[132:135], a[184:187], 0
  s_waitcnt vmcnt(10)
  v_mfma_f32_32x32x16_bf16 v[96:111], v[136:139], a[188:191], v[96:111]
  s_add_u32 s76, s88, 0x3000
  buffer_load_dwordx4 a[168:171], v1, s[20:23], s76 offen offset:0 sc1
  v_mfma_f32_32x32x16_bf16 v[112:127], v[140:143], a[188:191], v[112:127]
  s_waitcnt vmcnt(10)
  v_mfma_f32_32x32x16_bf16 v[96:111], v[144:147], a[192:195], v[96:111]
  buffer_load_dwordx4 a[172:175], v1, s[20:23], s76 offen offset:1024 sc1
  ds_write_b128 v10, v[72:75] offset:0
  v_mfma_f32_32x32x16_bf16 v[112:127], v[148:151], a[192:195], v[112:127]
  ds_write_b128 v10, v[76:79] offset:1024
  s_waitcnt vmcnt(10)
  v_mfma_f32_32x32x16_bf16 v[96:111], v[152:155], a[196:199], v[96:111]
  buffer_load_dwordx4 a[176:179], v1, s[20:23], s76 offen offset:2048 sc1
  ds_write_b128 v11, v[80:83] offset:0
  v_mfma_f32_32x32x16_bf16 v[112:127], v[156:159], a[196:199], v[112:127]
  ds_write_b128 v11, v[84:87] offset:1024
  s_waitcnt vmcnt(10)
  v_mfma_f32_32x32x16_bf16 v[96:111], v[160:163], a[136:139], v[96:111]
  buffer_load_dwordx4 a[180:183], v1, s[20:23], s76 offen offset:3072 sc1
  ds_write_b128 v12, v[88:91] offset:0
  v_mfma_f32_32x32x16_bf16 v[112:127], v[164:167], a[136:139], v[112:127]
  ds_write_b128 v12, v[92:95] offset:1024
  s_waitcnt vmcnt(10)
  v_mfma_f32_32x32x16_bf16 v[96:111], v[168:171], a[140:143], v[96:111]
  s_add_u32 s77, s88, 0x4000
  buffer_load_dwordx4 a[184:187], v1, s[20:23], s77 offen offset:0 sc1
  v_mfma_f32_32x32x16_bf16 v[112:127], v[172:175], a[140:143], v[112:127]
  s_waitcnt vmcnt(10)
  v_mfma_f32_32x32x16_bf16 v[96:111], v[176:179], a[144:147], v[96:111]
  buffer_load_dwordx4 a[188:191], v1, s[20:23], s77 offen offset:1024 sc1
  v_mfma_f32_32x32x16_bf16 v[112:127], v[180:183], a[144:147], v[112:127]
  s_waitcnt lgkmcnt(0)
  s_barrier
  ds_read_b128 v[72:75], v13 offset:0
  ds_read_b128 v[76:79], v13 offset:1024
  ds_read_b128 v[80:83], v13 offset:2048
  s_waitcnt vmcnt(10)
  v_mfma_f32_32x32x16_bf16 v[96:111], v[184:187], a[148:151], v[96:111]
  buffer_load_dwordx4 a[192:195], v1, s[20:23], s77 offen offset:2048 sc1
  ds_read_b128 v[84:87], v13 offset:3072
  ds_read_b128 v[88:91], v13 offset:4096
  ds_read_b128 v[92:95], v13 offset:5120
  s_mul_i32 s57, s34, 28672
  v_mfma_f32_32x32x16_bf16 v[112:127], v[188:191], a[148:151], v[112:127]
  s_lshl_b32 s58, s47, 2
  s_add_u32 s58, s58, s42
  s_lshl_b32 s58, s58, 5
  s_add_u32 s57, s57, s58
  s_waitcnt vmcnt(10)
  v_mfma_f32_32x32x16_bf16 v[96:111], v[192:195], a[152:155], v[96:111]
  buffer_load_dwordx4 a[196:199], v1, s[20:23], s77 offen offset:3072 sc1
  v_lshlrev_b32 v40, 16, v16
  v_and_b32 v16, 0xffff0000, v16
  v_lshlrev_b32 v41, 16, v17
  v_and_b32 v17, 0xffff0000, v17
  v_mfma_f32_32x32x16_bf16 v[112:127], v[196:199], a[152:155], v[112:127]
  v_lshlrev_b32 v42, 16, v18
  v_and_b32 v18, 0xffff0000, v18
  v_lshlrev_b32 v43, 16, v19
  v_and_b32 v19, 0xffff0000, v19
  s_waitcnt vmcnt(10)
  v_mfma_f32_32x32x16_bf16 v[96:111], v[200:203], a[156:159], v[96:111]
  s_add_u32 s74, s88, 0x5000
  buffer_load_dwordx4 a[136:139], v1, s[20:23], s74 offen offset:0 sc1
  v_add_f32 v64, v64, v40
  v_add_f32 v65, v65, v16
  v_add_f32 v66, v66, v41
  v_add_f32 v67, v67, v17
  v_mfma_f32_32x32x16_bf16 v[112:127], v[204:207], a[156:159], v[112:127]
  v_add_f32 v68, v68, v42
  v_add_f32 v69, v69, v18
  v_add_f32 v70, v70, v43
  v_add_f32 v71, v71, v19
  s_waitcnt vmcnt(10)
  v_mfma_f32_32x32x16_bf16 v[96:111], v[208:211], a[160:163], v[96:111]
  buffer_load_dwordx4 a[140:143], v1, s[20:23], s74 offen offset:1024 sc1
  s_waitcnt lgkmcnt(4)
  v_add_f32 v64, v64, v72
  v_add_f32 v65, v65, v73
  v_add_f32 v66, v66, v74
  v_add_f32 v67, v67, v75
  v_mfma_f32_32x32x16_bf16 v[112:127], v[212:215], a[160:163], v[112:127]
  v_add_f32 v68, v68, v76
  v_add_f32 v69, v69, v77
  v_add_f32 v70, v70, v78
  v_add_f32 v71, v71, v79
  s_waitcnt vmcnt(10)
  v_mfma_f32_32x32x16_bf16 v[96:111], v[216:219], a[164:167], v[96:111]
  buffer_load_dwordx4 a[144:147], v1, s[20:23], s74 offen offset:2048 sc1
  s_waitcnt lgkmcnt(2)
  v_add_f32 v64, v64, v80
  v_add_f32 v65, v65, v81
  v_add_f32 v66, v66, v82
  v_add_f32 v67, v67, v83
  v_mfma_f32_32x32x16_bf16 v[112:127], v[220:223], a[164:167], v[112:127]
  v_add_f32 v68, v68, v84
  v_add_f32 v69, v69, v85
  v_add_f32 v70, v70, v86
  v_add_f32 v71, v71, v87
  s_waitcnt vmcnt(10)
  v_mfma_f32_32x32x16_bf16 v[96:111], v[224:227], a[168:171], v[96:111]
  buffer_load_dwordx4 a[148:151], v1, s[20:23], s74 offen offset:3072 sc1
  s_waitcnt lgkmcnt(0)
  v_add_f32 v64, v64, v88
  v_add_f32 v65, v65, v89
  v_add_f32 v66, v66, v90
  v_add_f32 v67, v67, v91
  v_mfma_f32_32x32x16_bf16 v[112:127], v[228:231], a[168:171], v[112:127]
  v_add_f32 v68, v68, v92
  v_add_f32 v69, v69, v93
  v_add_f32 v70, v70, v94
  v_add_f32 v71, v71, v95
  s_waitcnt vmcnt(10)
  v_mfma_f32_32x32x16_bf16 v[96:111], v[232:235], a[172:175], v[96:111]
  s_add_u32 s75, s88, 0x6000
  buffer_load_dwordx4 a[152:155], v1, s[20:23], s75 offen offset:0 sc1
  v_cvt_pk_bf16_f32 v40, v64, v65
  v_cvt_pk_bf16_f32 v41, v66, v67
  v_cvt_pk_bf16_f32 v42, v68, v69
  v_cvt_pk_bf16_f32 v43, v70, v71
  v_mfma_f32_32x32x16_bf16 v[112:127], v[236:239], a[172:175], v[112:127]
  v_permlane32_swap_b32 v40, v42
  v_permlane32_swap_b32 v41, v43
  s_waitcnt vmcnt(10)
  v_mfma_f32_32x32x16_bf16 v[96:111], v[240:243], a[176:179], v[96:111]
  buffer_load_dwordx4 a[156:159], v1, s[20:23], s75 offen offset:1024 sc1
  buffer_store_dwordx4 v[40:43], v6, s[24:27], s57 offen
  v_mfma_f32_32x32x16_bf16 v[112:127], v[244:247], a[176:179], v[112:127]
  s_waitcnt vmcnt(11)
  v_mfma_f32_32x32x16_bf16 v[96:111], v[248:251], a[180:183], v[96:111]
  buffer_load_dwordx4 a[160:163], v1, s[20:23], s75 offen offset:2048 sc1
  v_mfma_f32_32x32x16_bf16 v[112:127], v[252:255], a[180:183], v[112:127]
  s_waitcnt vmcnt(11)
  v_mfma_f32_32x32x16_bf16 v[96:111], a[232:235], a[184:187], v[96:111]
  buffer_load_dwordx4 a[164:167], v1, s[20:23], s75 offen offset:3072 sc1
  v_mfma_f32_32x32x16_bf16 v[112:127], a[236:239], a[184:187], v[112:127]
  s_waitcnt vmcnt(11)
  v_mfma_f32_32x32x16_bf16 v[96:111], a[240:243], a[188:191], v[96:111]
  v_mfma_f32_32x32x16_bf16 v[112:127], a[244:247], a[188:191], v[112:127]
  s_waitcnt vmcnt(10)
  v_mfma_f32_32x32x16_bf16 v[96:111], a[248:251], a[192:195], v[96:111]
  v_mfma_f32_32x32x16_bf16 v[112:127], a[252:255], a[192:195], v[112:127]
  s_waitcnt vmcnt(9)
  v_mfma_f32_32x32x16_bf16 v[96:111], a[0:3], a[196:199], v[96:111]
  v_mfma_f32_32x32x16_bf16 v[112:127], a[4:7], a[196:199], v[112:127]
  s_waitcnt vmcnt(8)
  v_mfma_f32_32x32x16_bf16 v[96:111], a[8:11], a[136:139], v[96:111]
  v_mfma_f32_32x32x16_bf16 v[112:127], a[12:15], a[136:139], v[112:127]
  s_waitcnt vmcnt(7)
  v_mfma_f32_32x32x16_bf16 v[96:111], a[16:19], a[140:143], v[96:111]
  v_mfma_f32_32x32x16_bf16 v[112:127], a[20:23], a[140:143], v[112:127]
  s_waitcnt vmcnt(6)
  v_mfma_f32_32x32x16_bf16 v[96:111], a[24:27], a[144:147], v[96:111]
  v_mfma_f32_32x32x16_bf16 v[112:127], a[28:31], a[144:147], v[112:127]
  s_waitcnt vmcnt(5)
  v_mfma_f32_32x32x16_bf16 v[96:111], a[32:35], a[148:151], v[96:111]
  v_mfma_f32_32x32x16_bf16 v[112:127], a[36:39], a[148:151], v[112:127]
  s_waitcnt vmcnt(4)
  v_mfma_f32_32x32x16_bf16 v[96:111], a[40:43], a[152:155], v[96:111]
  v_mfma_f32_32x32x16_bf16 v[112:127], a[44:47], a[152:155], v[112:127]
  s_waitcnt vmcnt(3)
  v_mfma_f32_32x32x16_bf16 v[96:111], a[48:51], a[156:159], v[96:111]
  v_mfma_f32_32x32x16_bf16 v[112:127], a[52:55], a[156:159], v[112:127]
  s_waitcnt vmcnt(1)
  v_mfma_f32_32x32x16_bf16 v[96:111], a[56:59], a[160:163], v[96:111]
  v_mfma_f32_32x32x16_bf16 v[112:127], a[60:63], a[160:163], v[112:127]
  s_waitcnt vmcnt(0)
  v_mfma_f32_32x32x16_bf16 v[96:111], a[64:67], a[164:167], v[96:111]
  v_mfma_f32_32x32x16_bf16 v[112:127], a[68:71], a[164:167], v[112:127]
  s_nop 10
  ds_write_b128 v10, v[104:107] offset:24576
  ds_write_b128 v10, v[108:111] offset:25600
  ds_write_b128 v11, v[112:115] offset:24576
  ds_write_b128 v11, v[116:119] offset:25600
  ds_write_b128 v12, v[120:123] offset:24576
  ds_write_b128 v12, v[124:127] offset:25600
  v_dot2_f32_bf16 v96, v20, s60, v96
  v_dot2_f32_bf16 v97, v20, s61, v97
  v_dot2_f32_bf16 v98, v21, s60, v98
  v_dot2_f32_bf16 v99, v21, s61, v99
  v_dot2_f32_bf16 v100, v22, s60, v100
  v_dot2_f32_bf16 v101, v22, s61, v101
  v_dot2_f32_bf16 v102, v23, s60, v102
  v_dot2_f32_bf16 v103, v23, s61, v103
  s_waitcnt lgkmcnt(0)
  s_barrier
  ds_read_b128 v[104:107], v13 offset:24576
  ds_read_b128 v[108:111], v13 offset:25600
  ds_read_b128 v[112:115], v13 offset:26624
  ds_read_b128 v[116:119], v13 offset:27648
  ds_read_b128 v[120:123], v13 offset:28672
  ds_read_b128 v[124:127], v13 offset:29696
  s_mul_i32 s57, s34, 28672
  s_lshl_b32 s58, s47, 2
  s_add_u32 s58, s58, s42
  s_lshl_b32 s58, s58, 5
  s_add_u32 s57, s57, s58
  s_add_u32 s57, s57, 57344
  s_waitcnt lgkmcnt(4)
  v_pk_add_f32 v[96:97], v[96:97], v[104:105]
  v_pk_add_f32 v[98:99], v[98:99], v[106:107]
  v_pk_add_f32 v[100:101], v[100:101], v[108:109]
  v_pk_add_f32 v[102:103], v[102:103], v[110:111]
  s_waitcnt lgkmcnt(2)
  v_pk_add_f32 v[96:97], v[96:97], v[112:113]
  v_pk_add_f32 v[98:99], v[98:99], v[114:115]
  v_pk_add_f32 v[100:101], v[100:101], v[116:117]
  v_pk_add_f32 v[102:103], v[102:103], v[118:119]
  s_waitcnt lgkmcnt(0)
  v_pk_add_f32 v[96:97], v[96:97], v[120:121]
  v_pk_add_f32 v[98:99], v[98:99], v[122:123]
  v_pk_add_f32 v[100:101], v[100:101], v[124:125]
  v_pk_add_f32 v[102:103], v[102:103], v[126:127]
  v_cvt_pk_bf16_f32 v48, v96, v97
  v_cvt_pk_bf16_f32 v49, v98, v99
  v_cvt_pk_bf16_f32 v50, v100, v101
  v_cvt_pk_bf16_f32 v51, v102, v103
  s_nop 0
  v_permlane32_swap_b32 v48, v50
  v_permlane32_swap_b32 v49, v51
  buffer_store_dwordx4 v[48:51], v6, s[24:27], s57 offen
  s_nop 1
L_fin:
L_end:
  s_endpgm
L_help0:
  v_lshlrev_b32 v10, 7, v0
  s_lshl_b32 s48, s42, 13
  s_add_u32 s48, s48, L_wo0-L_pc
  v_add_u32 v11, s48, v10
  v_min_u32 v11, L_code_end-L_pc-4, v11
  global_load_dword v56, v11, s[96:97]
  s_sub_u32 s69, s41, 14
  s_lshl_b32 s69, s69, 2
  s_add_u32 s69, s69, s42
  s_lshl_b32 s69, s69, 13
  s_lshl_b32 s48, s42, 6
  v_add_u32 v12, s48, v0
  v_lshlrev_b32 v12, 6, v12
  v_add_u32 v12, 0x13000, v12
  v_mov_b32 v11, s43
  v_not_b32 v11, v11
  s_mov_b32 s63, 0
L_shpoll_158:
  v_cmp_ne_u32 vcc, s43, v11
  s_add_u32 s63, s63, 1
  s_nop 1
  s_cbranch_vccz L_shdone_159
  buffer_load_dword v11, v12, s[20:23], 0 offen sc1
  s_waitcnt vmcnt(0)
  s_cmp_lt_u32 s63, 262144
  s_cbranch_scc1 L_shpoll_158
L_shdone_159:
  s_barrier
  s_and_b32 s48, s40, 1
  s_lshl_b32 s48, s48, 16
  s_add_u32 s48, s48, s69
  s_lshr_b32 s48, s48, 13
  s_mul_i32 s48, s48, 207872
  s_add_u32 s48, s48, 0x20f000
  s_add_u32 s49, s48, 0x0
  buffer_load_dword v48, v10, s[20:23], s49 offen
  s_add_u32 s49, s48, 0x7400
  buffer_load_dword v49, v10, s[20:23], s49 offen
  s_add_u32 s49, s48, 0xe800
  buffer_load_dword v50, v10, s[20:23], s49 offen
  s_add_u32 s49, s48, 0x15c00
  buffer_load_dword v51, v10, s[20:23], s49 offen
  s_add_u32 s49, s48, 0x1d000
  buffer_load_dword v52, v10, s[20:23], s49 offen
  s_add_u32 s49, s48, 0x24400
  buffer_load_dword v53, v10, s[20:23], s49 offen
  s_add_u32 s49, s48, 0x2b800
  buffer_load_dword v54, v10, s[20:23], s49 offen
  s_add_u32 s49, s48, 0x2000
  buffer_load_dword v48, v10, s[20:23], s49 offen
  s_add_u32 s49, s48, 0x9400
  buffer_load_dword v49, v10, s[20:23], s49 offen
  s_add_u32 s49, s48, 0x10800
  buffer_load_dword v50, v10, s[20:23], s49 offen
  s_add_u32 s49, s48, 0x17c00
  buffer_load_dword v51, v10, s[20:23], s49 offen
  s_add_u32 s49, s48, 0x1f000
  buffer_load_dword v52, v10, s[20:23], s49 offen
  s_add_u32 s49, s48, 0x26400
  buffer_load_dword v53, v10, s[20:23], s49 offen
  s_add_u32 s49, s48, 0x2d800
  buffer_load_dword v54, v10, s[20:23], s49 offen
  s_cmp_lg_u32 s42, 0
  s_cbranch_scc1 L_pollskip_160
  s_lshl_b32 s56, s40, 7
  s_add_u32 s56, s56, 0x2000
  s_mov_b32 s63, 0
  s_mov_b64 exec, 0x3fff
L_poll_161:
  buffer_load_dword v8, v7, s[20:23], s56 offen sc1
  s_waitcnt vmcnt(0)
  v_cmp_ne_u32 vcc, s43, v8
  s_add_u32 s63, s63, 1
  s_nop 1
  s_cbranch_vccz L_polldone_162
  s_cmp_lt_u32 s63, 262144
  s_cbranch_scc1 L_poll_161
L_polldone_162:
  s_mov_b64 exec, -1
L_pollskip_160:
  s_barrier
  s_lshl_b32 s48, s42, 13
  s_add_u32 s48, s48, L_gu0-L_pc
  v_add_u32 v11, s48, v10
  v_min_u32 v11, L_code_end-L_pc-4, v11
  global_load_dword v56, v11, s[96:97]
  s_nop 1
  s_cmp_lg_u32 s42, 0
  s_cbranch_scc1 L_pollskip_163
  s_lshl_b32 s56, s40, 7
  s_add_u32 s56, s56, 0x2800
  s_mov_b32 s63, 0
  s_mov_b64 exec, 0x3fff
L_poll_164:
  buffer_load_dword v8, v7, s[20:23], s56 offen sc1
  s_waitcnt vmcnt(0)
  v_cmp_ne_u32 vcc, s43, v8
  s_add_u32 s63, s63, 1
  s_nop 1
  s_cbranch_vccz L_polldone_165
  s_cmp_lt_u32 s63, 262144
  s_cbranch_scc1 L_poll_164
L_polldone_165:
  s_mov_b64 exec, -1
L_pollskip_163:
  s_barrier
  s_lshl_b32 s48, s42, 13
  s_add_u32 s48, s48, L_join0-L_pc
  v_add_u32 v11, s48, v10
  v_min_u32 v11, L_code_end-L_pc-4, v11
  global_load_dword v56, v11, s[96:97]
  s_mul_i32 s56, s40, 0x90000
  s_add_u32 s56, s56, 0x834000
  s_add_u32 s56, s56, s69
  s_add_u32 s57, s69, 0x0
  s_cmp_lt_u32 s57, 0x1c000
  s_cselect_b32 s57, s56, 0x7f000000
  buffer_load_dword v40, v10, s[20:23], s57 offen
  s_add_u32 s56, s56, 0x10000
  s_add_u32 s57, s69, 0x10000
  s_cmp_lt_u32 s57, 0x1c000
  s_cselect_b32 s57, s56, 0x7f000000
  buffer_load_dword v41, v10, s[20:23], s57 offen
  s_add_u32 s56, s56, 0x10000
  s_mul_i32 s56, s40, 0x7000
  s_add_u32 s56, s56, 0x1130000
  s_add_u32 s56, s56, s69
  s_add_u32 s57, s69, 0x0
  s_cmp_lt_u32 s57, 0x7000
  s_cselect_b32 s57, s56, 0x7f000000
  buffer_load_dword v40, v10, s[20:23], s57 offen
  s_add_u32 s56, s56, 0x10000
  s_mul_i32 s56, s40, 0x7000
  s_add_u32 s56, s56, 0x10c0000
  s_add_u32 s56, s56, s69
  s_add_u32 s57, s69, 0x0
  s_cmp_lt_u32 s57, 0x7000
  s_cselect_b32 s57, s56, 0x7f000000
  buffer_load_dword v40, v10, s[20:23], s57 offen
  s_add_u32 s56, s56, 0x10000
  s_waitcnt vmcnt(0)
  s_branch L_join0
L_help1:
  v_lshlrev_b32 v10, 7, v0
  s_lshl_b32 s48, s42, 13
  s_add_u32 s48, s48, L_wo1-L_pc
  v_add_u32 v11, s48, v10
  v_min_u32 v11, L_code_end-L_pc-4, v11
  global_load_dword v56, v11, s[96:97]
  s_sub_u32 s69, s41, 14
  s_lshl_b32 s69, s69, 2
  s_add_u32 s69, s69, s42
  s_lshl_b32 s69, s69, 13
  s_mul_i32 s56, s40, 0x90000
  s_add_u32 s56, s56, 0x834000
  s_add_u32 s56, s56, s69
  s_add_u32 s57, s69, 0x0
  s_cmp_lt_u32 s57, 0x1c000
  s_cselect_b32 s57, s56, 0x7f000000
  buffer_load_dword v40, v10, s[20:23], s57 offen
  s_add_u32 s56, s56, 0x10000
  s_add_u32 s57, s69, 0x10000
  s_cmp_lt_u32 s57, 0x1c000
  s_cselect_b32 s57, s56, 0x7f000000
  buffer_load_dword v41, v10, s[20:23], s57 offen
  s_add_u32 s56, s56, 0x10000
  s_mul_i32 s56, s40, 0x90000
  s_add_u32 s56, s56, 0x7fc000
  s_add_u32 s56, s56, s69
  s_add_u32 s57, s69, 0x0
  s_cmp_lt_u32 s57, 0x1c000
  s_cselect_b32 s57, s56, 0x7f000000
  buffer_load_dword v40, v10, s[20:23], s57 offen
  s_add_u32 s56, s56, 0x10000
  s_add_u32 s57, s69, 0x10000
  s_cmp_lt_u32 s57, 0x1c000
  s_cselect_b32 s57, s56, 0x7f000000
  buffer_load_dword v41, v10, s[20:23], s57 offen
  s_add_u32 s56, s56, 0x10000
  s_waitcnt vmcnt(0)
  s_branch L_fin
L_hot_end:
L_kv3s_14:
  buffer_store_dwordx3 v[104:106], v10, s[20:23], s56 offen sc1
  s_nop 0
  s_branch L_kv3j_15
L_kv3l_22:
  s_add_u32 s48, s69, 0
  buffer_load_dwordx3 v[128:130], v12, s[20:23], s48 offen sc1
  s_add_u32 s49, s69, 4096
  buffer_load_dwordx3 v[132:134], v12, s[20:23], s49 offen sc1
  s_add_u32 s50, s69, 8192
  buffer_load_dwordx3 v[136:138], v12, s[20:23], s50 offen sc1
  s_add_u32 s51, s69, 12288
  buffer_load_dwordx3 v[140:142], v12, s[20:23], s51 offen sc1
  s_add_u32 s48, s69, 16384
  buffer_load_dwordx3 v[144:146], v12, s[20:23], s48 offen sc1
  s_add_u32 s49, s69, 20480
  buffer_load_dwordx3 v[148:150], v12, s[20:23], s49 offen sc1
  s_add_u32 s50, s69, 24576
  buffer_load_dwordx3 v[152:154], v12, s[20:23], s50 offen sc1
  s_add_u32 s51, s69, 28672
  buffer_load_dwordx3 v[156:158], v12, s[20:23], s51 offen sc1
  s_add_u32 s48, s93, 32768
  buffer_load_dwordx3 v[160:162], v12, s[20:23], s48 offen sc1
  s_add_u32 s49, s93, 36864
  buffer_load_dwordx3 v[164:166], v12, s[20:23], s49 offen sc1
  s_add_u32 s50, s93, 40960
  buffer_load_dwordx3 v[168:170], v12, s[20:23], s50 offen sc1
  s_add_u32 s51, s93, 45056
  buffer_load_dwordx3 v[172:174], v12, s[20:23], s51 offen sc1
  s_add_u32 s48, s93, 49152
  buffer_load_dwordx3 v[176:178], v12, s[20:23], s48 offen sc1
  s_add_u32 s49, s93, 53248
  buffer_load_dwordx3 v[180:182], v12, s[20:23], s49 offen sc1
  s_add_u32 s50, s93, 57344
  buffer_load_dwordx3 v[184:186], v12, s[20:23], s50 offen sc1
  s_add_u32 s51, s93, 61440
  buffer_load_dwordx3 v[188:190], v12, s[20:23], s51 offen sc1
  s_branch L_kv3k_23
L_slow_25:
  buffer_store_dword v8, v7, s[20:23], s56 offen sc1
  s_nop 0
  s_branch L_join_26
L_fsp_31:
  s_lshl_b32 s56, s40, 7
  s_add_u32 s56, s56, 0x1000
  s_mov_b32 s63, 0
  s_mov_b64 exec, 0xffff
L_fspin_29:
  buffer_load_dword v36, v7, s[20:23], s56 offen sc1
  s_waitcnt vmcnt(0)
  v_cmp_ne_u32 vcc, s43, v36
  s_add_u32 s63, s63, 1
  s_nop 1
  s_cbranch_vccz L_fex_32
  s_cmp_lt_u32 s63, 262144
  s_cbranch_scc1 L_fspin_29
L_fex_32:
  s_mov_b64 exec, -1
  s_nop 0
  s_branch L_fok_30
L_slow_33:
  buffer_store_dwordx4 v[40:43], v1, s[20:23], s57 offen sc1
  s_nop 0
  s_branch L_join_34
L_slow_35:
  buffer_store_dword v44, v4, s[20:23], s58 offen sc1
  s_nop 0
  s_branch L_join_36
L_slow_38:
  buffer_store_dword v8, v7, s[20:23], s56 offen sc1
  s_nop 0
  s_branch L_join_39
L_slow_40:
  buffer_store_dwordx4 v[48:51], v1, s[20:23], s57 offen sc1
  s_nop 0
  s_branch L_join_41
L_slow_42:
  buffer_store_dword v52, v4, s[20:23], s58 offen sc1
  s_nop 0
  s_branch L_join_43
L_fsp_46:
  s_lshl_b32 s56, s40, 7
  s_add_u32 s56, s56, 0x1800
  s_mov_b32 s63, 0
  s_mov_b64 exec, 0x3fff
L_fspin_44:
  buffer_load_dword v10, v7, s[20:23], s56 offen sc1
  s_waitcnt vmcnt(0)
  v_cmp_ne_u32 vcc, s43, v10
  s_add_u32 s63, s63, 1
  s_nop 1
  s_cbranch_vccz L_fex_47
  s_cmp_lt_u32 s63, 262144
  s_cbranch_scc1 L_fspin_44
L_fex_47:
  s_mov_b64 exec, -1
  s_nop 0
  s_branch L_fok_45
L_slow_49:
  buffer_store_dword v8, v7, s[20:23], s56 offen sc1
  s_nop 0
  s_branch L_join_50
L_fsp_53:
  s_lshl_b32 s56, s40, 7
  s_add_u32 s56, s56, 0x2000
  s_mov_b32 s63, 0
  s_mov_b64 exec, 0x3fff
L_fspin_51:
  buffer_load_dword v12, v7, s[20:23], s56 offen sc1
  s_waitcnt vmcnt(0)
  v_cmp_ne_u32 vcc, s43, v12
  s_add_u32 s63, s63, 1
  s_nop 1
  s_cbranch_vccz L_fex_54
  s_cmp_lt_u32 s63, 262144
  s_cbranch_scc1 L_fspin_51
L_fex_54:
  s_mov_b64 exec, -1
  s_nop 0
  s_branch L_fok_52
L_slow_58:
  buffer_store_dword v13, v7, s[20:23], s56 offen sc1
  s_nop 0
  s_branch L_join_59
L_fsp_62:
  s_lshl_b32 s56, s40, 7
  s_add_u32 s56, s56, 0x2800
  s_mov_b32 s63, 0
  s_mov_b64 exec, 0x3fff
L_fspin_60:
  buffer_load_dword v12, v7, s[20:23], s56 offen sc1
  s_waitcnt vmcnt(0)
  v_cmp_ne_u32 vcc, s43, v12
  s_add_u32 s63, s63, 1
  s_nop 1
  s_cbranch_vccz L_fex_63
  s_cmp_lt_u32 s63, 262144
  s_cbranch_scc1 L_fspin_60
L_fex_63:
  s_mov_b64 exec, -1
  s_nop 0
  s_branch L_fok_61
L_slow_64:
  buffer_store_dwordx4 v[32:35], v1, s[20:23], s49 offen offset:0 sc1
  s_nop 0
  s_branch L_join_65
L_slow_66:
  buffer_store_dwordx4 v[36:39], v1, s[20:23], s50 offen offset:1024 sc1
  s_nop 0
  s_branch L_join_67
L_slow_69:
  buffer_store_dword v57, v7, s[20:23], s56 offen sc1
  s_nop 0
  s_branch L_join_70
L_fsp_73:
  s_lshl_b32 s56, s40, 7
  s_add_u32 s56, s56, 0x3000
  s_mov_b32 s63, 0
  s_mov_b64 exec, 0x3fff
L_fspin_71:
  buffer_load_dword v56, v7, s[20:23], s56 offen sc1
  s_waitcnt vmcnt(0)
  v_cmp_ne_u32 vcc, s43, v56
  s_add_u32 s63, s63, 1
  s_nop 1
  s_cbranch_vccz L_fex_74
  s_cmp_lt_u32 s63, 262144
  s_cbranch_scc1 L_fspin_71
L_fex_74:
  s_mov_b64 exec, -1
  s_nop 0
  s_branch L_fok_72
L_slow_75:
  buffer_store_dwordx4 v[40:43], v1, s[20:23], s57 offen sc1
  s_nop 0
  s_branch L_join_76
L_slow_77:
  buffer_store_dword v44, v4, s[20:23], s58 offen sc1
  s_nop 0
  s_branch L_join_78
L_slow_79:
  buffer_store_dwordx4 v[48:51], v1, s[20:23], s57 offen sc1
  s_nop 0
  s_branch L_join_80
L_slow_81:
  buffer_store_dword v52, v4, s[20:23], s58 offen sc1
  s_nop 0
  s_branch L_join_82
L_slow_84:
  buffer_store_dword v8, v7, s[20:23], s56 offen sc1
  s_nop 0
  s_branch L_join_85
L_kv3s_89:
  buffer_store_dwordx3 v[104:106], v10, s[20:23], s56 offen sc1
  s_nop 0
  s_branch L_kv3j_90
L_kv3l_95:
  s_add_u32 s48, s69, 0
  buffer_load_dwordx3 v[128:130], v12, s[20:23], s48 offen sc1
  s_add_u32 s49, s69, 4096
  buffer_load_dwordx3 v[132:134], v12, s[20:23], s49 offen sc1
  s_add_u32 s50, s69, 8192
  buffer_load_dwordx3 v[136:138], v12, s[20:23], s50 offen sc1
  s_add_u32 s51, s69, 12288
  buffer_load_dwordx3 v[140:142], v12, s[20:23], s51 offen sc1
  s_add_u32 s48, s69, 16384
  buffer_load_dwordx3 v[144:146], v12, s[20:23], s48 offen sc1
  s_add_u32 s49, s69, 20480
  buffer_load_dwordx3 v[148:150], v12, s[20:23], s49 offen sc1
  s_add_u32 s50, s69, 24576
  buffer_load_dwordx3 v[152:154], v12, s[20:23], s50 offen sc1
  s_add_u32 s51, s69, 28672
  buffer_load_dwordx3 v[156:158], v12, s[20:23], s51 offen sc1
  s_add_u32 s48, s93, 32768
  buffer_load_dwordx3 v[160:162], v12, s[20:23], s48 offen sc1
  s_add_u32 s49, s93, 36864
  buffer_load_dwordx3 v[164:166], v12, s[20:23], s49 offen sc1
  s_add_u32 s50, s93, 40960
  buffer_load_dwordx3 v[168:170], v12, s[20:23], s50 offen sc1
  s_add_u32 s51, s93, 45056
  buffer_load_dwordx3 v[172:174], v12, s[20:23], s51 offen sc1
  s_add_u32 s48, s93, 49152
  buffer_load_dwordx3 v[176:178], v12, s[20:23], s48 offen sc1
  s_add_u32 s49, s93, 53248
  buffer_load_dwordx3 v[180:182], v12, s[20:23], s49 offen sc1
  s_add_u32 s50, s93, 57344
  buffer_load_dwordx3 v[184:186], v12, s[20:23], s50 offen sc1
  s_add_u32 s51, s93, 61440
  buffer_load_dwordx3 v[188:190], v12, s[20:23], s51 offen sc1
  s_branch L_kv3k_96
L_slow_97:
  buffer_store_dwordx4 v[40:43], v1, s[20:23], s56 offen offset:0 sc1
  buffer_store_dwordx4 v[44:47], v1, s[20:23], s56 offen offset:1024 sc1
  s_nop 0
  s_branch L_join_98
L_slow_100:
  buffer_store_dword v8, v7, s[20:23], s56 offen sc1
  s_nop 0
  s_branch L_join_101
L_slow_106:
  buffer_store_dwordx4 v[40:43], v1, s[20:23], s57 offen sc1
  s_nop 0
  s_branch L_join_107
L_slow_108:
  buffer_store_dword v44, v4, s[20:23], s58 offen sc1
  s_nop 0
  s_branch L_join_109
L_slow_111:
  buffer_store_dword v8, v7, s[20:23], s56 offen sc1
  s_nop 0
  s_branch L_join_112
L_slow_113:
  buffer_store_dwordx4 v[48:51], v1, s[20:23], s57 offen sc1
  s_nop 0
  s_branch L_join_114
L_slow_115:
  buffer_store_dword v52, v4, s[20:23], s58 offen sc1
  s_nop 0
  s_branch L_join_116
L_fsp_119:
  s_lshl_b32 s56, s40, 7
  s_add_u32 s56, s56, 0x4800
  s_mov_b32 s63, 0
  s_mov_b64 exec, 0x3fff
L_fspin_117:
  buffer_load_dword v10, v7, s[20:23], s56 offen sc1
  s_waitcnt vmcnt(0)
  v_cmp_ne_u32 vcc, s43, v10
  s_add_u32 s63, s63, 1
  s_nop 1
  s_cbranch_vccz L_fex_120
  s_cmp_lt_u32 s63, 262144
  s_cbranch_scc1 L_fspin_117
L_fex_120:
  s_mov_b64 exec, -1
  s_nop 0
  s_branch L_fok_118
L_slow_122:
  buffer_store_dword v8, v7, s[20:23], s56 offen sc1
  s_nop 0
  s_branch L_join_123
L_fsp_126:
  s_lshl_b32 s56, s40, 7
  s_add_u32 s56, s56, 0x5000
  s_mov_b32 s63, 0
  s_mov_b64 exec, 0x3fff
L_fspin_124:
  buffer_load_dword v12, v7, s[20:23], s56 offen sc1
  s_waitcnt vmcnt(0)
  v_cmp_ne_u32 vcc, s43, v12
  s_add_u32 s63, s63, 1
  s_nop 1
  s_cbranch_vccz L_fex_127
  s_cmp_lt_u32 s63, 262144
  s_cbranch_scc1 L_fspin_124
L_fex_127:
  s_mov_b64 exec, -1
  s_nop 0
  s_branch L_fok_125
L_slow_128:
  buffer_store_dwordx4 v[24:27], v1, s[20:23], s53 offen offset:0 sc1
  s_nop 0
  s_branch L_join_129
L_slow_130:
  buffer_store_dwordx4 v[28:31], v1, s[20:23], s54 offen offset:1024 sc1
  s_nop 0
  s_branch L_join_131
L_slow_132:
  buffer_store_dwordx4 v[32:35], v1, s[20:23], s55 offen offset:0 sc1
  s_nop 0
  s_branch L_join_133
L_slow_134:
  buffer_store_dwordx4 v[36:39], v1, s[20:23], s48 offen offset:1024 sc1
  s_nop 0
  s_branch L_join_135
L_slow_137:
  buffer_store_dword v13, v7, s[20:23], s56 offen sc1
  s_nop 0
  s_branch L_join_138
L_slow_139:
  buffer_store_dwordx4 v[24:27], v1, s[20:23], s49 offen offset:0 sc1
  s_nop 0
  s_branch L_join_140
L_fsp_143:
  s_lshl_b32 s56, s40, 7
  s_add_u32 s56, s56, 0x5800
  s_mov_b32 s63, 0
  s_mov_b64 exec, 0x3fff
L_fspin_141:
  buffer_load_dword v12, v7, s[20:23], s56 offen sc1
  s_waitcnt vmcnt(0)
  v_cmp_ne_u32 vcc, s43, v12
  s_add_u32 s63, s63, 1
  s_nop 1
  s_cbranch_vccz L_fex_144
  s_cmp_lt_u32 s63, 262144
  s_cbranch_scc1 L_fspin_141
L_fex_144:
  s_mov_b64 exec, -1
  s_nop 0
  s_branch L_fok_142
L_slow_145:
  buffer_store_dwordx4 v[28:31], v1, s[20:23], s51 offen offset:1024 sc1
  s_nop 0
  s_branch L_join_146
L_slow_147:
  buffer_store_dwordx4 v[32:35], v1, s[20:23], s52 offen offset:0 sc1
  s_nop 0
  s_branch L_join_148
L_slow_149:
  buffer_store_dwordx4 v[36:39], v1, s[20:23], s53 offen offset:1024 sc1
  s_nop 0
  s_branch L_join_150
L_slow_152:
  buffer_store_dword v57, v7, s[20:23], s56 offen sc1
  s_nop 0
  s_branch L_join_153
L_fsp_156:
  s_lshl_b32 s56, s40, 7
  s_add_u32 s56, s56, 0x6000
  s_mov_b32 s63, 0
  s_mov_b64 exec, 0x3fff
L_fspin_154:
  buffer_load_dword v56, v7, s[20:23], s56 offen sc1
  s_waitcnt vmcnt(0)
  v_cmp_ne_u32 vcc, s43, v56
  s_add_u32 s63, s63, 1
  s_nop 1
  s_cbranch_vccz L_fex_157
  s_cmp_lt_u32 s63, 262144
  s_cbranch_scc1 L_fspin_154
L_fex_157:
  s_mov_b64 exec, -1
  s_nop 0
  s_branch L_fok_155
L_code_end:
.section .rodata,"a"
.p2align 6
.amdhsa_kernel interleave_layers__linear_kernel_hedgehog__glu_gated_geglu__prompt_kernel
  .amdhsa_next_free_vgpr 512
  .amdhsa_next_free_sgpr 102
  .amdhsa_accum_offset 256
  .amdhsa_group_segment_fixed_size 0
  .amdhsa_kernarg_size 88
  .amdhsa_user_sgpr_count 2
  .amdhsa_user_sgpr_kernarg_segment_ptr 1
  .amdhsa_system_sgpr_workgroup_id_x 1
.end_amdhsa_kernel
```
